```python
import torch

def _softmax(x, axis=-1):
    return torch.softmax(x, dim=axis)
def _gelu(x):
    return torch.nn.functional.gelu(x, approximate="tanh")
def _silu(x):
    return torch.nn.functional.silu(x)
def _sigmoid(x):
    return torch.sigmoid(x)
def _layernorm(x, axis=-1, eps=1e-5):
    m = x.mean(dim=axis, keepdim=True)
    v = x.var(dim=axis, keepdim=True, unbiased=False)
    return (x - m) / torch.sqrt(v + eps)
def _scatter_add(tgt, idx, src, axis=0):
    return tgt.clone().index_add_(axis, idx, src)
def _segment_sum(src, seg, n):
    out = torch.zeros((n,) + src.shape[1:], dtype=src.dtype)
    return out.index_add_(0, seg, src)
def _pad(x, pw):
    flat = tuple(v for pair in reversed(pw) for v in pair)
    return torch.nn.functional.pad(x, flat)

kernel_name = 'concat_heads__mha_block__linear_attn_block__prompt'

def setup_inputs():

    _w = (lambda a: (lambda t: t.to(torch.bfloat16) if t.is_floating_point() else t)(torch.as_tensor(a)))
    def _A_setup():
        B, S, D, H = 1, 2048, 576, 32
        return {
            "x": _w((lambda *s: torch.randn(*s, dtype=torch.bfloat16) * 0.2)(B, S, D)),
            "wqkv": _w((lambda *s: torch.randn(*s, dtype=torch.bfloat16) * 0.2)(D, 3 * D)),
            "wo": _w((lambda *s: torch.randn(*s, dtype=torch.bfloat16) * 0.05)(D, D)),
        }
    _A_in = _A_setup()

    def _B_setup():
        B, S, D = 1, 2048, 576
        return {
            "x": _w((lambda *s: torch.randn(*s, dtype=torch.bfloat16) * 0.05)(B, S, D)),
            "wqkv": _w((lambda *s: torch.randn(*s, dtype=torch.bfloat16) * 1.6)(D, 3 * D)),
            "wo": _w((lambda *s: torch.randn(*s, dtype=torch.bfloat16) * 0.05)(D, D)),
        }
    _B_in = _B_setup()

    return {
        "A_x": _A_in["x"],
        "A_wqkv": _A_in["wqkv"],
        "A_wo": _A_in["wo"],
        "B_x": _B_in["x"],
        "B_wqkv": _B_in["wqkv"],
        "B_wo": _B_in["wo"],
    }

def reference(A_x, A_wqkv, A_wo, B_x, B_wqkv, B_wo):
    def _A_ref(x, wqkv, wo):
        B, S, D = x.shape
        H = 32
        Dh = D // H
        qkv = (lambda x, *d: x.permute(*d))((x @ wqkv).reshape(B, S, 3, H, Dh), 2, 0, 3, 1, 4)
        q, k, v = qkv[0], qkv[1], qkv[2]
        scores = torch.einsum("bhqd,bhkd->bhqk", q, k) * (Dh ** -0.5)
        p = _softmax(scores, axis=-1)
        o = torch.einsum("bhqk,bhkd->bhqd", p, v)
        return (lambda x, *d: x.permute(*d))(o, 0, 2, 1, 3).reshape(B, S, D) @ wo

    def _B_ref(x, wqkv, wo):
        B, S, D = x.shape
        H = 32; Dh = D // H
        qkv = (lambda x, *d: x.permute(*d))((x @ wqkv).reshape(B, S, 3, H, Dh), 2, 0, 3, 1, 4)
        q, k, v = qkv[0], qkv[1], qkv[2]
        phi = lambda t: torch.where(t > 0, t + 1, torch.exp(t)) + 1e-6
        pq, pk = phi(q), phi(k)
        kv = torch.einsum("bhsd,bhse->bhde", pk, v)
        z = torch.einsum("bhsd->bhd", pk)
        num = torch.einsum("bhqd,bhde->bhqe", pq, kv)
        den = torch.einsum("bhqd,bhd->bhq", pq, z)[..., None] + 1e-6
        o = num / den
        return (lambda x, *d: x.permute(*d))(o, 0, 2, 1, 3).reshape(B, S, D) @ wo

    a = _A_ref(A_x, A_wqkv, A_wo)
    b = _B_ref(B_x, B_wqkv, B_wo)
    return torch.concatenate([a, b], axis=-1)
```

```asm
; @launch grid=(256,1,1) block=(512,1,1) lds=151808
.amdgcn_target "amdgcn-amd-amdhsa--gfx950"
.text
.globl concat_heads__mha_block__linear_attn_block__prompt_kernel
.p2align 8
.type concat_heads__mha_block__linear_attn_block__prompt_kernel,@function
concat_heads__mha_block__linear_attn_block__prompt_kernel:

  s_cmp_ge_u32 s2, 256
  s_cbranch_scc1 fused_end
  s_load_dwordx4 s[4:7], s[0:1], 0
  s_load_dwordx4 s[24:27], s[0:1], 24
  s_load_dwordx2 s[28:29], s[0:1], 64
  s_load_dwordx2 s[60:61], s[0:1], 56
  v_lshrrev_b32 v1, 6, v0
  v_and_b32 v0, 63, v0
  v_readfirstlane_b32 s23, v1
  s_and_b32 s30, s2, 1
  s_lshl_b32 s21, s30, 3
  s_bfe_u32 s30, s2, 0x30003
  s_add_u32 s21, s21, s30
  s_bfe_u32 s30, s2, 0x20001
  s_lshl_b32 s22, s30, 2
  s_lshr_b32 s31, s2, 6
  s_add_u32 s22, s22, s31
  s_mov_b32 s101, s23
  s_lshr_b32 s30, s2, 3
  s_lshr_b32 s31, s30, 3
  s_add_u32 s34, s30, s31
  s_and_b32 s34, s34, 3
  s_mul_i32 s30, s22, 216
  s_and_b32 s40, s30, 127
  s_cmp_ge_u32 s23, 4
  s_cbranch_scc1 qkv_loader
  v_and_b32 v14, 15, v0
  v_lshrrev_b32 v15, 4, v0
  s_lshl_b32 s33, s21, 7
  s_lshl_b32 s32, s23, 5
  s_add_u32 s33, s33, s32
  v_lshrrev_b32 v160, 2, v14
  v_and_b32 v161, 3, v14
  v_lshl_add_u32 v162, v15, 3, v160
  v_mul_u32_u24 v162, 384, v162
  v_and_b32 v163, 2, v160
  v_and_b32 v164, 1, v15
  v_lshl_or_b32 v163, v164, 2, v163
  v_lshlrev_b32 v163, 4, v163
  v_lshl_add_u32 v164, v161, 3, s40
  v_xor_b32 v165, v164, v163
  v_add_u32 v1, v165, v162
  v_add_u32 v165, 40, v164
  v_xor_b32 v165, v165, v163
  v_add_u32 v2, v165, v162
  v_add_u32 v165, 72, v164
  v_xor_b32 v165, v165, v163
  v_add_u32 v3, v165, v162
  v_add_u32 v165, 112, v164
  v_xor_b32 v165, v165, v163
  v_add_u32 v4, v165, v162
  v_add_u32 v165, 144, v164
  v_xor_b32 v165, v165, v163
  v_add_u32 v5, v165, v162
  v_add_u32 v165, 184, v164
  v_xor_b32 v165, v165, v163
  v_add_u32 v6, v165, v162
  v_min_u32 v165, 2, v161
  v_mul_u32_u24 v165, 72, v165
  s_add_u32 s32, s40, 32
  v_add_u32 v165, s32, v165
  v_xor_b32 v165, v165, v163
  v_add_u32 v7, v165, v162
  v_lshrrev_b32 v160, 1, v14
  v_xor_b32 v160, v160, v15
  v_lshlrev_b32 v160, 4, v160
  v_lshl_add_u32 v160, v14, 7, v160
  s_lshl_b32 s32, s23, 12
  s_add_u32 s32, s32, 73728
  v_add_u32 v8, s32, v160
  v_xor_b32 v9, 64, v8
  v_add_u32 v10, 16384, v8
  v_add_u32 v11, 16384, v9
  v_add_u32 v12, 32768, v8
  v_add_u32 v13, 32768, v9
  s_mov_b32 s54, 0x358637bd
  s_mov_b32 s50, 0x3eae1a93
  s_mov_b32 s51, 0x3eae1a93
  s_mov_b32 s52, 0x3fb8aa3b
  s_mov_b32 s53, 0x3fb8aa3b
  s_lshr_b32 s59, s33, 5
  s_mul_i32 s31, s22, 3
  s_add_u32 s56, s31, 0
  s_lshr_b32 s57, s56, 4
  s_and_b32 s56, s56, 15
  s_cmp_lt_u32 s57, 2
  s_cbranch_scc0 qkv_segNa0
  s_mov_b32 s44, 65536
  s_mul_i32 s32, s57, 2097152
  s_lshl_b32 s56, s56, 17
  s_add_u32 s32, s32, s56
  s_lshl_b32 s56, s59, 10
  s_add_u32 s41, s32, s56
  s_branch qkv_segDa0
qkv_segNa0:
  s_mov_b32 s44, 73728
  s_mov_b32 s32, 4718592
  s_mul_i32 s56, s56, 147456
  s_add_u32 s32, s32, s56
  s_mul_i32 s56, s59, 1152
  s_add_u32 s41, s32, s56
qkv_segDa0:
  s_cmp_eq_u32 s57, 0
  s_cselect_b32 s47, 1, 0
  s_add_u32 s56, s31, 1
  s_lshr_b32 s57, s56, 4
  s_and_b32 s56, s56, 15
  s_cmp_lt_u32 s57, 2
  s_cbranch_scc0 qkv_segNa1
  s_mov_b32 s45, 65536
  s_mul_i32 s32, s57, 2097152
  s_lshl_b32 s56, s56, 17
  s_add_u32 s32, s32, s56
  s_lshl_b32 s56, s59, 10
  s_add_u32 s42, s32, s56
  s_branch qkv_segDa1
qkv_segNa1:
  s_mov_b32 s45, 73728
  s_mov_b32 s32, 4718592
  s_mul_i32 s56, s56, 147456
  s_add_u32 s32, s32, s56
  s_mul_i32 s56, s59, 1152
  s_add_u32 s42, s32, s56
qkv_segDa1:
  s_cmp_eq_u32 s57, 0
  s_cselect_b32 s48, 1, 0
  s_add_u32 s56, s31, 2
  s_lshr_b32 s57, s56, 4
  s_and_b32 s56, s56, 15
  s_cmp_lt_u32 s57, 2
  s_cbranch_scc0 qkv_segNa2
  s_mov_b32 s46, 65536
  s_mul_i32 s32, s57, 2097152
  s_lshl_b32 s56, s56, 17
  s_add_u32 s32, s32, s56
  s_lshl_b32 s56, s59, 10
  s_add_u32 s43, s32, s56
  s_branch qkv_segDa2
qkv_segNa2:
  s_mov_b32 s46, 73728
  s_mov_b32 s32, 4718592
  s_mul_i32 s56, s56, 147456
  s_add_u32 s32, s32, s56
  s_mul_i32 s56, s59, 1152
  s_add_u32 s43, s32, s56
qkv_segDa2:
  s_cmp_eq_u32 s57, 0
  s_cselect_b32 s49, 1, 0
  s_cmp_eq_u32 s47, 2
  s_cselect_b32 s32, s54, 0
  v_mov_b32 v208, s32
  v_mov_b32 v209, s32
  v_mov_b32 v210, s32
  v_mov_b32 v211, s32
  s_cmp_eq_u32 s48, 2
  s_cselect_b32 s32, s54, 0
  v_mov_b32 v212, s32
  v_mov_b32 v213, s32
  v_mov_b32 v214, s32
  v_mov_b32 v215, s32
  s_cmp_eq_u32 s49, 2
  s_cselect_b32 s32, s54, 0
  v_mov_b32 v216, s32
  v_mov_b32 v217, s32
  v_mov_b32 v218, s32
  v_mov_b32 v219, s32
  v_lshrrev_b32 v192, 2, v14
  v_cmp_eq_u32 vcc, 1, v192
  v_cmp_le_u32 s[58:59], 2, v192
  s_nop 0
  v_mov_b32 v193, s47
  v_mov_b32 v194, s48
  v_cndmask_b32 v193, v193, v194, vcc
  v_mov_b32 v194, s49
  v_cndmask_b32 v193, v193, v194, s[58:59]
  v_cmp_eq_u32 vcc, 2, v193
  v_mov_b32 v194, s54
  s_nop 0
  v_cndmask_b32 v220, 0, v194, vcc
  v_mov_b32 v221, v220
  v_mov_b32 v222, v220
  v_mov_b32 v223, v220
  s_lshr_b32 s59, s33, 5
  s_mul_i32 s31, s22, 3
  s_add_u32 s56, s31, 0
  s_lshr_b32 s57, s56, 4
  s_and_b32 s56, s56, 15
  s_cmp_lt_u32 s57, 1
  s_cbranch_scc0 qkv_segNb0
  s_mov_b32 s11, 65536
  s_mov_b32 s32, 7340032
  s_lshl_b32 s56, s56, 17
  s_add_u32 s32, s32, s56
  s_lshl_b32 s56, s59, 10
  s_add_u32 s8, s32, s56
  s_branch qkv_segDb0
qkv_segNb0:
  s_mov_b32 s11, 73728
  s_cmp_eq_u32 s57, 1
  s_mov_b32 s32, 12058624
  s_cselect_b32 s32, 9699328, s32
  s_mul_i32 s56, s56, 147456
  s_add_u32 s32, s32, s56
  s_mul_i32 s56, s59, 1152
  s_add_u32 s8, s32, s56
qkv_segDb0:
  s_cmp_lt_u32 s57, 2
  s_cselect_b32 s14, 2, 0
  s_add_u32 s56, s31, 1
  s_lshr_b32 s57, s56, 4
  s_and_b32 s56, s56, 15
  s_cmp_lt_u32 s57, 1
  s_cbranch_scc0 qkv_segNb1
  s_mov_b32 s12, 65536
  s_mov_b32 s32, 7340032
  s_lshl_b32 s56, s56, 17
  s_add_u32 s32, s32, s56
  s_lshl_b32 s56, s59, 10
  s_add_u32 s9, s32, s56
  s_branch qkv_segDb1
qkv_segNb1:
  s_mov_b32 s12, 73728
  s_cmp_eq_u32 s57, 1
  s_mov_b32 s32, 12058624
  s_cselect_b32 s32, 9699328, s32
  s_mul_i32 s56, s56, 147456
  s_add_u32 s32, s32, s56
  s_mul_i32 s56, s59, 1152
  s_add_u32 s9, s32, s56
qkv_segDb1:
  s_cmp_lt_u32 s57, 2
  s_cselect_b32 s15, 2, 0
  s_add_u32 s56, s31, 2
  s_lshr_b32 s57, s56, 4
  s_and_b32 s56, s56, 15
  s_cmp_lt_u32 s57, 1
  s_cbranch_scc0 qkv_segNb2
  s_mov_b32 s13, 65536
  s_mov_b32 s32, 7340032
  s_lshl_b32 s56, s56, 17
  s_add_u32 s32, s32, s56
  s_lshl_b32 s56, s59, 10
  s_add_u32 s10, s32, s56
  s_branch qkv_segDb2
qkv_segNb2:
  s_mov_b32 s13, 73728
  s_cmp_eq_u32 s57, 1
  s_mov_b32 s32, 12058624
  s_cselect_b32 s32, 9699328, s32
  s_mul_i32 s56, s56, 147456
  s_add_u32 s32, s32, s56
  s_mul_i32 s56, s59, 1152
  s_add_u32 s10, s32, s56
qkv_segDb2:
  s_cmp_lt_u32 s57, 2
  s_cselect_b32 s55, 2, 0
  s_mov_b32 s20, 0
  s_waitcnt lgkmcnt(0)
  s_mov_b32 s16, s28
  s_and_b32 s17, s29, 0xffff
  s_mov_b32 s18, 19922944
  s_mov_b32 s19, 0x00020000
  s_lshl_b32 s30, s2, 2
  s_add_u32 s30, s30, s23
  v_lshlrev_b32 v200, 7, v0
  v_mov_b32 v201, 2146435072
  v_cmp_gt_u32 vcc, 18, v0
  s_mul_i32 s35, s30, 2304
  s_lshl_b32 s34, s30, 11
  v_cndmask_b32 v202, v201, v200, vcc
  v_cmp_gt_u32 vcc, 16, v0
  s_nop 1
  v_cndmask_b32 v203, v201, v200, vcc
  v_mov_b32 v54, 0
  v_mov_b32 v55, 0
  s_or_b32 s56, s2, s101
  s_cmp_lg_u32 s56, 0
  s_cbranch_scc1 qkv_nonce
  s_memrealtime s[56:57]
  s_waitcnt lgkmcnt(0)
  s_or_b32 s56, s56, 1
  v_mov_b32 v53, s56
  s_mov_b64 exec, 1
  global_store_dword v54, v53, s[60:61] sc0 sc1
  s_mov_b64 exec, -1
qkv_nonce:
qkv_pass:
  s_sub_u32 s32, 2, s20
  s_lshl_b32 s32, s32, 4
  s_mul_i32 s31, s22, 3
  s_sub_i32 s32, s32, s31
  s_cmp_ge_i32 s32, 3
  s_cbranch_scc1 qkv_v3
  s_cmp_eq_i32 s32, 2
  s_cbranch_scc1 qkv_v2
  s_cmp_eq_i32 s32, 1
  s_cbranch_scc1 qkv_v1
qkv_v0:
  s_waitcnt lgkmcnt(0)
  s_barrier
  ds_read_b64_tr_b16 v[24:25], v1 offset:0
  ds_read_b64_tr_b16 v[26:27], v1 offset:1536
  ds_read_b128 v[112:115], v8 offset:0
  ds_read_b128 v[116:119], v8 offset:2048
  ds_read_b64_tr_b16 v[28:29], v2 offset:0
  ds_read_b64_tr_b16 v[30:31], v2 offset:1536
  ds_read_b64_tr_b16 v[32:33], v3 offset:0
  ds_read_b64_tr_b16 v[34:35], v3 offset:1536
  ds_read_b64_tr_b16 v[36:37], v4 offset:0
  ds_read_b64_tr_b16 v[38:39], v4 offset:1536
  ds_read_b128 v[120:123], v9 offset:0
  ds_read_b128 v[124:127], v9 offset:2048
  ds_read_b64_tr_b16 v[40:41], v5 offset:0
  ds_read_b64_tr_b16 v[42:43], v5 offset:1536
  s_waitcnt lgkmcnt(10)
  v_mfma_f32_16x16x32_bf16 v[56:59], v[112:115], v[24:27], v[208:211]
  v_mfma_f32_16x16x32_bf16 v[60:63], v[116:119], v[24:27], v[208:211]
  ds_read_b64_tr_b16 v[44:45], v6 offset:0
  ds_read_b64_tr_b16 v[46:47], v6 offset:1536
  s_waitcnt lgkmcnt(10)
  v_mfma_f32_16x16x32_bf16 v[64:67], v[112:115], v[28:31], v[208:211]
  v_mfma_f32_16x16x32_bf16 v[68:71], v[116:119], v[28:31], v[208:211]
  ds_read_b64_tr_b16 v[48:49], v7 offset:0
  ds_read_b64_tr_b16 v[50:51], v7 offset:1536
  s_waitcnt lgkmcnt(10)
  v_mfma_f32_16x16x32_bf16 v[72:75], v[112:115], v[32:35], v[212:215]
  v_mfma_f32_16x16x32_bf16 v[76:79], v[116:119], v[32:35], v[212:215]
  ds_read_b64_tr_b16 v[24:25], v1 offset:12288
  ds_read_b64_tr_b16 v[26:27], v1 offset:13824
  s_waitcnt lgkmcnt(10)
  v_mfma_f32_16x16x32_bf16 v[80:83], v[112:115], v[36:39], v[212:215]
  v_mfma_f32_16x16x32_bf16 v[84:87], v[116:119], v[36:39], v[212:215]
  ds_read_b64_tr_b16 v[28:29], v2 offset:12288
  ds_read_b64_tr_b16 v[30:31], v2 offset:13824
  s_waitcnt lgkmcnt(8)
  v_mfma_f32_16x16x32_bf16 v[88:91], v[112:115], v[40:43], v[216:219]
  v_mfma_f32_16x16x32_bf16 v[92:95], v[116:119], v[40:43], v[216:219]
  ds_read_b64_tr_b16 v[32:33], v3 offset:12288
  ds_read_b64_tr_b16 v[34:35], v3 offset:13824
  s_waitcnt lgkmcnt(8)
  v_mfma_f32_16x16x32_bf16 v[96:99], v[112:115], v[44:47], v[216:219]
  v_mfma_f32_16x16x32_bf16 v[100:103], v[116:119], v[44:47], v[216:219]
  ds_read_b64_tr_b16 v[36:37], v4 offset:12288
  ds_read_b64_tr_b16 v[38:39], v4 offset:13824
  s_waitcnt lgkmcnt(8)
  v_mfma_f32_16x16x32_bf16 v[104:107], v[112:115], v[48:51], v[220:223]
  v_mfma_f32_16x16x32_bf16 v[108:111], v[116:119], v[48:51], v[220:223]
  ds_read_b64_tr_b16 v[40:41], v5 offset:12288
  ds_read_b64_tr_b16 v[42:43], v5 offset:13824
  s_waitcnt lgkmcnt(8)
  v_mfma_f32_16x16x32_bf16 v[56:59], v[120:123], v[24:27], v[56:59]
  v_mfma_f32_16x16x32_bf16 v[60:63], v[124:127], v[24:27], v[60:63]
  ds_read_b64_tr_b16 v[44:45], v6 offset:12288
  ds_read_b64_tr_b16 v[46:47], v6 offset:13824
  s_waitcnt lgkmcnt(8)
  v_mfma_f32_16x16x32_bf16 v[64:67], v[120:123], v[28:31], v[64:67]
  v_mfma_f32_16x16x32_bf16 v[68:71], v[124:127], v[28:31], v[68:71]
  ds_read_b64_tr_b16 v[48:49], v7 offset:12288
  ds_read_b64_tr_b16 v[50:51], v7 offset:13824
  s_waitcnt lgkmcnt(8)
  v_mfma_f32_16x16x32_bf16 v[72:75], v[120:123], v[32:35], v[72:75]
  v_mfma_f32_16x16x32_bf16 v[76:79], v[124:127], v[32:35], v[76:79]
  s_waitcnt lgkmcnt(0)
  s_barrier
  ds_read_b64_tr_b16 v[24:25], v1 offset:24576
  ds_read_b64_tr_b16 v[26:27], v1 offset:26112
  ds_read_b128 v[112:115], v10 offset:0
  ds_read_b128 v[116:119], v10 offset:2048
  v_mfma_f32_16x16x32_bf16 v[80:83], v[120:123], v[36:39], v[80:83]
  v_mfma_f32_16x16x32_bf16 v[84:87], v[124:127], v[36:39], v[84:87]
  v_lshrrev_b32 v160, 2, v14
  v_cmp_eq_u32 vcc, 1, v160
  v_cmp_le_u32 s[58:59], 2, v160
  s_nop 0
  v_mov_b32 v161, s41
  ds_read_b64_tr_b16 v[28:29], v2 offset:24576
  ds_read_b64_tr_b16 v[30:31], v2 offset:26112
  v_mfma_f32_16x16x32_bf16 v[88:91], v[120:123], v[40:43], v[88:91]
  v_mfma_f32_16x16x32_bf16 v[92:95], v[124:127], v[40:43], v[92:95]
  v_mov_b32 v166, s42
  v_cndmask_b32 v161, v161, v166, vcc
  v_mov_b32 v166, s43
  v_cndmask_b32 v161, v161, v166, s[58:59]
  v_mov_b32 v162, s44
  ds_read_b64_tr_b16 v[32:33], v3 offset:24576
  ds_read_b64_tr_b16 v[34:35], v3 offset:26112
  v_mfma_f32_16x16x32_bf16 v[96:99], v[120:123], v[44:47], v[96:99]
  v_mfma_f32_16x16x32_bf16 v[100:103], v[124:127], v[44:47], v[100:103]
  v_mov_b32 v166, s45
  v_cndmask_b32 v162, v162, v166, vcc
  v_mov_b32 v166, s46
  v_cndmask_b32 v162, v162, v166, s[58:59]
  v_mov_b32 v163, s47
  ds_read_b64_tr_b16 v[36:37], v4 offset:24576
  ds_read_b64_tr_b16 v[38:39], v4 offset:26112
  v_mfma_f32_16x16x32_bf16 v[104:107], v[120:123], v[48:51], v[104:107]
  v_mfma_f32_16x16x32_bf16 v[108:111], v[124:127], v[48:51], v[108:111]
  v_mov_b32 v166, s48
  v_cndmask_b32 v163, v163, v166, vcc
  v_mov_b32 v166, s49
  v_cndmask_b32 v163, v163, v166, s[58:59]
  v_cmp_eq_u32 vcc, 2, v163
  ds_read_b128 v[120:123], v11 offset:0
  ds_read_b128 v[124:127], v11 offset:2048
  ds_read_b64_tr_b16 v[40:41], v5 offset:24576
  ds_read_b64_tr_b16 v[42:43], v5 offset:26112
  s_waitcnt lgkmcnt(10)
  v_mfma_f32_16x16x32_bf16 v[56:59], v[112:115], v[24:27], v[56:59]
  v_mfma_f32_16x16x32_bf16 v[60:63], v[116:119], v[24:27], v[60:63]
  v_mov_b32 v166, s50
  s_nop 0
  v_cndmask_b32 v21, 0, 1, vcc
  v_cmp_eq_u32 vcc, 1, v163
  v_and_b32 v160, 1, v15
  ds_read_b64_tr_b16 v[44:45], v6 offset:24576
  ds_read_b64_tr_b16 v[46:47], v6 offset:26112
  s_waitcnt lgkmcnt(10)
  v_mfma_f32_16x16x32_bf16 v[64:67], v[112:115], v[28:31], v[64:67]
  v_mfma_f32_16x16x32_bf16 v[68:71], v[116:119], v[28:31], v[68:71]
  v_lshrrev_b32 v164, 1, v15
  v_cndmask_b32 v20, 1.0, v166, vcc
  v_lshlrev_b32 v165, 9, v160
  v_lshl_add_u32 v165, v164, 8, v165
  v_lshl_add_u32 v16, v14, 4, v165
  ds_read_b64_tr_b16 v[48:49], v7 offset:24576
  ds_read_b64_tr_b16 v[50:51], v7 offset:26112
  s_waitcnt lgkmcnt(10)
  v_mfma_f32_16x16x32_bf16 v[72:75], v[112:115], v[32:35], v[72:75]
  v_mfma_f32_16x16x32_bf16 v[76:79], v[116:119], v[32:35], v[76:79]
  v_lshlrev_b32 v165, 8, v160
  v_lshl_add_u32 v165, v164, 9, v165
  v_lshl_add_u32 v17, v14, 4, v165
  v_lshlrev_b32 v165, 5, v160
  v_lshl_add_u32 v165, v164, 6, v165
  ds_read_b64_tr_b16 v[24:25], v1 offset:36864
  ds_read_b64_tr_b16 v[26:27], v1 offset:38400
  s_waitcnt lgkmcnt(10)
  v_mfma_f32_16x16x32_bf16 v[80:83], v[112:115], v[36:39], v[80:83]
  v_mfma_f32_16x16x32_bf16 v[84:87], v[116:119], v[36:39], v[84:87]
  v_bfe_u32 v166, v14, 1, 1
  v_mul_lo_u32 v167, v166, v162
  v_add_u32 v167, v167, v161
  v_and_b32 v168, 1, v14
  v_lshl_add_u32 v169, v168, 4, v165
  ds_read_b64_tr_b16 v[28:29], v2 offset:36864
  ds_read_b64_tr_b16 v[30:31], v2 offset:38400
  s_waitcnt lgkmcnt(8)
  v_mfma_f32_16x16x32_bf16 v[88:91], v[112:115], v[40:43], v[88:91]
  v_mfma_f32_16x16x32_bf16 v[92:95], v[116:119], v[40:43], v[92:95]
  v_add_u32 v169, 1024, v169
  v_add_u32 v169, v169, v167
  v_mov_b32 v170, 65536
  v_cmp_ne_u32 vcc, v162, v170
  v_cmp_gt_u32 s[58:59], 12, v14
  ds_read_b64_tr_b16 v[32:33], v3 offset:36864
  ds_read_b64_tr_b16 v[34:35], v3 offset:38400
  s_waitcnt lgkmcnt(8)
  v_mfma_f32_16x16x32_bf16 v[96:99], v[112:115], v[44:47], v[96:99]
  v_mfma_f32_16x16x32_bf16 v[100:103], v[116:119], v[44:47], v[100:103]
  v_mov_b32 v170, 2146435072
  s_and_b64 vcc, vcc, s[58:59]
  v_cndmask_b32 v19, v170, v169, vcc
  v_lshrrev_b32 v169, 3, v167
  v_lshrrev_b32 v171, 21, v167
  ds_read_b64_tr_b16 v[36:37], v4 offset:36864
  ds_read_b64_tr_b16 v[38:39], v4 offset:38400
  s_waitcnt lgkmcnt(8)
  v_mfma_f32_16x16x32_bf16 v[104:107], v[112:115], v[48:51], v[104:107]
  v_mfma_f32_16x16x32_bf16 v[108:111], v[116:119], v[48:51], v[108:111]
  v_mov_b32 v172, 0x400000
  v_mov_b32 v173, 0x820000
  v_cmp_le_u32 vcc, 3, v171
  v_lshl_add_u32 v169, v15, 4, v169
  v_mov_b32 v171, 65536
  ds_read_b64_tr_b16 v[40:41], v5 offset:36864
  ds_read_b64_tr_b16 v[42:43], v5 offset:38400
  s_waitcnt lgkmcnt(8)
  v_mfma_f32_16x16x32_bf16 v[56:59], v[120:123], v[24:27], v[56:59]
  v_mfma_f32_16x16x32_bf16 v[60:63], v[124:127], v[24:27], v[60:63]
  v_cndmask_b32 v172, v172, v173, vcc
  v_add_u32 v169, v169, v172
  v_lshl_add_u32 v169, v168, 6, v169
  v_cmp_eq_u32 vcc, v162, v171
  v_cmp_eq_u32 s[56:57], 1, v168
  ds_read_b64_tr_b16 v[44:45], v6 offset:36864
  ds_read_b64_tr_b16 v[46:47], v6 offset:38400
  s_waitcnt lgkmcnt(8)
  v_mfma_f32_16x16x32_bf16 v[64:67], v[120:123], v[28:31], v[64:67]
  v_mfma_f32_16x16x32_bf16 v[68:71], v[124:127], v[28:31], v[68:71]
  s_nop 0
  s_and_b64 vcc, vcc, s[58:59]
  v_cndmask_b32 v18, v170, v169, vcc
  v_cndmask_b32 v52, 0, -1, s[56:57]
  v_mov_b32 v22, 0xb5c1a2a0
  ds_read_b64_tr_b16 v[48:49], v7 offset:36864
  ds_read_b64_tr_b16 v[50:51], v7 offset:38400
  s_waitcnt lgkmcnt(8)
  v_mfma_f32_16x16x32_bf16 v[72:75], v[120:123], v[32:35], v[72:75]
  v_mfma_f32_16x16x32_bf16 v[76:79], v[124:127], v[32:35], v[76:79]
  v_mov_b32 v23, 0xb5c1a2a0
  s_cmp_eq_u32 s14, 2
  s_cselect_b32 s32, s54, 0
  v_mov_b32 v208, s32
  v_mov_b32 v209, s32
  s_waitcnt lgkmcnt(0)
  s_barrier
  ds_read_b64_tr_b16 v[24:25], v1 offset:49152
  ds_read_b64_tr_b16 v[26:27], v1 offset:50688
  ds_read_b128 v[112:115], v12 offset:0
  ds_read_b128 v[116:119], v12 offset:2048
  v_mfma_f32_16x16x32_bf16 v[80:83], v[120:123], v[36:39], v[80:83]
  v_mfma_f32_16x16x32_bf16 v[84:87], v[124:127], v[36:39], v[84:87]
  v_mov_b32 v210, s32
  v_mov_b32 v211, s32
  s_cmp_eq_u32 s15, 2
  s_cselect_b32 s32, s54, 0
  v_mov_b32 v212, s32
  ds_read_b64_tr_b16 v[28:29], v2 offset:49152
  ds_read_b64_tr_b16 v[30:31], v2 offset:50688
  v_mfma_f32_16x16x32_bf16 v[88:91], v[120:123], v[40:43], v[88:91]
  v_mfma_f32_16x16x32_bf16 v[92:95], v[124:127], v[40:43], v[92:95]
  v_mov_b32 v213, s32
  v_mov_b32 v214, s32
  v_mov_b32 v215, s32
  s_cmp_eq_u32 s55, 2
  s_cselect_b32 s32, s54, 0
  ds_read_b64_tr_b16 v[32:33], v3 offset:49152
  ds_read_b64_tr_b16 v[34:35], v3 offset:50688
  v_mfma_f32_16x16x32_bf16 v[96:99], v[120:123], v[44:47], v[96:99]
  v_mfma_f32_16x16x32_bf16 v[100:103], v[124:127], v[44:47], v[100:103]
  v_mov_b32 v216, s32
  v_mov_b32 v217, s32
  v_mov_b32 v218, s32
  v_mov_b32 v219, s32
  v_lshrrev_b32 v192, 2, v14
  ds_read_b64_tr_b16 v[36:37], v4 offset:49152
  ds_read_b64_tr_b16 v[38:39], v4 offset:50688
  v_mfma_f32_16x16x32_bf16 v[104:107], v[120:123], v[48:51], v[104:107]
  v_mfma_f32_16x16x32_bf16 v[108:111], v[124:127], v[48:51], v[108:111]
  v_cmp_eq_u32 vcc, 1, v192
  v_cmp_le_u32 s[58:59], 2, v192
  s_nop 0
  v_mov_b32 v193, s14
  v_mov_b32 v194, s15
  ds_read_b128 v[120:123], v13 offset:0
  ds_read_b128 v[124:127], v13 offset:2048
  ds_read_b64_tr_b16 v[40:41], v5 offset:49152
  ds_read_b64_tr_b16 v[42:43], v5 offset:50688
  s_waitcnt lgkmcnt(10)
  v_mfma_f32_16x16x32_bf16 v[56:59], v[112:115], v[24:27], v[56:59]
  v_mfma_f32_16x16x32_bf16 v[60:63], v[116:119], v[24:27], v[60:63]
  v_cndmask_b32 v193, v193, v194, vcc
  v_mov_b32 v194, s55
  v_cndmask_b32 v193, v193, v194, s[58:59]
  v_cmp_eq_u32 vcc, 2, v193
  v_mov_b32 v194, s54
  ds_read_b64_tr_b16 v[44:45], v6 offset:49152
  ds_read_b64_tr_b16 v[46:47], v6 offset:50688
  s_waitcnt lgkmcnt(10)
  v_mfma_f32_16x16x32_bf16 v[64:67], v[112:115], v[28:31], v[64:67]
  v_mfma_f32_16x16x32_bf16 v[68:71], v[116:119], v[28:31], v[68:71]
  s_nop 0
  v_cndmask_b32 v220, 0, v194, vcc
  v_mov_b32 v221, v220
  v_mov_b32 v222, v220
  v_mov_b32 v223, v220
  ds_read_b64_tr_b16 v[48:49], v7 offset:49152
  ds_read_b64_tr_b16 v[50:51], v7 offset:50688
  s_waitcnt lgkmcnt(10)
  v_mfma_f32_16x16x32_bf16 v[72:75], v[112:115], v[32:35], v[72:75]
  v_mfma_f32_16x16x32_bf16 v[76:79], v[116:119], v[32:35], v[76:79]
  ds_read_b64_tr_b16 v[24:25], v1 offset:61440
  ds_read_b64_tr_b16 v[26:27], v1 offset:62976
  s_waitcnt lgkmcnt(10)
  v_mfma_f32_16x16x32_bf16 v[80:83], v[112:115], v[36:39], v[80:83]
  v_mfma_f32_16x16x32_bf16 v[84:87], v[116:119], v[36:39], v[84:87]
  ds_read_b64_tr_b16 v[28:29], v2 offset:61440
  ds_read_b64_tr_b16 v[30:31], v2 offset:62976
  s_waitcnt lgkmcnt(8)
  v_mfma_f32_16x16x32_bf16 v[88:91], v[112:115], v[40:43], v[88:91]
  v_mfma_f32_16x16x32_bf16 v[92:95], v[116:119], v[40:43], v[92:95]
  ds_read_b64_tr_b16 v[32:33], v3 offset:61440
  ds_read_b64_tr_b16 v[34:35], v3 offset:62976
  s_waitcnt lgkmcnt(8)
  v_mfma_f32_16x16x32_bf16 v[96:99], v[112:115], v[44:47], v[96:99]
  v_mfma_f32_16x16x32_bf16 v[100:103], v[116:119], v[44:47], v[100:103]
  ds_read_b64_tr_b16 v[36:37], v4 offset:61440
  ds_read_b64_tr_b16 v[38:39], v4 offset:62976
  s_waitcnt lgkmcnt(8)
  v_mfma_f32_16x16x32_bf16 v[104:107], v[112:115], v[48:51], v[104:107]
  v_mfma_f32_16x16x32_bf16 v[108:111], v[116:119], v[48:51], v[108:111]
  ds_read_b64_tr_b16 v[40:41], v5 offset:61440
  ds_read_b64_tr_b16 v[42:43], v5 offset:62976
  s_waitcnt lgkmcnt(8)
  v_mfma_f32_16x16x32_bf16 v[56:59], v[120:123], v[24:27], v[56:59]
  v_mfma_f32_16x16x32_bf16 v[60:63], v[124:127], v[24:27], v[60:63]
  ds_read_b64_tr_b16 v[44:45], v6 offset:61440
  ds_read_b64_tr_b16 v[46:47], v6 offset:62976
  s_waitcnt lgkmcnt(8)
  v_mfma_f32_16x16x32_bf16 v[64:67], v[120:123], v[28:31], v[64:67]
  v_mfma_f32_16x16x32_bf16 v[68:71], v[124:127], v[28:31], v[68:71]
  ds_read_b64_tr_b16 v[48:49], v7 offset:61440
  ds_read_b64_tr_b16 v[50:51], v7 offset:62976
  s_waitcnt lgkmcnt(8)
  v_mfma_f32_16x16x32_bf16 v[72:75], v[120:123], v[32:35], v[72:75]
  v_mfma_f32_16x16x32_bf16 v[76:79], v[124:127], v[32:35], v[76:79]
  s_waitcnt lgkmcnt(0)
  s_barrier
  s_cmp_eq_u32 s20, 1
  s_cbranch_scc1 qkv_nopfm0
  s_mov_b32 s64, s26
  s_and_b32 s65, s27, 0xffff
  s_mov_b32 s66, 1990656
  s_mov_b32 s67, 0x00020000
  buffer_load_dword v204, v203, s[64:67], s34 offen
  s_mov_b32 s68, s24
  s_and_b32 s69, s25, 0xffff
  s_mov_b32 s70, 2359296
  s_mov_b32 s71, 0x00020000
  buffer_load_dword v205, v202, s[68:71], s35 offen
qkv_nopfm0:
  ds_read_b64_tr_b16 v[24:25], v1 offset:0
  ds_read_b64_tr_b16 v[26:27], v1 offset:1536
  ds_read_b128 v[112:115], v8 offset:0
  ds_read_b128 v[116:119], v8 offset:2048
  v_mfma_f32_16x16x32_bf16 v[80:83], v[120:123], v[36:39], v[80:83]
  v_mfma_f32_16x16x32_bf16 v[84:87], v[124:127], v[36:39], v[84:87]
  ds_read_b64_tr_b16 v[28:29], v2 offset:0
  ds_read_b64_tr_b16 v[30:31], v2 offset:1536
  v_mfma_f32_16x16x32_bf16 v[88:91], v[120:123], v[40:43], v[88:91]
  v_mfma_f32_16x16x32_bf16 v[92:95], v[124:127], v[40:43], v[92:95]
  ds_read_b64_tr_b16 v[32:33], v3 offset:0
  ds_read_b64_tr_b16 v[34:35], v3 offset:1536
  v_mfma_f32_16x16x32_bf16 v[96:99], v[120:123], v[44:47], v[96:99]
  v_mfma_f32_16x16x32_bf16 v[100:103], v[124:127], v[44:47], v[100:103]
  ds_read_b64_tr_b16 v[36:37], v4 offset:0
  ds_read_b64_tr_b16 v[38:39], v4 offset:1536
  v_mfma_f32_16x16x32_bf16 v[104:107], v[120:123], v[48:51], v[104:107]
  v_mfma_f32_16x16x32_bf16 v[108:111], v[124:127], v[48:51], v[108:111]
  ds_read_b128 v[120:123], v9 offset:0
  ds_read_b128 v[124:127], v9 offset:2048
  ds_read_b64_tr_b16 v[40:41], v5 offset:0
  ds_read_b64_tr_b16 v[42:43], v5 offset:1536
  s_waitcnt lgkmcnt(10)
  v_mfma_f32_16x16x32_bf16 v[56:59], v[112:115], v[24:27], v[56:59]
  v_mfma_f32_16x16x32_bf16 v[60:63], v[116:119], v[24:27], v[60:63]
  ds_read_b64_tr_b16 v[44:45], v6 offset:0
  ds_read_b64_tr_b16 v[46:47], v6 offset:1536
  s_waitcnt lgkmcnt(10)
  v_mfma_f32_16x16x32_bf16 v[64:67], v[112:115], v[28:31], v[64:67]
  v_mfma_f32_16x16x32_bf16 v[68:71], v[116:119], v[28:31], v[68:71]
  ds_read_b64_tr_b16 v[48:49], v7 offset:0
  ds_read_b64_tr_b16 v[50:51], v7 offset:1536
  s_waitcnt lgkmcnt(10)
  v_mfma_f32_16x16x32_bf16 v[72:75], v[112:115], v[32:35], v[72:75]
  v_mfma_f32_16x16x32_bf16 v[76:79], v[116:119], v[32:35], v[76:79]
  ds_read_b64_tr_b16 v[24:25], v1 offset:12288
  ds_read_b64_tr_b16 v[26:27], v1 offset:13824
  s_waitcnt lgkmcnt(10)
  v_mfma_f32_16x16x32_bf16 v[80:83], v[112:115], v[36:39], v[80:83]
  v_mfma_f32_16x16x32_bf16 v[84:87], v[116:119], v[36:39], v[84:87]
  ds_read_b64_tr_b16 v[28:29], v2 offset:12288
  ds_read_b64_tr_b16 v[30:31], v2 offset:13824
  s_waitcnt lgkmcnt(8)
  v_mfma_f32_16x16x32_bf16 v[88:91], v[112:115], v[40:43], v[88:91]
  v_mfma_f32_16x16x32_bf16 v[92:95], v[116:119], v[40:43], v[92:95]
  ds_read_b64_tr_b16 v[32:33], v3 offset:12288
  ds_read_b64_tr_b16 v[34:35], v3 offset:13824
  s_waitcnt lgkmcnt(8)
  v_mfma_f32_16x16x32_bf16 v[96:99], v[112:115], v[44:47], v[96:99]
  v_mfma_f32_16x16x32_bf16 v[100:103], v[116:119], v[44:47], v[100:103]
  ds_read_b64_tr_b16 v[36:37], v4 offset:12288
  ds_read_b64_tr_b16 v[38:39], v4 offset:13824
  s_waitcnt lgkmcnt(8)
  v_mfma_f32_16x16x32_bf16 v[104:107], v[112:115], v[48:51], v[104:107]
  v_mfma_f32_16x16x32_bf16 v[108:111], v[116:119], v[48:51], v[108:111]
  ds_read_b64_tr_b16 v[40:41], v5 offset:12288
  ds_read_b64_tr_b16 v[42:43], v5 offset:13824
  s_waitcnt lgkmcnt(8)
  v_mfma_f32_16x16x32_bf16 v[56:59], v[120:123], v[24:27], v[56:59]
  v_mfma_f32_16x16x32_bf16 v[60:63], v[124:127], v[24:27], v[60:63]
  ds_read_b64_tr_b16 v[44:45], v6 offset:12288
  ds_read_b64_tr_b16 v[46:47], v6 offset:13824
  s_waitcnt lgkmcnt(8)
  v_mfma_f32_16x16x32_bf16 v[64:67], v[120:123], v[28:31], v[64:67]
  v_mfma_f32_16x16x32_bf16 v[68:71], v[124:127], v[28:31], v[68:71]
  ds_read_b64_tr_b16 v[48:49], v7 offset:12288
  ds_read_b64_tr_b16 v[50:51], v7 offset:13824
  s_waitcnt lgkmcnt(8)
  v_mfma_f32_16x16x32_bf16 v[72:75], v[120:123], v[32:35], v[72:75]
  v_mfma_f32_16x16x32_bf16 v[76:79], v[124:127], v[32:35], v[76:79]
  s_waitcnt vmcnt(0) lgkmcnt(0)
  s_barrier
  s_cmp_eq_u32 s20, 0
  s_cbranch_scc1 qkv_pa0
  s_cmp_lg_u32 s23, 0
  s_cbranch_scc1 qkv_pa0
  v_readfirstlane_b32 s100, v55
  s_mov_b32 s31, 131072
  s_nop 2
qkv_ns0:
  s_cmp_lg_u32 s100, 0
  s_cbranch_scc1 qkv_nk0
  s_sub_u32 s31, s31, 1
  s_cmp_eq_u32 s31, 0
  s_cbranch_scc1 qkv_nk0
  global_load_dword v55, v54, s[60:61] sc1
  s_waitcnt vmcnt(0)
  v_readfirstlane_b32 s100, v55
  s_nop 3
  s_branch qkv_ns0
qkv_nk0:
  v_mov_b32 v53, 151552
  v_mov_b32 v55, s100
  ds_write_b32 v53, v55
  s_lshl_b32 s30, s22, 7
  s_lshl_b32 s31, s21, 2
  s_add_u32 s30, s30, s31
  s_add_u32 s30, s30, 19922944
  v_mul_u32_u24 v200, 2048, v0
  v_add_u32 v200, s30, v200
  v_mov_b32 v201, s100
  s_mov_b64 exec, 255
  global_store_dword v200, v201, s[28:29] sc1
  s_mov_b64 exec, -1
  s_waitcnt lgkmcnt(0)
qkv_pa0:
  ds_read_b64_tr_b16 v[24:25], v1 offset:24576
  ds_read_b64_tr_b16 v[26:27], v1 offset:26112
  ds_read_b128 v[112:115], v10 offset:0
  ds_read_b128 v[116:119], v10 offset:2048
  v_mfma_f32_16x16x32_bf16 v[80:83], v[120:123], v[36:39], v[80:83]
  v_mfma_f32_16x16x32_bf16 v[84:87], v[124:127], v[36:39], v[84:87]
  ds_read_b64_tr_b16 v[28:29], v2 offset:24576
  ds_read_b64_tr_b16 v[30:31], v2 offset:26112
  v_mfma_f32_16x16x32_bf16 v[88:91], v[120:123], v[40:43], v[88:91]
  v_mfma_f32_16x16x32_bf16 v[92:95], v[124:127], v[40:43], v[92:95]
  ds_read_b64_tr_b16 v[32:33], v3 offset:24576
  ds_read_b64_tr_b16 v[34:35], v3 offset:26112
  v_mfma_f32_16x16x32_bf16 v[96:99], v[120:123], v[44:47], v[96:99]
  v_mfma_f32_16x16x32_bf16 v[100:103], v[124:127], v[44:47], v[100:103]
  ds_read_b64_tr_b16 v[36:37], v4 offset:24576
  ds_read_b64_tr_b16 v[38:39], v4 offset:26112
  v_mfma_f32_16x16x32_bf16 v[104:107], v[120:123], v[48:51], v[104:107]
  v_mfma_f32_16x16x32_bf16 v[108:111], v[124:127], v[48:51], v[108:111]
  ds_read_b128 v[120:123], v11 offset:0
  ds_read_b128 v[124:127], v11 offset:2048
  ds_read_b64_tr_b16 v[40:41], v5 offset:24576
  ds_read_b64_tr_b16 v[42:43], v5 offset:26112
  s_waitcnt lgkmcnt(10)
  v_mfma_f32_16x16x32_bf16 v[56:59], v[112:115], v[24:27], v[56:59]
  v_mfma_f32_16x16x32_bf16 v[60:63], v[116:119], v[24:27], v[60:63]
  ds_read_b64_tr_b16 v[44:45], v6 offset:24576
  ds_read_b64_tr_b16 v[46:47], v6 offset:26112
  s_waitcnt lgkmcnt(10)
  v_mfma_f32_16x16x32_bf16 v[64:67], v[112:115], v[28:31], v[64:67]
  v_mfma_f32_16x16x32_bf16 v[68:71], v[116:119], v[28:31], v[68:71]
  ds_read_b64_tr_b16 v[48:49], v7 offset:24576
  ds_read_b64_tr_b16 v[50:51], v7 offset:26112
  s_waitcnt lgkmcnt(10)
  v_mfma_f32_16x16x32_bf16 v[72:75], v[112:115], v[32:35], v[72:75]
  v_mfma_f32_16x16x32_bf16 v[76:79], v[116:119], v[32:35], v[76:79]
  ds_read_b64_tr_b16 v[24:25], v1 offset:36864
  ds_read_b64_tr_b16 v[26:27], v1 offset:38400
  s_waitcnt lgkmcnt(10)
  v_mfma_f32_16x16x32_bf16 v[80:83], v[112:115], v[36:39], v[80:83]
  v_mfma_f32_16x16x32_bf16 v[84:87], v[116:119], v[36:39], v[84:87]
  ds_read_b64_tr_b16 v[28:29], v2 offset:36864
  ds_read_b64_tr_b16 v[30:31], v2 offset:38400
  s_waitcnt lgkmcnt(8)
  v_mfma_f32_16x16x32_bf16 v[88:91], v[112:115], v[40:43], v[88:91]
  v_mfma_f32_16x16x32_bf16 v[92:95], v[116:119], v[40:43], v[92:95]
  ds_read_b64_tr_b16 v[32:33], v3 offset:36864
  ds_read_b64_tr_b16 v[34:35], v3 offset:38400
  s_waitcnt lgkmcnt(8)
  v_mfma_f32_16x16x32_bf16 v[96:99], v[112:115], v[44:47], v[96:99]
  v_mfma_f32_16x16x32_bf16 v[100:103], v[116:119], v[44:47], v[100:103]
  ds_read_b64_tr_b16 v[36:37], v4 offset:36864
  ds_read_b64_tr_b16 v[38:39], v4 offset:38400
  s_waitcnt lgkmcnt(8)
  v_mfma_f32_16x16x32_bf16 v[104:107], v[112:115], v[48:51], v[104:107]
  v_mfma_f32_16x16x32_bf16 v[108:111], v[116:119], v[48:51], v[108:111]
  ds_read_b64_tr_b16 v[40:41], v5 offset:36864
  ds_read_b64_tr_b16 v[42:43], v5 offset:38400
  s_waitcnt lgkmcnt(8)
  v_mfma_f32_16x16x32_bf16 v[56:59], v[120:123], v[24:27], v[56:59]
  v_mfma_f32_16x16x32_bf16 v[60:63], v[124:127], v[24:27], v[60:63]
  ds_read_b64_tr_b16 v[44:45], v6 offset:36864
  ds_read_b64_tr_b16 v[46:47], v6 offset:38400
  s_waitcnt lgkmcnt(8)
  v_mfma_f32_16x16x32_bf16 v[64:67], v[120:123], v[28:31], v[64:67]
  v_mfma_f32_16x16x32_bf16 v[68:71], v[124:127], v[28:31], v[68:71]
  ds_read_b64_tr_b16 v[48:49], v7 offset:36864
  ds_read_b64_tr_b16 v[50:51], v7 offset:38400
  s_waitcnt lgkmcnt(8)
  v_mfma_f32_16x16x32_bf16 v[72:75], v[120:123], v[32:35], v[72:75]
  v_mfma_f32_16x16x32_bf16 v[76:79], v[124:127], v[32:35], v[76:79]
  s_waitcnt lgkmcnt(0)
  s_barrier
  ds_read_b64_tr_b16 v[24:25], v1 offset:49152
  ds_read_b64_tr_b16 v[26:27], v1 offset:50688
  ds_read_b128 v[112:115], v12 offset:0
  ds_read_b128 v[116:119], v12 offset:2048
  v_mfma_f32_16x16x32_bf16 v[80:83], v[120:123], v[36:39], v[80:83]
  v_mfma_f32_16x16x32_bf16 v[84:87], v[124:127], v[36:39], v[84:87]
  ds_read_b64_tr_b16 v[28:29], v2 offset:49152
  ds_read_b64_tr_b16 v[30:31], v2 offset:50688
  v_mfma_f32_16x16x32_bf16 v[88:91], v[120:123], v[40:43], v[88:91]
  v_mfma_f32_16x16x32_bf16 v[92:95], v[124:127], v[40:43], v[92:95]
  ds_read_b64_tr_b16 v[32:33], v3 offset:49152
  ds_read_b64_tr_b16 v[34:35], v3 offset:50688
  v_mfma_f32_16x16x32_bf16 v[96:99], v[120:123], v[44:47], v[96:99]
  v_mfma_f32_16x16x32_bf16 v[100:103], v[124:127], v[44:47], v[100:103]
  ds_read_b64_tr_b16 v[36:37], v4 offset:49152
  ds_read_b64_tr_b16 v[38:39], v4 offset:50688
  v_mfma_f32_16x16x32_bf16 v[104:107], v[120:123], v[48:51], v[104:107]
  v_mfma_f32_16x16x32_bf16 v[108:111], v[124:127], v[48:51], v[108:111]
  ds_read_b128 v[120:123], v13 offset:0
  ds_read_b128 v[124:127], v13 offset:2048
  ds_read_b64_tr_b16 v[40:41], v5 offset:49152
  ds_read_b64_tr_b16 v[42:43], v5 offset:50688
  s_waitcnt lgkmcnt(10)
  v_mfma_f32_16x16x32_bf16 v[56:59], v[112:115], v[24:27], v[56:59]
  v_mfma_f32_16x16x32_bf16 v[60:63], v[116:119], v[24:27], v[60:63]
  ds_read_b64_tr_b16 v[44:45], v6 offset:49152
  ds_read_b64_tr_b16 v[46:47], v6 offset:50688
  s_waitcnt lgkmcnt(10)
  v_mfma_f32_16x16x32_bf16 v[64:67], v[112:115], v[28:31], v[64:67]
  v_mfma_f32_16x16x32_bf16 v[68:71], v[116:119], v[28:31], v[68:71]
  ds_read_b64_tr_b16 v[48:49], v7 offset:49152
  ds_read_b64_tr_b16 v[50:51], v7 offset:50688
  s_waitcnt lgkmcnt(10)
  v_mfma_f32_16x16x32_bf16 v[72:75], v[112:115], v[32:35], v[72:75]
  v_mfma_f32_16x16x32_bf16 v[76:79], v[116:119], v[32:35], v[76:79]
  ds_read_b64_tr_b16 v[24:25], v1 offset:61440
  ds_read_b64_tr_b16 v[26:27], v1 offset:62976
  s_waitcnt lgkmcnt(10)
  v_mfma_f32_16x16x32_bf16 v[80:83], v[112:115], v[36:39], v[80:83]
  v_mfma_f32_16x16x32_bf16 v[84:87], v[116:119], v[36:39], v[84:87]
  ds_read_b64_tr_b16 v[28:29], v2 offset:61440
  ds_read_b64_tr_b16 v[30:31], v2 offset:62976
  s_waitcnt lgkmcnt(8)
  v_mfma_f32_16x16x32_bf16 v[88:91], v[112:115], v[40:43], v[88:91]
  v_mfma_f32_16x16x32_bf16 v[92:95], v[116:119], v[40:43], v[92:95]
  ds_read_b64_tr_b16 v[32:33], v3 offset:61440
  ds_read_b64_tr_b16 v[34:35], v3 offset:62976
  s_waitcnt lgkmcnt(8)
  v_mfma_f32_16x16x32_bf16 v[96:99], v[112:115], v[44:47], v[96:99]
  v_mfma_f32_16x16x32_bf16 v[100:103], v[116:119], v[44:47], v[100:103]
  ds_read_b64_tr_b16 v[36:37], v4 offset:61440
  ds_read_b64_tr_b16 v[38:39], v4 offset:62976
  s_waitcnt lgkmcnt(8)
  v_mfma_f32_16x16x32_bf16 v[104:107], v[112:115], v[48:51], v[104:107]
  v_mfma_f32_16x16x32_bf16 v[108:111], v[116:119], v[48:51], v[108:111]
  ds_read_b64_tr_b16 v[40:41], v5 offset:61440
  ds_read_b64_tr_b16 v[42:43], v5 offset:62976
  s_waitcnt lgkmcnt(8)
  v_mfma_f32_16x16x32_bf16 v[56:59], v[120:123], v[24:27], v[56:59]
  v_mfma_f32_16x16x32_bf16 v[60:63], v[124:127], v[24:27], v[60:63]
  ds_read_b64_tr_b16 v[44:45], v6 offset:61440
  ds_read_b64_tr_b16 v[46:47], v6 offset:62976
  s_waitcnt lgkmcnt(8)
  v_mfma_f32_16x16x32_bf16 v[64:67], v[120:123], v[28:31], v[64:67]
  v_mfma_f32_16x16x32_bf16 v[68:71], v[124:127], v[28:31], v[68:71]
  ds_read_b64_tr_b16 v[48:49], v7 offset:61440
  ds_read_b64_tr_b16 v[50:51], v7 offset:62976
  s_waitcnt lgkmcnt(8)
  v_mfma_f32_16x16x32_bf16 v[72:75], v[120:123], v[32:35], v[72:75]
  v_mfma_f32_16x16x32_bf16 v[76:79], v[124:127], v[32:35], v[76:79]
  s_waitcnt lgkmcnt(0)
  s_barrier
  ds_read_b64_tr_b16 v[24:25], v1 offset:0
  ds_read_b64_tr_b16 v[26:27], v1 offset:1536
  ds_read_b128 v[112:115], v8 offset:0
  ds_read_b128 v[116:119], v8 offset:2048
  v_mfma_f32_16x16x32_bf16 v[80:83], v[120:123], v[36:39], v[80:83]
  v_mfma_f32_16x16x32_bf16 v[84:87], v[124:127], v[36:39], v[84:87]
  ds_read_b64_tr_b16 v[28:29], v2 offset:0
  ds_read_b64_tr_b16 v[30:31], v2 offset:1536
  v_mfma_f32_16x16x32_bf16 v[88:91], v[120:123], v[40:43], v[88:91]
  v_mfma_f32_16x16x32_bf16 v[92:95], v[124:127], v[40:43], v[92:95]
  ds_read_b64_tr_b16 v[32:33], v3 offset:0
  ds_read_b64_tr_b16 v[34:35], v3 offset:1536
  v_mfma_f32_16x16x32_bf16 v[96:99], v[120:123], v[44:47], v[96:99]
  v_mfma_f32_16x16x32_bf16 v[100:103], v[124:127], v[44:47], v[100:103]
  ds_read_b64_tr_b16 v[36:37], v4 offset:0
  ds_read_b64_tr_b16 v[38:39], v4 offset:1536
  v_mfma_f32_16x16x32_bf16 v[104:107], v[120:123], v[48:51], v[104:107]
  v_mfma_f32_16x16x32_bf16 v[108:111], v[124:127], v[48:51], v[108:111]
  ds_read_b128 v[120:123], v9 offset:0
  ds_read_b128 v[124:127], v9 offset:2048
  ds_read_b64_tr_b16 v[40:41], v5 offset:0
  ds_read_b64_tr_b16 v[42:43], v5 offset:1536
  s_waitcnt lgkmcnt(10)
  v_mfma_f32_16x16x32_bf16 v[56:59], v[112:115], v[24:27], v[56:59]
  v_mfma_f32_16x16x32_bf16 v[60:63], v[116:119], v[24:27], v[60:63]
  ds_read_b64_tr_b16 v[44:45], v6 offset:0
  ds_read_b64_tr_b16 v[46:47], v6 offset:1536
  s_waitcnt lgkmcnt(10)
  v_mfma_f32_16x16x32_bf16 v[64:67], v[112:115], v[28:31], v[64:67]
  v_mfma_f32_16x16x32_bf16 v[68:71], v[116:119], v[28:31], v[68:71]
  ds_read_b64_tr_b16 v[48:49], v7 offset:0
  ds_read_b64_tr_b16 v[50:51], v7 offset:1536
  s_waitcnt lgkmcnt(10)
  v_mfma_f32_16x16x32_bf16 v[72:75], v[112:115], v[32:35], v[72:75]
  v_mfma_f32_16x16x32_bf16 v[76:79], v[116:119], v[32:35], v[76:79]
  ds_read_b64_tr_b16 v[24:25], v1 offset:12288
  ds_read_b64_tr_b16 v[26:27], v1 offset:13824
  s_waitcnt lgkmcnt(10)
  v_mfma_f32_16x16x32_bf16 v[80:83], v[112:115], v[36:39], v[80:83]
  v_mfma_f32_16x16x32_bf16 v[84:87], v[116:119], v[36:39], v[84:87]
  ds_read_b64_tr_b16 v[28:29], v2 offset:12288
  ds_read_b64_tr_b16 v[30:31], v2 offset:13824
  s_waitcnt lgkmcnt(8)
  v_mfma_f32_16x16x32_bf16 v[88:91], v[112:115], v[40:43], v[88:91]
  v_mfma_f32_16x16x32_bf16 v[92:95], v[116:119], v[40:43], v[92:95]
  ds_read_b64_tr_b16 v[32:33], v3 offset:12288
  ds_read_b64_tr_b16 v[34:35], v3 offset:13824
  s_waitcnt lgkmcnt(8)
  v_mfma_f32_16x16x32_bf16 v[96:99], v[112:115], v[44:47], v[96:99]
  v_mfma_f32_16x16x32_bf16 v[100:103], v[116:119], v[44:47], v[100:103]
  ds_read_b64_tr_b16 v[36:37], v4 offset:12288
  ds_read_b64_tr_b16 v[38:39], v4 offset:13824
  s_waitcnt lgkmcnt(8)
  v_mfma_f32_16x16x32_bf16 v[104:107], v[112:115], v[48:51], v[104:107]
  v_mfma_f32_16x16x32_bf16 v[108:111], v[116:119], v[48:51], v[108:111]
  ds_read_b64_tr_b16 v[40:41], v5 offset:12288
  ds_read_b64_tr_b16 v[42:43], v5 offset:13824
  s_waitcnt lgkmcnt(8)
  v_mfma_f32_16x16x32_bf16 v[56:59], v[120:123], v[24:27], v[56:59]
  v_mfma_f32_16x16x32_bf16 v[60:63], v[124:127], v[24:27], v[60:63]
  ds_read_b64_tr_b16 v[44:45], v6 offset:12288
  ds_read_b64_tr_b16 v[46:47], v6 offset:13824
  s_waitcnt lgkmcnt(8)
  v_mfma_f32_16x16x32_bf16 v[64:67], v[120:123], v[28:31], v[64:67]
  v_mfma_f32_16x16x32_bf16 v[68:71], v[124:127], v[28:31], v[68:71]
  ds_read_b64_tr_b16 v[48:49], v7 offset:12288
  ds_read_b64_tr_b16 v[50:51], v7 offset:13824
  s_waitcnt lgkmcnt(8)
  v_mfma_f32_16x16x32_bf16 v[72:75], v[120:123], v[32:35], v[72:75]
  v_mfma_f32_16x16x32_bf16 v[76:79], v[124:127], v[32:35], v[76:79]
  s_waitcnt lgkmcnt(0)
  s_barrier
  ds_read_b64_tr_b16 v[24:25], v1 offset:24576
  ds_read_b64_tr_b16 v[26:27], v1 offset:26112
  ds_read_b128 v[112:115], v10 offset:0
  ds_read_b128 v[116:119], v10 offset:2048
  v_mfma_f32_16x16x32_bf16 v[80:83], v[120:123], v[36:39], v[80:83]
  v_mfma_f32_16x16x32_bf16 v[84:87], v[124:127], v[36:39], v[84:87]
  ds_read_b64_tr_b16 v[28:29], v2 offset:24576
  ds_read_b64_tr_b16 v[30:31], v2 offset:26112
  v_mfma_f32_16x16x32_bf16 v[88:91], v[120:123], v[40:43], v[88:91]
  v_mfma_f32_16x16x32_bf16 v[92:95], v[124:127], v[40:43], v[92:95]
  ds_read_b64_tr_b16 v[32:33], v3 offset:24576
  ds_read_b64_tr_b16 v[34:35], v3 offset:26112
  v_mfma_f32_16x16x32_bf16 v[96:99], v[120:123], v[44:47], v[96:99]
  v_mfma_f32_16x16x32_bf16 v[100:103], v[124:127], v[44:47], v[100:103]
  ds_read_b64_tr_b16 v[36:37], v4 offset:24576
  ds_read_b64_tr_b16 v[38:39], v4 offset:26112
  v_mfma_f32_16x16x32_bf16 v[104:107], v[120:123], v[48:51], v[104:107]
  v_mfma_f32_16x16x32_bf16 v[108:111], v[124:127], v[48:51], v[108:111]
  ds_read_b128 v[120:123], v11 offset:0
  ds_read_b128 v[124:127], v11 offset:2048
  ds_read_b64_tr_b16 v[40:41], v5 offset:24576
  ds_read_b64_tr_b16 v[42:43], v5 offset:26112
  s_waitcnt lgkmcnt(10)
  v_mfma_f32_16x16x32_bf16 v[56:59], v[112:115], v[24:27], v[56:59]
  v_mfma_f32_16x16x32_bf16 v[60:63], v[116:119], v[24:27], v[60:63]
  ds_read_b64_tr_b16 v[44:45], v6 offset:24576
  ds_read_b64_tr_b16 v[46:47], v6 offset:26112
  s_waitcnt lgkmcnt(10)
  v_mfma_f32_16x16x32_bf16 v[64:67], v[112:115], v[28:31], v[64:67]
  v_mfma_f32_16x16x32_bf16 v[68:71], v[116:119], v[28:31], v[68:71]
  ds_read_b64_tr_b16 v[48:49], v7 offset:24576
  ds_read_b64_tr_b16 v[50:51], v7 offset:26112
  s_waitcnt lgkmcnt(10)
  v_mfma_f32_16x16x32_bf16 v[72:75], v[112:115], v[32:35], v[72:75]
  v_mfma_f32_16x16x32_bf16 v[76:79], v[116:119], v[32:35], v[76:79]
  ds_read_b64_tr_b16 v[24:25], v1 offset:36864
  ds_read_b64_tr_b16 v[26:27], v1 offset:38400
  s_waitcnt lgkmcnt(10)
  v_mfma_f32_16x16x32_bf16 v[80:83], v[112:115], v[36:39], v[80:83]
  v_mfma_f32_16x16x32_bf16 v[84:87], v[116:119], v[36:39], v[84:87]
  ds_read_b64_tr_b16 v[28:29], v2 offset:36864
  ds_read_b64_tr_b16 v[30:31], v2 offset:38400
  s_waitcnt lgkmcnt(8)
  v_mfma_f32_16x16x32_bf16 v[88:91], v[112:115], v[40:43], v[88:91]
  v_mfma_f32_16x16x32_bf16 v[92:95], v[116:119], v[40:43], v[92:95]
  ds_read_b64_tr_b16 v[32:33], v3 offset:36864
  ds_read_b64_tr_b16 v[34:35], v3 offset:38400
  s_waitcnt lgkmcnt(8)
  v_mfma_f32_16x16x32_bf16 v[96:99], v[112:115], v[44:47], v[96:99]
  v_mfma_f32_16x16x32_bf16 v[100:103], v[116:119], v[44:47], v[100:103]
  ds_read_b64_tr_b16 v[36:37], v4 offset:36864
  ds_read_b64_tr_b16 v[38:39], v4 offset:38400
  s_waitcnt lgkmcnt(8)
  v_mfma_f32_16x16x32_bf16 v[104:107], v[112:115], v[48:51], v[104:107]
  v_mfma_f32_16x16x32_bf16 v[108:111], v[116:119], v[48:51], v[108:111]
  ds_read_b64_tr_b16 v[40:41], v5 offset:36864
  ds_read_b64_tr_b16 v[42:43], v5 offset:38400
  s_waitcnt lgkmcnt(8)
  v_mfma_f32_16x16x32_bf16 v[56:59], v[120:123], v[24:27], v[56:59]
  v_mfma_f32_16x16x32_bf16 v[60:63], v[124:127], v[24:27], v[60:63]
  ds_read_b64_tr_b16 v[44:45], v6 offset:36864
  ds_read_b64_tr_b16 v[46:47], v6 offset:38400
  s_waitcnt lgkmcnt(8)
  v_mfma_f32_16x16x32_bf16 v[64:67], v[120:123], v[28:31], v[64:67]
  v_mfma_f32_16x16x32_bf16 v[68:71], v[124:127], v[28:31], v[68:71]
  ds_read_b64_tr_b16 v[48:49], v7 offset:36864
  ds_read_b64_tr_b16 v[50:51], v7 offset:38400
  s_waitcnt lgkmcnt(8)
  v_mfma_f32_16x16x32_bf16 v[72:75], v[120:123], v[32:35], v[72:75]
  v_mfma_f32_16x16x32_bf16 v[76:79], v[124:127], v[32:35], v[76:79]
  s_waitcnt lgkmcnt(0)
  s_barrier
  ds_read_b64_tr_b16 v[24:25], v1 offset:49152
  ds_read_b64_tr_b16 v[26:27], v1 offset:50688
  ds_read_b128 v[112:115], v12 offset:0
  ds_read_b128 v[116:119], v12 offset:2048
  v_mfma_f32_16x16x32_bf16 v[80:83], v[120:123], v[36:39], v[80:83]
  v_mfma_f32_16x16x32_bf16 v[84:87], v[124:127], v[36:39], v[84:87]
  ds_read_b64_tr_b16 v[28:29], v2 offset:49152
  ds_read_b64_tr_b16 v[30:31], v2 offset:50688
  v_mfma_f32_16x16x32_bf16 v[88:91], v[120:123], v[40:43], v[88:91]
  v_mfma_f32_16x16x32_bf16 v[92:95], v[124:127], v[40:43], v[92:95]
  ds_read_b64_tr_b16 v[32:33], v3 offset:49152
  ds_read_b64_tr_b16 v[34:35], v3 offset:50688
  v_mfma_f32_16x16x32_bf16 v[96:99], v[120:123], v[44:47], v[96:99]
  v_mfma_f32_16x16x32_bf16 v[100:103], v[124:127], v[44:47], v[100:103]
  ds_read_b64_tr_b16 v[36:37], v4 offset:49152
  ds_read_b64_tr_b16 v[38:39], v4 offset:50688
  v_mfma_f32_16x16x32_bf16 v[104:107], v[120:123], v[48:51], v[104:107]
  v_mfma_f32_16x16x32_bf16 v[108:111], v[124:127], v[48:51], v[108:111]
  ds_read_b128 v[120:123], v13 offset:0
  ds_read_b128 v[124:127], v13 offset:2048
  ds_read_b64_tr_b16 v[40:41], v5 offset:49152
  ds_read_b64_tr_b16 v[42:43], v5 offset:50688
  s_waitcnt lgkmcnt(10)
  v_mfma_f32_16x16x32_bf16 v[56:59], v[112:115], v[24:27], v[56:59]
  v_mfma_f32_16x16x32_bf16 v[60:63], v[116:119], v[24:27], v[60:63]
  ds_read_b64_tr_b16 v[44:45], v6 offset:49152
  ds_read_b64_tr_b16 v[46:47], v6 offset:50688
  s_waitcnt lgkmcnt(10)
  v_mfma_f32_16x16x32_bf16 v[64:67], v[112:115], v[28:31], v[64:67]
  v_mfma_f32_16x16x32_bf16 v[68:71], v[116:119], v[28:31], v[68:71]
  ds_read_b64_tr_b16 v[48:49], v7 offset:49152
  ds_read_b64_tr_b16 v[50:51], v7 offset:50688
  s_waitcnt lgkmcnt(10)
  v_mfma_f32_16x16x32_bf16 v[72:75], v[112:115], v[32:35], v[72:75]
  v_mfma_f32_16x16x32_bf16 v[76:79], v[116:119], v[32:35], v[76:79]
  ds_read_b64_tr_b16 v[24:25], v1 offset:61440
  ds_read_b64_tr_b16 v[26:27], v1 offset:62976
  s_waitcnt lgkmcnt(10)
  v_mfma_f32_16x16x32_bf16 v[80:83], v[112:115], v[36:39], v[80:83]
  v_mfma_f32_16x16x32_bf16 v[84:87], v[116:119], v[36:39], v[84:87]
  ds_read_b64_tr_b16 v[28:29], v2 offset:61440
  ds_read_b64_tr_b16 v[30:31], v2 offset:62976
  s_waitcnt lgkmcnt(8)
  v_mfma_f32_16x16x32_bf16 v[88:91], v[112:115], v[40:43], v[88:91]
  v_mfma_f32_16x16x32_bf16 v[92:95], v[116:119], v[40:43], v[92:95]
  ds_read_b64_tr_b16 v[32:33], v3 offset:61440
  ds_read_b64_tr_b16 v[34:35], v3 offset:62976
  s_waitcnt lgkmcnt(8)
  v_mfma_f32_16x16x32_bf16 v[96:99], v[112:115], v[44:47], v[96:99]
  v_mfma_f32_16x16x32_bf16 v[100:103], v[116:119], v[44:47], v[100:103]
  ds_read_b64_tr_b16 v[36:37], v4 offset:61440
  ds_read_b64_tr_b16 v[38:39], v4 offset:62976
  s_waitcnt lgkmcnt(8)
  v_mfma_f32_16x16x32_bf16 v[104:107], v[112:115], v[48:51], v[104:107]
  v_mfma_f32_16x16x32_bf16 v[108:111], v[116:119], v[48:51], v[108:111]
  ds_read_b64_tr_b16 v[40:41], v5 offset:61440
  ds_read_b64_tr_b16 v[42:43], v5 offset:62976
  s_waitcnt lgkmcnt(8)
  v_mfma_f32_16x16x32_bf16 v[56:59], v[120:123], v[24:27], v[56:59]
  v_mfma_f32_16x16x32_bf16 v[60:63], v[124:127], v[24:27], v[60:63]
  ds_read_b64_tr_b16 v[44:45], v6 offset:61440
  ds_read_b64_tr_b16 v[46:47], v6 offset:62976
  s_waitcnt lgkmcnt(8)
  v_mfma_f32_16x16x32_bf16 v[64:67], v[120:123], v[28:31], v[64:67]
  v_mfma_f32_16x16x32_bf16 v[68:71], v[124:127], v[28:31], v[68:71]
  ds_read_b64_tr_b16 v[48:49], v7 offset:61440
  ds_read_b64_tr_b16 v[50:51], v7 offset:62976
  s_waitcnt lgkmcnt(8)
  v_mfma_f32_16x16x32_bf16 v[72:75], v[120:123], v[32:35], v[72:75]
  v_mfma_f32_16x16x32_bf16 v[76:79], v[124:127], v[32:35], v[76:79]
  s_waitcnt lgkmcnt(0)
  v_mfma_f32_16x16x32_bf16 v[80:83], v[120:123], v[36:39], v[80:83]
  v_mfma_f32_16x16x32_bf16 v[84:87], v[124:127], v[36:39], v[84:87]
  v_mfma_f32_16x16x32_bf16 v[88:91], v[120:123], v[40:43], v[88:91]
  v_mfma_f32_16x16x32_bf16 v[92:95], v[124:127], v[40:43], v[92:95]
  v_mfma_f32_16x16x32_bf16 v[96:99], v[120:123], v[44:47], v[96:99]
  v_mfma_f32_16x16x32_bf16 v[100:103], v[124:127], v[44:47], v[100:103]
  v_mfma_f32_16x16x32_bf16 v[104:107], v[120:123], v[48:51], v[104:107]
  v_mfma_f32_16x16x32_bf16 v[108:111], v[124:127], v[48:51], v[108:111]
  s_nop 7
  s_cmp_eq_u32 s47, 2
  s_cbranch_scc0 qkv_np0_0
  v_pk_fma_f32 v[160:161], v[56:57], s[52:53], v[22:23]
  v_pk_fma_f32 v[162:163], v[58:59], s[52:53], v[22:23]
  v_pk_fma_f32 v[164:165], v[60:61], s[52:53], v[22:23]
  v_pk_fma_f32 v[166:167], v[62:63], s[52:53], v[22:23]
  v_pk_fma_f32 v[168:169], v[64:65], s[52:53], v[22:23]
  v_pk_fma_f32 v[170:171], v[66:67], s[52:53], v[22:23]
  v_pk_fma_f32 v[172:173], v[68:69], s[52:53], v[22:23]
  v_pk_fma_f32 v[174:175], v[70:71], s[52:53], v[22:23]
  v_exp_f32_e64 v160, v160 clamp
  v_max_f32 v56, s54, v56
  v_exp_f32_e64 v161, v161 clamp
  v_max_f32 v57, s54, v57
  v_exp_f32_e64 v162, v162 clamp
  v_max_f32 v58, s54, v58
  v_exp_f32_e64 v163, v163 clamp
  v_max_f32 v59, s54, v59
  v_exp_f32_e64 v164, v164 clamp
  v_max_f32 v60, s54, v60
  v_exp_f32_e64 v165, v165 clamp
  v_max_f32 v61, s54, v61
  v_exp_f32_e64 v166, v166 clamp
  v_max_f32 v62, s54, v62
  v_exp_f32_e64 v167, v167 clamp
  v_max_f32 v63, s54, v63
  v_exp_f32_e64 v168, v168 clamp
  v_max_f32 v64, s54, v64
  v_exp_f32_e64 v169, v169 clamp
  v_max_f32 v65, s54, v65
  v_exp_f32_e64 v170, v170 clamp
  v_max_f32 v66, s54, v66
  v_exp_f32_e64 v171, v171 clamp
  v_max_f32 v67, s54, v67
  v_exp_f32_e64 v172, v172 clamp
  v_max_f32 v68, s54, v68
  v_exp_f32_e64 v173, v173 clamp
  v_max_f32 v69, s54, v69
  v_exp_f32_e64 v174, v174 clamp
  v_max_f32 v70, s54, v70
  v_exp_f32_e64 v175, v175 clamp
  v_max_f32 v71, s54, v71
  v_pk_add_f32 v[56:57], v[56:57], v[160:161]
  v_pk_add_f32 v[58:59], v[58:59], v[162:163]
  v_pk_add_f32 v[60:61], v[60:61], v[164:165]
  v_pk_add_f32 v[62:63], v[62:63], v[166:167]
  v_pk_add_f32 v[64:65], v[64:65], v[168:169]
  v_pk_add_f32 v[66:67], v[66:67], v[170:171]
  v_pk_add_f32 v[68:69], v[68:69], v[172:173]
  v_pk_add_f32 v[70:71], v[70:71], v[174:175]
qkv_np0_0:
  v_cvt_pk_bf16_f32 v128, v56, v57
  v_cvt_pk_bf16_f32 v129, v58, v59
  v_cvt_pk_bf16_f32 v130, v60, v61
  v_cvt_pk_bf16_f32 v131, v62, v63
  s_nop 0
  v_permlane32_swap_b32 v128, v130
  v_permlane32_swap_b32 v129, v131
  buffer_store_dwordx4 v[128:131], v17, s[16:19], s41 offen sc1
  s_add_u32 s56, s41, s44
  v_cvt_pk_bf16_f32 v132, v64, v65
  v_cvt_pk_bf16_f32 v133, v66, v67
  v_cvt_pk_bf16_f32 v134, v68, v69
  v_cvt_pk_bf16_f32 v135, v70, v71
  s_nop 0
  v_permlane32_swap_b32 v132, v134
  v_permlane32_swap_b32 v133, v135
  buffer_store_dwordx4 v[132:135], v17, s[16:19], s56 offen sc1
  s_cmp_eq_u32 s48, 2
  s_cbranch_scc0 qkv_np0_1
  v_pk_fma_f32 v[160:161], v[72:73], s[52:53], v[22:23]
  v_pk_fma_f32 v[162:163], v[74:75], s[52:53], v[22:23]
  v_pk_fma_f32 v[164:165], v[76:77], s[52:53], v[22:23]
  v_pk_fma_f32 v[166:167], v[78:79], s[52:53], v[22:23]
  v_pk_fma_f32 v[168:169], v[80:81], s[52:53], v[22:23]
  v_pk_fma_f32 v[170:171], v[82:83], s[52:53], v[22:23]
  v_pk_fma_f32 v[172:173], v[84:85], s[52:53], v[22:23]
  v_pk_fma_f32 v[174:175], v[86:87], s[52:53], v[22:23]
  v_exp_f32_e64 v160, v160 clamp
  v_max_f32 v72, s54, v72
  v_exp_f32_e64 v161, v161 clamp
  v_max_f32 v73, s54, v73
  v_exp_f32_e64 v162, v162 clamp
  v_max_f32 v74, s54, v74
  v_exp_f32_e64 v163, v163 clamp
  v_max_f32 v75, s54, v75
  v_exp_f32_e64 v164, v164 clamp
  v_max_f32 v76, s54, v76
  v_exp_f32_e64 v165, v165 clamp
  v_max_f32 v77, s54, v77
  v_exp_f32_e64 v166, v166 clamp
  v_max_f32 v78, s54, v78
  v_exp_f32_e64 v167, v167 clamp
  v_max_f32 v79, s54, v79
  v_exp_f32_e64 v168, v168 clamp
  v_max_f32 v80, s54, v80
  v_exp_f32_e64 v169, v169 clamp
  v_max_f32 v81, s54, v81
  v_exp_f32_e64 v170, v170 clamp
  v_max_f32 v82, s54, v82
  v_exp_f32_e64 v171, v171 clamp
  v_max_f32 v83, s54, v83
  v_exp_f32_e64 v172, v172 clamp
  v_max_f32 v84, s54, v84
  v_exp_f32_e64 v173, v173 clamp
  v_max_f32 v85, s54, v85
  v_exp_f32_e64 v174, v174 clamp
  v_max_f32 v86, s54, v86
  v_exp_f32_e64 v175, v175 clamp
  v_max_f32 v87, s54, v87
  v_pk_add_f32 v[72:73], v[72:73], v[160:161]
  v_pk_add_f32 v[74:75], v[74:75], v[162:163]
  v_pk_add_f32 v[76:77], v[76:77], v[164:165]
  v_pk_add_f32 v[78:79], v[78:79], v[166:167]
  v_pk_add_f32 v[80:81], v[80:81], v[168:169]
  v_pk_add_f32 v[82:83], v[82:83], v[170:171]
  v_pk_add_f32 v[84:85], v[84:85], v[172:173]
  v_pk_add_f32 v[86:87], v[86:87], v[174:175]
qkv_np0_1:
  v_cvt_pk_bf16_f32 v136, v72, v73
  v_cvt_pk_bf16_f32 v137, v74, v75
  v_cvt_pk_bf16_f32 v138, v76, v77
  v_cvt_pk_bf16_f32 v139, v78, v79
  s_nop 0
  v_permlane32_swap_b32 v136, v138
  v_permlane32_swap_b32 v137, v139
  buffer_store_dwordx4 v[136:139], v17, s[16:19], s42 offen sc1
  s_add_u32 s56, s42, s45
  v_cvt_pk_bf16_f32 v140, v80, v81
  v_cvt_pk_bf16_f32 v141, v82, v83
  v_cvt_pk_bf16_f32 v142, v84, v85
  v_cvt_pk_bf16_f32 v143, v86, v87
  s_nop 0
  v_permlane32_swap_b32 v140, v142
  v_permlane32_swap_b32 v141, v143
  buffer_store_dwordx4 v[140:143], v17, s[16:19], s56 offen sc1
  s_cmp_eq_u32 s49, 2
  s_cbranch_scc0 qkv_np0_2
  v_pk_fma_f32 v[160:161], v[88:89], s[52:53], v[22:23]
  v_pk_fma_f32 v[162:163], v[90:91], s[52:53], v[22:23]
  v_pk_fma_f32 v[164:165], v[92:93], s[52:53], v[22:23]
  v_pk_fma_f32 v[166:167], v[94:95], s[52:53], v[22:23]
  v_pk_fma_f32 v[168:169], v[96:97], s[52:53], v[22:23]
  v_pk_fma_f32 v[170:171], v[98:99], s[52:53], v[22:23]
  v_pk_fma_f32 v[172:173], v[100:101], s[52:53], v[22:23]
  v_pk_fma_f32 v[174:175], v[102:103], s[52:53], v[22:23]
  v_exp_f32_e64 v160, v160 clamp
  v_max_f32 v88, s54, v88
  v_exp_f32_e64 v161, v161 clamp
  v_max_f32 v89, s54, v89
  v_exp_f32_e64 v162, v162 clamp
  v_max_f32 v90, s54, v90
  v_exp_f32_e64 v163, v163 clamp
  v_max_f32 v91, s54, v91
  v_exp_f32_e64 v164, v164 clamp
  v_max_f32 v92, s54, v92
  v_exp_f32_e64 v165, v165 clamp
  v_max_f32 v93, s54, v93
  v_exp_f32_e64 v166, v166 clamp
  v_max_f32 v94, s54, v94
  v_exp_f32_e64 v167, v167 clamp
  v_max_f32 v95, s54, v95
  v_exp_f32_e64 v168, v168 clamp
  v_max_f32 v96, s54, v96
  v_exp_f32_e64 v169, v169 clamp
  v_max_f32 v97, s54, v97
  v_exp_f32_e64 v170, v170 clamp
  v_max_f32 v98, s54, v98
  v_exp_f32_e64 v171, v171 clamp
  v_max_f32 v99, s54, v99
  v_exp_f32_e64 v172, v172 clamp
  v_max_f32 v100, s54, v100
  v_exp_f32_e64 v173, v173 clamp
  v_max_f32 v101, s54, v101
  v_exp_f32_e64 v174, v174 clamp
  v_max_f32 v102, s54, v102
  v_exp_f32_e64 v175, v175 clamp
  v_max_f32 v103, s54, v103
  v_pk_add_f32 v[88:89], v[88:89], v[160:161]
  v_pk_add_f32 v[90:91], v[90:91], v[162:163]
  v_pk_add_f32 v[92:93], v[92:93], v[164:165]
  v_pk_add_f32 v[94:95], v[94:95], v[166:167]
  v_pk_add_f32 v[96:97], v[96:97], v[168:169]
  v_pk_add_f32 v[98:99], v[98:99], v[170:171]
  v_pk_add_f32 v[100:101], v[100:101], v[172:173]
  v_pk_add_f32 v[102:103], v[102:103], v[174:175]
qkv_np0_2:
  v_cvt_pk_bf16_f32 v144, v88, v89
  v_cvt_pk_bf16_f32 v145, v90, v91
  v_cvt_pk_bf16_f32 v146, v92, v93
  v_cvt_pk_bf16_f32 v147, v94, v95
  s_nop 0
  v_permlane32_swap_b32 v144, v146
  v_permlane32_swap_b32 v145, v147
  buffer_store_dwordx4 v[144:147], v17, s[16:19], s43 offen sc1
  s_add_u32 s56, s43, s46
  v_cvt_pk_bf16_f32 v148, v96, v97
  v_cvt_pk_bf16_f32 v149, v98, v99
  v_cvt_pk_bf16_f32 v150, v100, v101
  v_cvt_pk_bf16_f32 v151, v102, v103
  s_nop 0
  v_permlane32_swap_b32 v148, v150
  v_permlane32_swap_b32 v149, v151
  buffer_store_dwordx4 v[148:151], v17, s[16:19], s56 offen sc1
  v_mul_f32 v104, v20, v104
  v_mul_f32 v105, v20, v105
  v_mul_f32 v106, v20, v106
  v_mul_f32 v107, v20, v107
  v_mul_f32 v108, v20, v108
  v_mul_f32 v109, v20, v109
  v_mul_f32 v110, v20, v110
  v_mul_f32 v111, v20, v111
  s_cmp_eq_u32 s20, 0
  s_cbranch_scc1 qkv_xp0
  v_pk_mul_f32 v[176:177], v[104:105], 1.0 op_sel_hi:[1,0]
  v_pk_mul_f32 v[178:179], v[106:107], 1.0 op_sel_hi:[1,0]
  v_pk_mul_f32 v[180:181], v[108:109], 1.0 op_sel_hi:[1,0]
  v_pk_mul_f32 v[182:183], v[110:111], 1.0 op_sel_hi:[1,0]
  v_pk_fma_f32 v[160:161], v[176:177], s[52:53], v[22:23]
  v_pk_fma_f32 v[162:163], v[178:179], s[52:53], v[22:23]
  v_pk_fma_f32 v[164:165], v[180:181], s[52:53], v[22:23]
  v_pk_fma_f32 v[166:167], v[182:183], s[52:53], v[22:23]
  v_exp_f32_e64 v160, v160 clamp
  v_max_f32 v176, s54, v176
  v_exp_f32_e64 v161, v161 clamp
  v_max_f32 v177, s54, v177
  v_exp_f32_e64 v162, v162 clamp
  v_max_f32 v178, s54, v178
  v_exp_f32_e64 v163, v163 clamp
  v_max_f32 v179, s54, v179
  v_exp_f32_e64 v164, v164 clamp
  v_max_f32 v180, s54, v180
  v_exp_f32_e64 v165, v165 clamp
  v_max_f32 v181, s54, v181
  v_exp_f32_e64 v166, v166 clamp
  v_max_f32 v182, s54, v182
  v_exp_f32_e64 v167, v167 clamp
  v_max_f32 v183, s54, v183
  v_pk_add_f32 v[176:177], v[176:177], v[160:161]
  v_pk_add_f32 v[178:179], v[178:179], v[162:163]
  v_pk_add_f32 v[180:181], v[180:181], v[164:165]
  v_pk_add_f32 v[182:183], v[182:183], v[166:167]
  v_cmp_eq_u32 vcc, 1, v21
  s_nop 1
  v_cndmask_b32 v104, v104, v176, vcc
  v_cndmask_b32 v105, v105, v177, vcc
  v_cndmask_b32 v106, v106, v178, vcc
  v_cndmask_b32 v107, v107, v179, vcc
  v_cndmask_b32 v108, v108, v180, vcc
  v_cndmask_b32 v109, v109, v181, vcc
  v_cndmask_b32 v110, v110, v182, vcc
  v_cndmask_b32 v111, v111, v183, vcc
qkv_xp0:
  v_cvt_pk_bf16_f32 v152, v104, v105
  v_cvt_pk_bf16_f32 v153, v106, v107
  v_cvt_pk_bf16_f32 v154, v108, v109
  v_cvt_pk_bf16_f32 v155, v110, v111
  s_nop 0
  v_permlane32_swap_b32 v152, v154
  v_permlane32_swap_b32 v153, v155
  buffer_store_dwordx4 v[152:155], v19, s[16:19], 0 offen sc1
  s_branch qkv_passend
qkv_v1:
  s_waitcnt lgkmcnt(0)
  s_barrier
  ds_read_b64_tr_b16 v[24:25], v1 offset:0
  ds_read_b64_tr_b16 v[26:27], v1 offset:1536
  ds_read_b128 v[112:115], v8 offset:0
  ds_read_b128 v[116:119], v8 offset:2048
  ds_read_b64_tr_b16 v[28:29], v2 offset:0
  ds_read_b64_tr_b16 v[30:31], v2 offset:1536
  ds_read_b64_tr_b16 v[32:33], v3 offset:0
  ds_read_b64_tr_b16 v[34:35], v3 offset:1536
  ds_read_b64_tr_b16 v[36:37], v4 offset:0
  ds_read_b64_tr_b16 v[38:39], v4 offset:1536
  ds_read_b128 v[120:123], v9 offset:0
  ds_read_b128 v[124:127], v9 offset:2048
  ds_read_b64_tr_b16 v[40:41], v5 offset:0
  ds_read_b64_tr_b16 v[42:43], v5 offset:1536
  s_waitcnt lgkmcnt(10)
  v_mfma_f32_16x16x32_bf16 v[56:59], v[24:27], v[112:115], v[208:211]
  v_mfma_f32_16x16x32_bf16 v[60:63], v[24:27], v[116:119], v[208:211]
  ds_read_b64_tr_b16 v[44:45], v6 offset:0
  ds_read_b64_tr_b16 v[46:47], v6 offset:1536
  s_waitcnt lgkmcnt(10)
  v_mfma_f32_16x16x32_bf16 v[64:67], v[28:31], v[112:115], v[208:211]
  v_mfma_f32_16x16x32_bf16 v[68:71], v[28:31], v[116:119], v[208:211]
  ds_read_b64_tr_b16 v[48:49], v7 offset:0
  ds_read_b64_tr_b16 v[50:51], v7 offset:1536
  s_waitcnt lgkmcnt(10)
  v_mfma_f32_16x16x32_bf16 v[72:75], v[112:115], v[32:35], v[212:215]
  v_mfma_f32_16x16x32_bf16 v[76:79], v[116:119], v[32:35], v[212:215]
  ds_read_b64_tr_b16 v[24:25], v1 offset:12288
  ds_read_b64_tr_b16 v[26:27], v1 offset:13824
  s_waitcnt lgkmcnt(10)
  v_mfma_f32_16x16x32_bf16 v[80:83], v[112:115], v[36:39], v[212:215]
  v_mfma_f32_16x16x32_bf16 v[84:87], v[116:119], v[36:39], v[212:215]
  ds_read_b64_tr_b16 v[28:29], v2 offset:12288
  ds_read_b64_tr_b16 v[30:31], v2 offset:13824
  s_waitcnt lgkmcnt(8)
  v_mfma_f32_16x16x32_bf16 v[88:91], v[112:115], v[40:43], v[216:219]
  v_mfma_f32_16x16x32_bf16 v[92:95], v[116:119], v[40:43], v[216:219]
  ds_read_b64_tr_b16 v[32:33], v3 offset:12288
  ds_read_b64_tr_b16 v[34:35], v3 offset:13824
  s_waitcnt lgkmcnt(8)
  v_mfma_f32_16x16x32_bf16 v[96:99], v[112:115], v[44:47], v[216:219]
  v_mfma_f32_16x16x32_bf16 v[100:103], v[116:119], v[44:47], v[216:219]
  ds_read_b64_tr_b16 v[36:37], v4 offset:12288
  ds_read_b64_tr_b16 v[38:39], v4 offset:13824
  s_waitcnt lgkmcnt(8)
  v_mfma_f32_16x16x32_bf16 v[104:107], v[112:115], v[48:51], v[220:223]
  v_mfma_f32_16x16x32_bf16 v[108:111], v[116:119], v[48:51], v[220:223]
  ds_read_b64_tr_b16 v[40:41], v5 offset:12288
  ds_read_b64_tr_b16 v[42:43], v5 offset:13824
  s_waitcnt lgkmcnt(8)
  v_mfma_f32_16x16x32_bf16 v[56:59], v[24:27], v[120:123], v[56:59]
  v_mfma_f32_16x16x32_bf16 v[60:63], v[24:27], v[124:127], v[60:63]
  ds_read_b64_tr_b16 v[44:45], v6 offset:12288
  ds_read_b64_tr_b16 v[46:47], v6 offset:13824
  s_waitcnt lgkmcnt(8)
  v_mfma_f32_16x16x32_bf16 v[64:67], v[28:31], v[120:123], v[64:67]
  v_mfma_f32_16x16x32_bf16 v[68:71], v[28:31], v[124:127], v[68:71]
  ds_read_b64_tr_b16 v[48:49], v7 offset:12288
  ds_read_b64_tr_b16 v[50:51], v7 offset:13824
  s_waitcnt lgkmcnt(8)
  v_mfma_f32_16x16x32_bf16 v[72:75], v[120:123], v[32:35], v[72:75]
  v_mfma_f32_16x16x32_bf16 v[76:79], v[124:127], v[32:35], v[76:79]
  s_waitcnt lgkmcnt(0)
  s_barrier
  ds_read_b64_tr_b16 v[24:25], v1 offset:24576
  ds_read_b64_tr_b16 v[26:27], v1 offset:26112
  ds_read_b128 v[112:115], v10 offset:0
  ds_read_b128 v[116:119], v10 offset:2048
  v_mfma_f32_16x16x32_bf16 v[80:83], v[120:123], v[36:39], v[80:83]
  v_mfma_f32_16x16x32_bf16 v[84:87], v[124:127], v[36:39], v[84:87]
  v_lshrrev_b32 v160, 2, v14
  v_cmp_eq_u32 vcc, 1, v160
  v_cmp_le_u32 s[58:59], 2, v160
  s_nop 0
  v_mov_b32 v161, s41
  ds_read_b64_tr_b16 v[28:29], v2 offset:24576
  ds_read_b64_tr_b16 v[30:31], v2 offset:26112
  v_mfma_f32_16x16x32_bf16 v[88:91], v[120:123], v[40:43], v[88:91]
  v_mfma_f32_16x16x32_bf16 v[92:95], v[124:127], v[40:43], v[92:95]
  v_mov_b32 v166, s42
  v_cndmask_b32 v161, v161, v166, vcc
  v_mov_b32 v166, s43
  v_cndmask_b32 v161, v161, v166, s[58:59]
  v_mov_b32 v162, s44
  ds_read_b64_tr_b16 v[32:33], v3 offset:24576
  ds_read_b64_tr_b16 v[34:35], v3 offset:26112
  v_mfma_f32_16x16x32_bf16 v[96:99], v[120:123], v[44:47], v[96:99]
  v_mfma_f32_16x16x32_bf16 v[100:103], v[124:127], v[44:47], v[100:103]
  v_mov_b32 v166, s45
  v_cndmask_b32 v162, v162, v166, vcc
  v_mov_b32 v166, s46
  v_cndmask_b32 v162, v162, v166, s[58:59]
  v_mov_b32 v163, s47
  ds_read_b64_tr_b16 v[36:37], v4 offset:24576
  ds_read_b64_tr_b16 v[38:39], v4 offset:26112
  v_mfma_f32_16x16x32_bf16 v[104:107], v[120:123], v[48:51], v[104:107]
  v_mfma_f32_16x16x32_bf16 v[108:111], v[124:127], v[48:51], v[108:111]
  v_mov_b32 v166, s48
  v_cndmask_b32 v163, v163, v166, vcc
  v_mov_b32 v166, s49
  v_cndmask_b32 v163, v163, v166, s[58:59]
  v_cmp_eq_u32 vcc, 2, v163
  ds_read_b128 v[120:123], v11 offset:0
  ds_read_b128 v[124:127], v11 offset:2048
  ds_read_b64_tr_b16 v[40:41], v5 offset:24576
  ds_read_b64_tr_b16 v[42:43], v5 offset:26112
  s_waitcnt lgkmcnt(10)
  v_mfma_f32_16x16x32_bf16 v[56:59], v[24:27], v[112:115], v[56:59]
  v_mfma_f32_16x16x32_bf16 v[60:63], v[24:27], v[116:119], v[60:63]
  v_mov_b32 v166, s50
  s_nop 0
  v_cndmask_b32 v21, 0, 1, vcc
  v_cmp_eq_u32 vcc, 1, v163
  v_and_b32 v160, 1, v15
  ds_read_b64_tr_b16 v[44:45], v6 offset:24576
  ds_read_b64_tr_b16 v[46:47], v6 offset:26112
  s_waitcnt lgkmcnt(10)
  v_mfma_f32_16x16x32_bf16 v[64:67], v[28:31], v[112:115], v[64:67]
  v_mfma_f32_16x16x32_bf16 v[68:71], v[28:31], v[116:119], v[68:71]
  v_lshrrev_b32 v164, 1, v15
  v_cndmask_b32 v20, 1.0, v166, vcc
  v_lshlrev_b32 v165, 9, v160
  v_lshl_add_u32 v165, v164, 8, v165
  v_lshl_add_u32 v16, v14, 4, v165
  ds_read_b64_tr_b16 v[48:49], v7 offset:24576
  ds_read_b64_tr_b16 v[50:51], v7 offset:26112
  s_waitcnt lgkmcnt(10)
  v_mfma_f32_16x16x32_bf16 v[72:75], v[112:115], v[32:35], v[72:75]
  v_mfma_f32_16x16x32_bf16 v[76:79], v[116:119], v[32:35], v[76:79]
  v_lshlrev_b32 v165, 8, v160
  v_lshl_add_u32 v165, v164, 9, v165
  v_lshl_add_u32 v17, v14, 4, v165
  v_lshlrev_b32 v165, 5, v160
  v_lshl_add_u32 v165, v164, 6, v165
  ds_read_b64_tr_b16 v[24:25], v1 offset:36864
  ds_read_b64_tr_b16 v[26:27], v1 offset:38400
  s_waitcnt lgkmcnt(10)
  v_mfma_f32_16x16x32_bf16 v[80:83], v[112:115], v[36:39], v[80:83]
  v_mfma_f32_16x16x32_bf16 v[84:87], v[116:119], v[36:39], v[84:87]
  v_bfe_u32 v166, v14, 1, 1
  v_mul_lo_u32 v167, v166, v162
  v_add_u32 v167, v167, v161
  v_and_b32 v168, 1, v14
  v_lshl_add_u32 v169, v168, 4, v165
  ds_read_b64_tr_b16 v[28:29], v2 offset:36864
  ds_read_b64_tr_b16 v[30:31], v2 offset:38400
  s_waitcnt lgkmcnt(8)
  v_mfma_f32_16x16x32_bf16 v[88:91], v[112:115], v[40:43], v[88:91]
  v_mfma_f32_16x16x32_bf16 v[92:95], v[116:119], v[40:43], v[92:95]
  v_add_u32 v169, 1024, v169
  v_add_u32 v169, v169, v167
  v_mov_b32 v170, 65536
  v_cmp_ne_u32 vcc, v162, v170
  v_cmp_gt_u32 s[58:59], 12, v14
  ds_read_b64_tr_b16 v[32:33], v3 offset:36864
  ds_read_b64_tr_b16 v[34:35], v3 offset:38400
  s_waitcnt lgkmcnt(8)
  v_mfma_f32_16x16x32_bf16 v[96:99], v[112:115], v[44:47], v[96:99]
  v_mfma_f32_16x16x32_bf16 v[100:103], v[116:119], v[44:47], v[100:103]
  v_mov_b32 v170, 2146435072
  s_and_b64 vcc, vcc, s[58:59]
  v_cndmask_b32 v19, v170, v169, vcc
  v_lshrrev_b32 v169, 3, v167
  v_lshrrev_b32 v171, 21, v167
  ds_read_b64_tr_b16 v[36:37], v4 offset:36864
  ds_read_b64_tr_b16 v[38:39], v4 offset:38400
  s_waitcnt lgkmcnt(8)
  v_mfma_f32_16x16x32_bf16 v[104:107], v[112:115], v[48:51], v[104:107]
  v_mfma_f32_16x16x32_bf16 v[108:111], v[116:119], v[48:51], v[108:111]
  v_mov_b32 v172, 0x400000
  v_mov_b32 v173, 0x820000
  v_cmp_le_u32 vcc, 3, v171
  v_lshl_add_u32 v169, v15, 4, v169
  v_mov_b32 v171, 65536
  ds_read_b64_tr_b16 v[40:41], v5 offset:36864
  ds_read_b64_tr_b16 v[42:43], v5 offset:38400
  s_waitcnt lgkmcnt(8)
  v_mfma_f32_16x16x32_bf16 v[56:59], v[24:27], v[120:123], v[56:59]
  v_mfma_f32_16x16x32_bf16 v[60:63], v[24:27], v[124:127], v[60:63]
  v_cndmask_b32 v172, v172, v173, vcc
  v_add_u32 v169, v169, v172
  v_lshl_add_u32 v169, v168, 6, v169
  v_cmp_eq_u32 vcc, v162, v171
  v_cmp_eq_u32 s[56:57], 1, v168
  ds_read_b64_tr_b16 v[44:45], v6 offset:36864
  ds_read_b64_tr_b16 v[46:47], v6 offset:38400
  s_waitcnt lgkmcnt(8)
  v_mfma_f32_16x16x32_bf16 v[64:67], v[28:31], v[120:123], v[64:67]
  v_mfma_f32_16x16x32_bf16 v[68:71], v[28:31], v[124:127], v[68:71]
  s_nop 0
  s_and_b64 vcc, vcc, s[58:59]
  v_cndmask_b32 v18, v170, v169, vcc
  v_cndmask_b32 v52, 0, -1, s[56:57]
  v_mov_b32 v22, 0xb5c1a2a0
  ds_read_b64_tr_b16 v[48:49], v7 offset:36864
  ds_read_b64_tr_b16 v[50:51], v7 offset:38400
  s_waitcnt lgkmcnt(8)
  v_mfma_f32_16x16x32_bf16 v[72:75], v[120:123], v[32:35], v[72:75]
  v_mfma_f32_16x16x32_bf16 v[76:79], v[124:127], v[32:35], v[76:79]
  v_mov_b32 v23, 0xb5c1a2a0
  s_cmp_eq_u32 s14, 2
  s_cselect_b32 s32, s54, 0
  v_mov_b32 v208, s32
  v_mov_b32 v209, s32
  s_waitcnt lgkmcnt(0)
  s_barrier
  ds_read_b64_tr_b16 v[24:25], v1 offset:49152
  ds_read_b64_tr_b16 v[26:27], v1 offset:50688
  ds_read_b128 v[112:115], v12 offset:0
  ds_read_b128 v[116:119], v12 offset:2048
  v_mfma_f32_16x16x32_bf16 v[80:83], v[120:123], v[36:39], v[80:83]
  v_mfma_f32_16x16x32_bf16 v[84:87], v[124:127], v[36:39], v[84:87]
  v_mov_b32 v210, s32
  v_mov_b32 v211, s32
  s_cmp_eq_u32 s15, 2
  s_cselect_b32 s32, s54, 0
  v_mov_b32 v212, s32
  ds_read_b64_tr_b16 v[28:29], v2 offset:49152
  ds_read_b64_tr_b16 v[30:31], v2 offset:50688
  v_mfma_f32_16x16x32_bf16 v[88:91], v[120:123], v[40:43], v[88:91]
  v_mfma_f32_16x16x32_bf16 v[92:95], v[124:127], v[40:43], v[92:95]
  v_mov_b32 v213, s32
  v_mov_b32 v214, s32
  v_mov_b32 v215, s32
  s_cmp_eq_u32 s55, 2
  s_cselect_b32 s32, s54, 0
  ds_read_b64_tr_b16 v[32:33], v3 offset:49152
  ds_read_b64_tr_b16 v[34:35], v3 offset:50688
  v_mfma_f32_16x16x32_bf16 v[96:99], v[120:123], v[44:47], v[96:99]
  v_mfma_f32_16x16x32_bf16 v[100:103], v[124:127], v[44:47], v[100:103]
  v_mov_b32 v216, s32
  v_mov_b32 v217, s32
  v_mov_b32 v218, s32
  v_mov_b32 v219, s32
  v_lshrrev_b32 v192, 2, v14
  ds_read_b64_tr_b16 v[36:37], v4 offset:49152
  ds_read_b64_tr_b16 v[38:39], v4 offset:50688
  v_mfma_f32_16x16x32_bf16 v[104:107], v[120:123], v[48:51], v[104:107]
  v_mfma_f32_16x16x32_bf16 v[108:111], v[124:127], v[48:51], v[108:111]
  v_cmp_eq_u32 vcc, 1, v192
  v_cmp_le_u32 s[58:59], 2, v192
  s_nop 0
  v_mov_b32 v193, s14
  v_mov_b32 v194, s15
  ds_read_b128 v[120:123], v13 offset:0
  ds_read_b128 v[124:127], v13 offset:2048
  ds_read_b64_tr_b16 v[40:41], v5 offset:49152
  ds_read_b64_tr_b16 v[42:43], v5 offset:50688
  s_waitcnt lgkmcnt(10)
  v_mfma_f32_16x16x32_bf16 v[56:59], v[24:27], v[112:115], v[56:59]
  v_mfma_f32_16x16x32_bf16 v[60:63], v[24:27], v[116:119], v[60:63]
  v_cndmask_b32 v193, v193, v194, vcc
  v_mov_b32 v194, s55
  v_cndmask_b32 v193, v193, v194, s[58:59]
  v_cmp_eq_u32 vcc, 2, v193
  v_mov_b32 v194, s54
  ds_read_b64_tr_b16 v[44:45], v6 offset:49152
  ds_read_b64_tr_b16 v[46:47], v6 offset:50688
  s_waitcnt lgkmcnt(10)
  v_mfma_f32_16x16x32_bf16 v[64:67], v[28:31], v[112:115], v[64:67]
  v_mfma_f32_16x16x32_bf16 v[68:71], v[28:31], v[116:119], v[68:71]
  s_nop 0
  v_cndmask_b32 v220, 0, v194, vcc
  v_mov_b32 v221, v220
  v_mov_b32 v222, v220
  v_mov_b32 v223, v220
  ds_read_b64_tr_b16 v[48:49], v7 offset:49152
  ds_read_b64_tr_b16 v[50:51], v7 offset:50688
  s_waitcnt lgkmcnt(10)
  v_mfma_f32_16x16x32_bf16 v[72:75], v[112:115], v[32:35], v[72:75]
  v_mfma_f32_16x16x32_bf16 v[76:79], v[116:119], v[32:35], v[76:79]
  ds_read_b64_tr_b16 v[24:25], v1 offset:61440
  ds_read_b64_tr_b16 v[26:27], v1 offset:62976
  s_waitcnt lgkmcnt(10)
  v_mfma_f32_16x16x32_bf16 v[80:83], v[112:115], v[36:39], v[80:83]
  v_mfma_f32_16x16x32_bf16 v[84:87], v[116:119], v[36:39], v[84:87]
  ds_read_b64_tr_b16 v[28:29], v2 offset:61440
  ds_read_b64_tr_b16 v[30:31], v2 offset:62976
  s_waitcnt lgkmcnt(8)
  v_mfma_f32_16x16x32_bf16 v[88:91], v[112:115], v[40:43], v[88:91]
  v_mfma_f32_16x16x32_bf16 v[92:95], v[116:119], v[40:43], v[92:95]
  ds_read_b64_tr_b16 v[32:33], v3 offset:61440
  ds_read_b64_tr_b16 v[34:35], v3 offset:62976
  s_waitcnt lgkmcnt(8)
  v_mfma_f32_16x16x32_bf16 v[96:99], v[112:115], v[44:47], v[96:99]
  v_mfma_f32_16x16x32_bf16 v[100:103], v[116:119], v[44:47], v[100:103]
  ds_read_b64_tr_b16 v[36:37], v4 offset:61440
  ds_read_b64_tr_b16 v[38:39], v4 offset:62976
  s_waitcnt lgkmcnt(8)
  v_mfma_f32_16x16x32_bf16 v[104:107], v[112:115], v[48:51], v[104:107]
  v_mfma_f32_16x16x32_bf16 v[108:111], v[116:119], v[48:51], v[108:111]
  ds_read_b64_tr_b16 v[40:41], v5 offset:61440
  ds_read_b64_tr_b16 v[42:43], v5 offset:62976
  s_waitcnt lgkmcnt(8)
  v_mfma_f32_16x16x32_bf16 v[56:59], v[24:27], v[120:123], v[56:59]
  v_mfma_f32_16x16x32_bf16 v[60:63], v[24:27], v[124:127], v[60:63]
  ds_read_b64_tr_b16 v[44:45], v6 offset:61440
  ds_read_b64_tr_b16 v[46:47], v6 offset:62976
  s_waitcnt lgkmcnt(8)
  v_mfma_f32_16x16x32_bf16 v[64:67], v[28:31], v[120:123], v[64:67]
  v_mfma_f32_16x16x32_bf16 v[68:71], v[28:31], v[124:127], v[68:71]
  ds_read_b64_tr_b16 v[48:49], v7 offset:61440
  ds_read_b64_tr_b16 v[50:51], v7 offset:62976
  s_waitcnt lgkmcnt(8)
  v_mfma_f32_16x16x32_bf16 v[72:75], v[120:123], v[32:35], v[72:75]
  v_mfma_f32_16x16x32_bf16 v[76:79], v[124:127], v[32:35], v[76:79]
  s_waitcnt lgkmcnt(0)
  s_barrier
  s_cmp_eq_u32 s20, 1
  s_cbranch_scc1 qkv_nopfm1
  s_mov_b32 s64, s26
  s_and_b32 s65, s27, 0xffff
  s_mov_b32 s66, 1990656
  s_mov_b32 s67, 0x00020000
  buffer_load_dword v204, v203, s[64:67], s34 offen
  s_mov_b32 s68, s24
  s_and_b32 s69, s25, 0xffff
  s_mov_b32 s70, 2359296
  s_mov_b32 s71, 0x00020000
  buffer_load_dword v205, v202, s[68:71], s35 offen
qkv_nopfm1:
  ds_read_b64_tr_b16 v[24:25], v1 offset:0
  ds_read_b64_tr_b16 v[26:27], v1 offset:1536
  ds_read_b128 v[112:115], v8 offset:0
  ds_read_b128 v[116:119], v8 offset:2048
  v_mfma_f32_16x16x32_bf16 v[80:83], v[120:123], v[36:39], v[80:83]
  v_mfma_f32_16x16x32_bf16 v[84:87], v[124:127], v[36:39], v[84:87]
  ds_read_b64_tr_b16 v[28:29], v2 offset:0
  ds_read_b64_tr_b16 v[30:31], v2 offset:1536
  v_mfma_f32_16x16x32_bf16 v[88:91], v[120:123], v[40:43], v[88:91]
  v_mfma_f32_16x16x32_bf16 v[92:95], v[124:127], v[40:43], v[92:95]
  ds_read_b64_tr_b16 v[32:33], v3 offset:0
  ds_read_b64_tr_b16 v[34:35], v3 offset:1536
  v_mfma_f32_16x16x32_bf16 v[96:99], v[120:123], v[44:47], v[96:99]
  v_mfma_f32_16x16x32_bf16 v[100:103], v[124:127], v[44:47], v[100:103]
  ds_read_b64_tr_b16 v[36:37], v4 offset:0
  ds_read_b64_tr_b16 v[38:39], v4 offset:1536
  v_mfma_f32_16x16x32_bf16 v[104:107], v[120:123], v[48:51], v[104:107]
  v_mfma_f32_16x16x32_bf16 v[108:111], v[124:127], v[48:51], v[108:111]
  ds_read_b128 v[120:123], v9 offset:0
  ds_read_b128 v[124:127], v9 offset:2048
  ds_read_b64_tr_b16 v[40:41], v5 offset:0
  ds_read_b64_tr_b16 v[42:43], v5 offset:1536
  s_waitcnt lgkmcnt(10)
  v_mfma_f32_16x16x32_bf16 v[56:59], v[24:27], v[112:115], v[56:59]
  v_mfma_f32_16x16x32_bf16 v[60:63], v[24:27], v[116:119], v[60:63]
  ds_read_b64_tr_b16 v[44:45], v6 offset:0
  ds_read_b64_tr_b16 v[46:47], v6 offset:1536
  s_waitcnt lgkmcnt(10)
  v_mfma_f32_16x16x32_bf16 v[64:67], v[28:31], v[112:115], v[64:67]
  v_mfma_f32_16x16x32_bf16 v[68:71], v[28:31], v[116:119], v[68:71]
  ds_read_b64_tr_b16 v[48:49], v7 offset:0
  ds_read_b64_tr_b16 v[50:51], v7 offset:1536
  s_waitcnt lgkmcnt(10)
  v_mfma_f32_16x16x32_bf16 v[72:75], v[112:115], v[32:35], v[72:75]
  v_mfma_f32_16x16x32_bf16 v[76:79], v[116:119], v[32:35], v[76:79]
  ds_read_b64_tr_b16 v[24:25], v1 offset:12288
  ds_read_b64_tr_b16 v[26:27], v1 offset:13824
  s_waitcnt lgkmcnt(10)
  v_mfma_f32_16x16x32_bf16 v[80:83], v[112:115], v[36:39], v[80:83]
  v_mfma_f32_16x16x32_bf16 v[84:87], v[116:119], v[36:39], v[84:87]
  ds_read_b64_tr_b16 v[28:29], v2 offset:12288
  ds_read_b64_tr_b16 v[30:31], v2 offset:13824
  s_waitcnt lgkmcnt(8)
  v_mfma_f32_16x16x32_bf16 v[88:91], v[112:115], v[40:43], v[88:91]
  v_mfma_f32_16x16x32_bf16 v[92:95], v[116:119], v[40:43], v[92:95]
  ds_read_b64_tr_b16 v[32:33], v3 offset:12288
  ds_read_b64_tr_b16 v[34:35], v3 offset:13824
  s_waitcnt lgkmcnt(8)
  v_mfma_f32_16x16x32_bf16 v[96:99], v[112:115], v[44:47], v[96:99]
  v_mfma_f32_16x16x32_bf16 v[100:103], v[116:119], v[44:47], v[100:103]
  ds_read_b64_tr_b16 v[36:37], v4 offset:12288
  ds_read_b64_tr_b16 v[38:39], v4 offset:13824
  s_waitcnt lgkmcnt(8)
  v_mfma_f32_16x16x32_bf16 v[104:107], v[112:115], v[48:51], v[104:107]
  v_mfma_f32_16x16x32_bf16 v[108:111], v[116:119], v[48:51], v[108:111]
  ds_read_b64_tr_b16 v[40:41], v5 offset:12288
  ds_read_b64_tr_b16 v[42:43], v5 offset:13824
  s_waitcnt lgkmcnt(8)
  v_mfma_f32_16x16x32_bf16 v[56:59], v[24:27], v[120:123], v[56:59]
  v_mfma_f32_16x16x32_bf16 v[60:63], v[24:27], v[124:127], v[60:63]
  ds_read_b64_tr_b16 v[44:45], v6 offset:12288
  ds_read_b64_tr_b16 v[46:47], v6 offset:13824
  s_waitcnt lgkmcnt(8)
  v_mfma_f32_16x16x32_bf16 v[64:67], v[28:31], v[120:123], v[64:67]
  v_mfma_f32_16x16x32_bf16 v[68:71], v[28:31], v[124:127], v[68:71]
  ds_read_b64_tr_b16 v[48:49], v7 offset:12288
  ds_read_b64_tr_b16 v[50:51], v7 offset:13824
  s_waitcnt lgkmcnt(8)
  v_mfma_f32_16x16x32_bf16 v[72:75], v[120:123], v[32:35], v[72:75]
  v_mfma_f32_16x16x32_bf16 v[76:79], v[124:127], v[32:35], v[76:79]
  s_waitcnt vmcnt(0) lgkmcnt(0)
  s_barrier
  s_cmp_eq_u32 s20, 0
  s_cbranch_scc1 qkv_pa1
  s_cmp_lg_u32 s23, 0
  s_cbranch_scc1 qkv_pa1
  v_readfirstlane_b32 s100, v55
  s_mov_b32 s31, 131072
  s_nop 2
qkv_ns1:
  s_cmp_lg_u32 s100, 0
  s_cbranch_scc1 qkv_nk1
  s_sub_u32 s31, s31, 1
  s_cmp_eq_u32 s31, 0
  s_cbranch_scc1 qkv_nk1
  global_load_dword v55, v54, s[60:61] sc1
  s_waitcnt vmcnt(0)
  v_readfirstlane_b32 s100, v55
  s_nop 3
  s_branch qkv_ns1
qkv_nk1:
  v_mov_b32 v53, 151552
  v_mov_b32 v55, s100
  ds_write_b32 v53, v55
  s_lshl_b32 s30, s22, 7
  s_lshl_b32 s31, s21, 2
  s_add_u32 s30, s30, s31
  s_add_u32 s30, s30, 19922944
  v_mul_u32_u24 v200, 2048, v0
  v_add_u32 v200, s30, v200
  v_mov_b32 v201, s100
  s_mov_b64 exec, 255
  global_store_dword v200, v201, s[28:29] sc1
  s_mov_b64 exec, -1
  s_waitcnt lgkmcnt(0)
qkv_pa1:
  ds_read_b64_tr_b16 v[24:25], v1 offset:24576
  ds_read_b64_tr_b16 v[26:27], v1 offset:26112
  ds_read_b128 v[112:115], v10 offset:0
  ds_read_b128 v[116:119], v10 offset:2048
  v_mfma_f32_16x16x32_bf16 v[80:83], v[120:123], v[36:39], v[80:83]
  v_mfma_f32_16x16x32_bf16 v[84:87], v[124:127], v[36:39], v[84:87]
  ds_read_b64_tr_b16 v[28:29], v2 offset:24576
  ds_read_b64_tr_b16 v[30:31], v2 offset:26112
  v_mfma_f32_16x16x32_bf16 v[88:91], v[120:123], v[40:43], v[88:91]
  v_mfma_f32_16x16x32_bf16 v[92:95], v[124:127], v[40:43], v[92:95]
  ds_read_b64_tr_b16 v[32:33], v3 offset:24576
  ds_read_b64_tr_b16 v[34:35], v3 offset:26112
  v_mfma_f32_16x16x32_bf16 v[96:99], v[120:123], v[44:47], v[96:99]
  v_mfma_f32_16x16x32_bf16 v[100:103], v[124:127], v[44:47], v[100:103]
  ds_read_b64_tr_b16 v[36:37], v4 offset:24576
  ds_read_b64_tr_b16 v[38:39], v4 offset:26112
  v_mfma_f32_16x16x32_bf16 v[104:107], v[120:123], v[48:51], v[104:107]
  v_mfma_f32_16x16x32_bf16 v[108:111], v[124:127], v[48:51], v[108:111]
  ds_read_b128 v[120:123], v11 offset:0
  ds_read_b128 v[124:127], v11 offset:2048
  ds_read_b64_tr_b16 v[40:41], v5 offset:24576
  ds_read_b64_tr_b16 v[42:43], v5 offset:26112
  s_waitcnt lgkmcnt(10)
  v_mfma_f32_16x16x32_bf16 v[56:59], v[24:27], v[112:115], v[56:59]
  v_mfma_f32_16x16x32_bf16 v[60:63], v[24:27], v[116:119], v[60:63]
  ds_read_b64_tr_b16 v[44:45], v6 offset:24576
  ds_read_b64_tr_b16 v[46:47], v6 offset:26112
  s_waitcnt lgkmcnt(10)
  v_mfma_f32_16x16x32_bf16 v[64:67], v[28:31], v[112:115], v[64:67]
  v_mfma_f32_16x16x32_bf16 v[68:71], v[28:31], v[116:119], v[68:71]
  ds_read_b64_tr_b16 v[48:49], v7 offset:24576
  ds_read_b64_tr_b16 v[50:51], v7 offset:26112
  s_waitcnt lgkmcnt(10)
  v_mfma_f32_16x16x32_bf16 v[72:75], v[112:115], v[32:35], v[72:75]
  v_mfma_f32_16x16x32_bf16 v[76:79], v[116:119], v[32:35], v[76:79]
  ds_read_b64_tr_b16 v[24:25], v1 offset:36864
  ds_read_b64_tr_b16 v[26:27], v1 offset:38400
  s_waitcnt lgkmcnt(10)
  v_mfma_f32_16x16x32_bf16 v[80:83], v[112:115], v[36:39], v[80:83]
  v_mfma_f32_16x16x32_bf16 v[84:87], v[116:119], v[36:39], v[84:87]
  ds_read_b64_tr_b16 v[28:29], v2 offset:36864
  ds_read_b64_tr_b16 v[30:31], v2 offset:38400
  s_waitcnt lgkmcnt(8)
  v_mfma_f32_16x16x32_bf16 v[88:91], v[112:115], v[40:43], v[88:91]
  v_mfma_f32_16x16x32_bf16 v[92:95], v[116:119], v[40:43], v[92:95]
  ds_read_b64_tr_b16 v[32:33], v3 offset:36864
  ds_read_b64_tr_b16 v[34:35], v3 offset:38400
  s_waitcnt lgkmcnt(8)
  v_mfma_f32_16x16x32_bf16 v[96:99], v[112:115], v[44:47], v[96:99]
  v_mfma_f32_16x16x32_bf16 v[100:103], v[116:119], v[44:47], v[100:103]
  ds_read_b64_tr_b16 v[36:37], v4 offset:36864
  ds_read_b64_tr_b16 v[38:39], v4 offset:38400
  s_waitcnt lgkmcnt(8)
  v_mfma_f32_16x16x32_bf16 v[104:107], v[112:115], v[48:51], v[104:107]
  v_mfma_f32_16x16x32_bf16 v[108:111], v[116:119], v[48:51], v[108:111]
  ds_read_b64_tr_b16 v[40:41], v5 offset:36864
  ds_read_b64_tr_b16 v[42:43], v5 offset:38400
  s_waitcnt lgkmcnt(8)
  v_mfma_f32_16x16x32_bf16 v[56:59], v[24:27], v[120:123], v[56:59]
  v_mfma_f32_16x16x32_bf16 v[60:63], v[24:27], v[124:127], v[60:63]
  ds_read_b64_tr_b16 v[44:45], v6 offset:36864
  ds_read_b64_tr_b16 v[46:47], v6 offset:38400
  s_waitcnt lgkmcnt(8)
  v_mfma_f32_16x16x32_bf16 v[64:67], v[28:31], v[120:123], v[64:67]
  v_mfma_f32_16x16x32_bf16 v[68:71], v[28:31], v[124:127], v[68:71]
  ds_read_b64_tr_b16 v[48:49], v7 offset:36864
  ds_read_b64_tr_b16 v[50:51], v7 offset:38400
  s_waitcnt lgkmcnt(8)
  v_mfma_f32_16x16x32_bf16 v[72:75], v[120:123], v[32:35], v[72:75]
  v_mfma_f32_16x16x32_bf16 v[76:79], v[124:127], v[32:35], v[76:79]
  s_waitcnt lgkmcnt(0)
  s_barrier
  ds_read_b64_tr_b16 v[24:25], v1 offset:49152
  ds_read_b64_tr_b16 v[26:27], v1 offset:50688
  ds_read_b128 v[112:115], v12 offset:0
  ds_read_b128 v[116:119], v12 offset:2048
  v_mfma_f32_16x16x32_bf16 v[80:83], v[120:123], v[36:39], v[80:83]
  v_mfma_f32_16x16x32_bf16 v[84:87], v[124:127], v[36:39], v[84:87]
  ds_read_b64_tr_b16 v[28:29], v2 offset:49152
  ds_read_b64_tr_b16 v[30:31], v2 offset:50688
  v_mfma_f32_16x16x32_bf16 v[88:91], v[120:123], v[40:43], v[88:91]
  v_mfma_f32_16x16x32_bf16 v[92:95], v[124:127], v[40:43], v[92:95]
  ds_read_b64_tr_b16 v[32:33], v3 offset:49152
  ds_read_b64_tr_b16 v[34:35], v3 offset:50688
  v_mfma_f32_16x16x32_bf16 v[96:99], v[120:123], v[44:47], v[96:99]
  v_mfma_f32_16x16x32_bf16 v[100:103], v[124:127], v[44:47], v[100:103]
  ds_read_b64_tr_b16 v[36:37], v4 offset:49152
  ds_read_b64_tr_b16 v[38:39], v4 offset:50688
  v_mfma_f32_16x16x32_bf16 v[104:107], v[120:123], v[48:51], v[104:107]
  v_mfma_f32_16x16x32_bf16 v[108:111], v[124:127], v[48:51], v[108:111]
  ds_read_b128 v[120:123], v13 offset:0
  ds_read_b128 v[124:127], v13 offset:2048
  ds_read_b64_tr_b16 v[40:41], v5 offset:49152
  ds_read_b64_tr_b16 v[42:43], v5 offset:50688
  s_waitcnt lgkmcnt(10)
  v_mfma_f32_16x16x32_bf16 v[56:59], v[24:27], v[112:115], v[56:59]
  v_mfma_f32_16x16x32_bf16 v[60:63], v[24:27], v[116:119], v[60:63]
  ds_read_b64_tr_b16 v[44:45], v6 offset:49152
  ds_read_b64_tr_b16 v[46:47], v6 offset:50688
  s_waitcnt lgkmcnt(10)
  v_mfma_f32_16x16x32_bf16 v[64:67], v[28:31], v[112:115], v[64:67]
  v_mfma_f32_16x16x32_bf16 v[68:71], v[28:31], v[116:119], v[68:71]
  ds_read_b64_tr_b16 v[48:49], v7 offset:49152
  ds_read_b64_tr_b16 v[50:51], v7 offset:50688
  s_waitcnt lgkmcnt(10)
  v_mfma_f32_16x16x32_bf16 v[72:75], v[112:115], v[32:35], v[72:75]
  v_mfma_f32_16x16x32_bf16 v[76:79], v[116:119], v[32:35], v[76:79]
  ds_read_b64_tr_b16 v[24:25], v1 offset:61440
  ds_read_b64_tr_b16 v[26:27], v1 offset:62976
  s_waitcnt lgkmcnt(10)
  v_mfma_f32_16x16x32_bf16 v[80:83], v[112:115], v[36:39], v[80:83]
  v_mfma_f32_16x16x32_bf16 v[84:87], v[116:119], v[36:39], v[84:87]
  ds_read_b64_tr_b16 v[28:29], v2 offset:61440
  ds_read_b64_tr_b16 v[30:31], v2 offset:62976
  s_waitcnt lgkmcnt(8)
  v_mfma_f32_16x16x32_bf16 v[88:91], v[112:115], v[40:43], v[88:91]
  v_mfma_f32_16x16x32_bf16 v[92:95], v[116:119], v[40:43], v[92:95]
  ds_read_b64_tr_b16 v[32:33], v3 offset:61440
  ds_read_b64_tr_b16 v[34:35], v3 offset:62976
  s_waitcnt lgkmcnt(8)
  v_mfma_f32_16x16x32_bf16 v[96:99], v[112:115], v[44:47], v[96:99]
  v_mfma_f32_16x16x32_bf16 v[100:103], v[116:119], v[44:47], v[100:103]
  ds_read_b64_tr_b16 v[36:37], v4 offset:61440
  ds_read_b64_tr_b16 v[38:39], v4 offset:62976
  s_waitcnt lgkmcnt(8)
  v_mfma_f32_16x16x32_bf16 v[104:107], v[112:115], v[48:51], v[104:107]
  v_mfma_f32_16x16x32_bf16 v[108:111], v[116:119], v[48:51], v[108:111]
  ds_read_b64_tr_b16 v[40:41], v5 offset:61440
  ds_read_b64_tr_b16 v[42:43], v5 offset:62976
  s_waitcnt lgkmcnt(8)
  v_mfma_f32_16x16x32_bf16 v[56:59], v[24:27], v[120:123], v[56:59]
  v_mfma_f32_16x16x32_bf16 v[60:63], v[24:27], v[124:127], v[60:63]
  ds_read_b64_tr_b16 v[44:45], v6 offset:61440
  ds_read_b64_tr_b16 v[46:47], v6 offset:62976
  s_waitcnt lgkmcnt(8)
  v_mfma_f32_16x16x32_bf16 v[64:67], v[28:31], v[120:123], v[64:67]
  v_mfma_f32_16x16x32_bf16 v[68:71], v[28:31], v[124:127], v[68:71]
  ds_read_b64_tr_b16 v[48:49], v7 offset:61440
  ds_read_b64_tr_b16 v[50:51], v7 offset:62976
  s_waitcnt lgkmcnt(8)
  v_mfma_f32_16x16x32_bf16 v[72:75], v[120:123], v[32:35], v[72:75]
  v_mfma_f32_16x16x32_bf16 v[76:79], v[124:127], v[32:35], v[76:79]
  s_waitcnt lgkmcnt(0)
  s_barrier
  ds_read_b64_tr_b16 v[24:25], v1 offset:0
  ds_read_b64_tr_b16 v[26:27], v1 offset:1536
  ds_read_b128 v[112:115], v8 offset:0
  ds_read_b128 v[116:119], v8 offset:2048
  v_mfma_f32_16x16x32_bf16 v[80:83], v[120:123], v[36:39], v[80:83]
  v_mfma_f32_16x16x32_bf16 v[84:87], v[124:127], v[36:39], v[84:87]
  ds_read_b64_tr_b16 v[28:29], v2 offset:0
  ds_read_b64_tr_b16 v[30:31], v2 offset:1536
  v_mfma_f32_16x16x32_bf16 v[88:91], v[120:123], v[40:43], v[88:91]
  v_mfma_f32_16x16x32_bf16 v[92:95], v[124:127], v[40:43], v[92:95]
  ds_read_b64_tr_b16 v[32:33], v3 offset:0
  ds_read_b64_tr_b16 v[34:35], v3 offset:1536
  v_mfma_f32_16x16x32_bf16 v[96:99], v[120:123], v[44:47], v[96:99]
  v_mfma_f32_16x16x32_bf16 v[100:103], v[124:127], v[44:47], v[100:103]
  ds_read_b64_tr_b16 v[36:37], v4 offset:0
  ds_read_b64_tr_b16 v[38:39], v4 offset:1536
  v_mfma_f32_16x16x32_bf16 v[104:107], v[120:123], v[48:51], v[104:107]
  v_mfma_f32_16x16x32_bf16 v[108:111], v[124:127], v[48:51], v[108:111]
  ds_read_b128 v[120:123], v9 offset:0
  ds_read_b128 v[124:127], v9 offset:2048
  ds_read_b64_tr_b16 v[40:41], v5 offset:0
  ds_read_b64_tr_b16 v[42:43], v5 offset:1536
  s_waitcnt lgkmcnt(10)
  v_mfma_f32_16x16x32_bf16 v[56:59], v[24:27], v[112:115], v[56:59]
  v_mfma_f32_16x16x32_bf16 v[60:63], v[24:27], v[116:119], v[60:63]
  ds_read_b64_tr_b16 v[44:45], v6 offset:0
  ds_read_b64_tr_b16 v[46:47], v6 offset:1536
  s_waitcnt lgkmcnt(10)
  v_mfma_f32_16x16x32_bf16 v[64:67], v[28:31], v[112:115], v[64:67]
  v_mfma_f32_16x16x32_bf16 v[68:71], v[28:31], v[116:119], v[68:71]
  ds_read_b64_tr_b16 v[48:49], v7 offset:0
  ds_read_b64_tr_b16 v[50:51], v7 offset:1536
  s_waitcnt lgkmcnt(10)
  v_mfma_f32_16x16x32_bf16 v[72:75], v[112:115], v[32:35], v[72:75]
  v_mfma_f32_16x16x32_bf16 v[76:79], v[116:119], v[32:35], v[76:79]
  ds_read_b64_tr_b16 v[24:25], v1 offset:12288
  ds_read_b64_tr_b16 v[26:27], v1 offset:13824
  s_waitcnt lgkmcnt(10)
  v_mfma_f32_16x16x32_bf16 v[80:83], v[112:115], v[36:39], v[80:83]
  v_mfma_f32_16x16x32_bf16 v[84:87], v[116:119], v[36:39], v[84:87]
  ds_read_b64_tr_b16 v[28:29], v2 offset:12288
  ds_read_b64_tr_b16 v[30:31], v2 offset:13824
  s_waitcnt lgkmcnt(8)
  v_mfma_f32_16x16x32_bf16 v[88:91], v[112:115], v[40:43], v[88:91]
  v_mfma_f32_16x16x32_bf16 v[92:95], v[116:119], v[40:43], v[92:95]
  ds_read_b64_tr_b16 v[32:33], v3 offset:12288
  ds_read_b64_tr_b16 v[34:35], v3 offset:13824
  s_waitcnt lgkmcnt(8)
  v_mfma_f32_16x16x32_bf16 v[96:99], v[112:115], v[44:47], v[96:99]
  v_mfma_f32_16x16x32_bf16 v[100:103], v[116:119], v[44:47], v[100:103]
  ds_read_b64_tr_b16 v[36:37], v4 offset:12288
  ds_read_b64_tr_b16 v[38:39], v4 offset:13824
  s_waitcnt lgkmcnt(8)
  v_mfma_f32_16x16x32_bf16 v[104:107], v[112:115], v[48:51], v[104:107]
  v_mfma_f32_16x16x32_bf16 v[108:111], v[116:119], v[48:51], v[108:111]
  ds_read_b64_tr_b16 v[40:41], v5 offset:12288
  ds_read_b64_tr_b16 v[42:43], v5 offset:13824
  s_waitcnt lgkmcnt(8)
  v_mfma_f32_16x16x32_bf16 v[56:59], v[24:27], v[120:123], v[56:59]
  v_mfma_f32_16x16x32_bf16 v[60:63], v[24:27], v[124:127], v[60:63]
  ds_read_b64_tr_b16 v[44:45], v6 offset:12288
  ds_read_b64_tr_b16 v[46:47], v6 offset:13824
  s_waitcnt lgkmcnt(8)
  v_mfma_f32_16x16x32_bf16 v[64:67], v[28:31], v[120:123], v[64:67]
  v_mfma_f32_16x16x32_bf16 v[68:71], v[28:31], v[124:127], v[68:71]
  ds_read_b64_tr_b16 v[48:49], v7 offset:12288
  ds_read_b64_tr_b16 v[50:51], v7 offset:13824
  s_waitcnt lgkmcnt(8)
  v_mfma_f32_16x16x32_bf16 v[72:75], v[120:123], v[32:35], v[72:75]
  v_mfma_f32_16x16x32_bf16 v[76:79], v[124:127], v[32:35], v[76:79]
  s_waitcnt lgkmcnt(0)
  s_barrier
  ds_read_b64_tr_b16 v[24:25], v1 offset:24576
  ds_read_b64_tr_b16 v[26:27], v1 offset:26112
  ds_read_b128 v[112:115], v10 offset:0
  ds_read_b128 v[116:119], v10 offset:2048
  v_mfma_f32_16x16x32_bf16 v[80:83], v[120:123], v[36:39], v[80:83]
  v_mfma_f32_16x16x32_bf16 v[84:87], v[124:127], v[36:39], v[84:87]
  ds_read_b64_tr_b16 v[28:29], v2 offset:24576
  ds_read_b64_tr_b16 v[30:31], v2 offset:26112
  v_mfma_f32_16x16x32_bf16 v[88:91], v[120:123], v[40:43], v[88:91]
  v_mfma_f32_16x16x32_bf16 v[92:95], v[124:127], v[40:43], v[92:95]
  ds_read_b64_tr_b16 v[32:33], v3 offset:24576
  ds_read_b64_tr_b16 v[34:35], v3 offset:26112
  v_mfma_f32_16x16x32_bf16 v[96:99], v[120:123], v[44:47], v[96:99]
  v_mfma_f32_16x16x32_bf16 v[100:103], v[124:127], v[44:47], v[100:103]
  ds_read_b64_tr_b16 v[36:37], v4 offset:24576
  ds_read_b64_tr_b16 v[38:39], v4 offset:26112
  v_mfma_f32_16x16x32_bf16 v[104:107], v[120:123], v[48:51], v[104:107]
  v_mfma_f32_16x16x32_bf16 v[108:111], v[124:127], v[48:51], v[108:111]
  ds_read_b128 v[120:123], v11 offset:0
  ds_read_b128 v[124:127], v11 offset:2048
  ds_read_b64_tr_b16 v[40:41], v5 offset:24576
  ds_read_b64_tr_b16 v[42:43], v5 offset:26112
  s_waitcnt lgkmcnt(10)
  v_mfma_f32_16x16x32_bf16 v[56:59], v[24:27], v[112:115], v[56:59]
  v_mfma_f32_16x16x32_bf16 v[60:63], v[24:27], v[116:119], v[60:63]
  ds_read_b64_tr_b16 v[44:45], v6 offset:24576
  ds_read_b64_tr_b16 v[46:47], v6 offset:26112
  s_waitcnt lgkmcnt(10)
  v_mfma_f32_16x16x32_bf16 v[64:67], v[28:31], v[112:115], v[64:67]
  v_mfma_f32_16x16x32_bf16 v[68:71], v[28:31], v[116:119], v[68:71]
  ds_read_b64_tr_b16 v[48:49], v7 offset:24576
  ds_read_b64_tr_b16 v[50:51], v7 offset:26112
  s_waitcnt lgkmcnt(10)
  v_mfma_f32_16x16x32_bf16 v[72:75], v[112:115], v[32:35], v[72:75]
  v_mfma_f32_16x16x32_bf16 v[76:79], v[116:119], v[32:35], v[76:79]
  ds_read_b64_tr_b16 v[24:25], v1 offset:36864
  ds_read_b64_tr_b16 v[26:27], v1 offset:38400
  s_waitcnt lgkmcnt(10)
  v_mfma_f32_16x16x32_bf16 v[80:83], v[112:115], v[36:39], v[80:83]
  v_mfma_f32_16x16x32_bf16 v[84:87], v[116:119], v[36:39], v[84:87]
  ds_read_b64_tr_b16 v[28:29], v2 offset:36864
  ds_read_b64_tr_b16 v[30:31], v2 offset:38400
  s_waitcnt lgkmcnt(8)
  v_mfma_f32_16x16x32_bf16 v[88:91], v[112:115], v[40:43], v[88:91]
  v_mfma_f32_16x16x32_bf16 v[92:95], v[116:119], v[40:43], v[92:95]
  ds_read_b64_tr_b16 v[32:33], v3 offset:36864
  ds_read_b64_tr_b16 v[34:35], v3 offset:38400
  s_waitcnt lgkmcnt(8)
  v_mfma_f32_16x16x32_bf16 v[96:99], v[112:115], v[44:47], v[96:99]
  v_mfma_f32_16x16x32_bf16 v[100:103], v[116:119], v[44:47], v[100:103]
  ds_read_b64_tr_b16 v[36:37], v4 offset:36864
  ds_read_b64_tr_b16 v[38:39], v4 offset:38400
  s_waitcnt lgkmcnt(8)
  v_mfma_f32_16x16x32_bf16 v[104:107], v[112:115], v[48:51], v[104:107]
  v_mfma_f32_16x16x32_bf16 v[108:111], v[116:119], v[48:51], v[108:111]
  ds_read_b64_tr_b16 v[40:41], v5 offset:36864
  ds_read_b64_tr_b16 v[42:43], v5 offset:38400
  s_waitcnt lgkmcnt(8)
  v_mfma_f32_16x16x32_bf16 v[56:59], v[24:27], v[120:123], v[56:59]
  v_mfma_f32_16x16x32_bf16 v[60:63], v[24:27], v[124:127], v[60:63]
  ds_read_b64_tr_b16 v[44:45], v6 offset:36864
  ds_read_b64_tr_b16 v[46:47], v6 offset:38400
  s_waitcnt lgkmcnt(8)
  v_mfma_f32_16x16x32_bf16 v[64:67], v[28:31], v[120:123], v[64:67]
  v_mfma_f32_16x16x32_bf16 v[68:71], v[28:31], v[124:127], v[68:71]
  ds_read_b64_tr_b16 v[48:49], v7 offset:36864
  ds_read_b64_tr_b16 v[50:51], v7 offset:38400
  s_waitcnt lgkmcnt(8)
  v_mfma_f32_16x16x32_bf16 v[72:75], v[120:123], v[32:35], v[72:75]
  v_mfma_f32_16x16x32_bf16 v[76:79], v[124:127], v[32:35], v[76:79]
  s_waitcnt lgkmcnt(0)
  s_barrier
  ds_read_b64_tr_b16 v[24:25], v1 offset:49152
  ds_read_b64_tr_b16 v[26:27], v1 offset:50688
  ds_read_b128 v[112:115], v12 offset:0
  ds_read_b128 v[116:119], v12 offset:2048
  v_mfma_f32_16x16x32_bf16 v[80:83], v[120:123], v[36:39], v[80:83]
  v_mfma_f32_16x16x32_bf16 v[84:87], v[124:127], v[36:39], v[84:87]
  ds_read_b64_tr_b16 v[28:29], v2 offset:49152
  ds_read_b64_tr_b16 v[30:31], v2 offset:50688
  v_mfma_f32_16x16x32_bf16 v[88:91], v[120:123], v[40:43], v[88:91]
  v_mfma_f32_16x16x32_bf16 v[92:95], v[124:127], v[40:43], v[92:95]
  ds_read_b64_tr_b16 v[32:33], v3 offset:49152
  ds_read_b64_tr_b16 v[34:35], v3 offset:50688
  v_mfma_f32_16x16x32_bf16 v[96:99], v[120:123], v[44:47], v[96:99]
  v_mfma_f32_16x16x32_bf16 v[100:103], v[124:127], v[44:47], v[100:103]
  ds_read_b64_tr_b16 v[36:37], v4 offset:49152
  ds_read_b64_tr_b16 v[38:39], v4 offset:50688
  v_mfma_f32_16x16x32_bf16 v[104:107], v[120:123], v[48:51], v[104:107]
  v_mfma_f32_16x16x32_bf16 v[108:111], v[124:127], v[48:51], v[108:111]
  ds_read_b128 v[120:123], v13 offset:0
  ds_read_b128 v[124:127], v13 offset:2048
  ds_read_b64_tr_b16 v[40:41], v5 offset:49152
  ds_read_b64_tr_b16 v[42:43], v5 offset:50688
  s_waitcnt lgkmcnt(10)
  v_mfma_f32_16x16x32_bf16 v[56:59], v[24:27], v[112:115], v[56:59]
  v_mfma_f32_16x16x32_bf16 v[60:63], v[24:27], v[116:119], v[60:63]
  ds_read_b64_tr_b16 v[44:45], v6 offset:49152
  ds_read_b64_tr_b16 v[46:47], v6 offset:50688
  s_waitcnt lgkmcnt(10)
  v_mfma_f32_16x16x32_bf16 v[64:67], v[28:31], v[112:115], v[64:67]
  v_mfma_f32_16x16x32_bf16 v[68:71], v[28:31], v[116:119], v[68:71]
  ds_read_b64_tr_b16 v[48:49], v7 offset:49152
  ds_read_b64_tr_b16 v[50:51], v7 offset:50688
  s_waitcnt lgkmcnt(10)
  v_mfma_f32_16x16x32_bf16 v[72:75], v[112:115], v[32:35], v[72:75]
  v_mfma_f32_16x16x32_bf16 v[76:79], v[116:119], v[32:35], v[76:79]
  ds_read_b64_tr_b16 v[24:25], v1 offset:61440
  ds_read_b64_tr_b16 v[26:27], v1 offset:62976
  s_waitcnt lgkmcnt(10)
  v_mfma_f32_16x16x32_bf16 v[80:83], v[112:115], v[36:39], v[80:83]
  v_mfma_f32_16x16x32_bf16 v[84:87], v[116:119], v[36:39], v[84:87]
  ds_read_b64_tr_b16 v[28:29], v2 offset:61440
  ds_read_b64_tr_b16 v[30:31], v2 offset:62976
  s_waitcnt lgkmcnt(8)
  v_mfma_f32_16x16x32_bf16 v[88:91], v[112:115], v[40:43], v[88:91]
  v_mfma_f32_16x16x32_bf16 v[92:95], v[116:119], v[40:43], v[92:95]
  ds_read_b64_tr_b16 v[32:33], v3 offset:61440
  ds_read_b64_tr_b16 v[34:35], v3 offset:62976
  s_waitcnt lgkmcnt(8)
  v_mfma_f32_16x16x32_bf16 v[96:99], v[112:115], v[44:47], v[96:99]
  v_mfma_f32_16x16x32_bf16 v[100:103], v[116:119], v[44:47], v[100:103]
  ds_read_b64_tr_b16 v[36:37], v4 offset:61440
  ds_read_b64_tr_b16 v[38:39], v4 offset:62976
  s_waitcnt lgkmcnt(8)
  v_mfma_f32_16x16x32_bf16 v[104:107], v[112:115], v[48:51], v[104:107]
  v_mfma_f32_16x16x32_bf16 v[108:111], v[116:119], v[48:51], v[108:111]
  ds_read_b64_tr_b16 v[40:41], v5 offset:61440
  ds_read_b64_tr_b16 v[42:43], v5 offset:62976
  s_waitcnt lgkmcnt(8)
  v_mfma_f32_16x16x32_bf16 v[56:59], v[24:27], v[120:123], v[56:59]
  v_mfma_f32_16x16x32_bf16 v[60:63], v[24:27], v[124:127], v[60:63]
  ds_read_b64_tr_b16 v[44:45], v6 offset:61440
  ds_read_b64_tr_b16 v[46:47], v6 offset:62976
  s_waitcnt lgkmcnt(8)
  v_mfma_f32_16x16x32_bf16 v[64:67], v[28:31], v[120:123], v[64:67]
  v_mfma_f32_16x16x32_bf16 v[68:71], v[28:31], v[124:127], v[68:71]
  ds_read_b64_tr_b16 v[48:49], v7 offset:61440
  ds_read_b64_tr_b16 v[50:51], v7 offset:62976
  s_waitcnt lgkmcnt(8)
  v_mfma_f32_16x16x32_bf16 v[72:75], v[120:123], v[32:35], v[72:75]
  v_mfma_f32_16x16x32_bf16 v[76:79], v[124:127], v[32:35], v[76:79]
  s_waitcnt lgkmcnt(0)
  v_mfma_f32_16x16x32_bf16 v[80:83], v[120:123], v[36:39], v[80:83]
  v_mfma_f32_16x16x32_bf16 v[84:87], v[124:127], v[36:39], v[84:87]
  v_mfma_f32_16x16x32_bf16 v[88:91], v[120:123], v[40:43], v[88:91]
  v_mfma_f32_16x16x32_bf16 v[92:95], v[124:127], v[40:43], v[92:95]
  v_mfma_f32_16x16x32_bf16 v[96:99], v[120:123], v[44:47], v[96:99]
  v_mfma_f32_16x16x32_bf16 v[100:103], v[124:127], v[44:47], v[100:103]
  v_mfma_f32_16x16x32_bf16 v[104:107], v[120:123], v[48:51], v[104:107]
  v_mfma_f32_16x16x32_bf16 v[108:111], v[124:127], v[48:51], v[108:111]
  s_nop 7
  s_cmp_eq_u32 s47, 1
  s_cbranch_scc0 qkv_ns1_0
  v_pk_mul_f32 v[56:57], v[56:57], s[50:51]
  v_pk_mul_f32 v[58:59], v[58:59], s[50:51]
  v_pk_mul_f32 v[60:61], v[60:61], s[50:51]
  v_pk_mul_f32 v[62:63], v[62:63], s[50:51]
  v_pk_mul_f32 v[64:65], v[64:65], s[50:51]
  v_pk_mul_f32 v[66:67], v[66:67], s[50:51]
  v_pk_mul_f32 v[68:69], v[68:69], s[50:51]
  v_pk_mul_f32 v[70:71], v[70:71], s[50:51]
qkv_ns1_0:
  s_cmp_eq_u32 s47, 2
  s_cbranch_scc0 qkv_np1_0
  v_pk_fma_f32 v[160:161], v[56:57], s[52:53], v[22:23]
  v_pk_fma_f32 v[162:163], v[58:59], s[52:53], v[22:23]
  v_pk_fma_f32 v[164:165], v[60:61], s[52:53], v[22:23]
  v_pk_fma_f32 v[166:167], v[62:63], s[52:53], v[22:23]
  v_pk_fma_f32 v[168:169], v[64:65], s[52:53], v[22:23]
  v_pk_fma_f32 v[170:171], v[66:67], s[52:53], v[22:23]
  v_pk_fma_f32 v[172:173], v[68:69], s[52:53], v[22:23]
  v_pk_fma_f32 v[174:175], v[70:71], s[52:53], v[22:23]
  v_exp_f32_e64 v160, v160 clamp
  v_max_f32 v56, s54, v56
  v_exp_f32_e64 v161, v161 clamp
  v_max_f32 v57, s54, v57
  v_exp_f32_e64 v162, v162 clamp
  v_max_f32 v58, s54, v58
  v_exp_f32_e64 v163, v163 clamp
  v_max_f32 v59, s54, v59
  v_exp_f32_e64 v164, v164 clamp
  v_max_f32 v60, s54, v60
  v_exp_f32_e64 v165, v165 clamp
  v_max_f32 v61, s54, v61
  v_exp_f32_e64 v166, v166 clamp
  v_max_f32 v62, s54, v62
  v_exp_f32_e64 v167, v167 clamp
  v_max_f32 v63, s54, v63
  v_exp_f32_e64 v168, v168 clamp
  v_max_f32 v64, s54, v64
  v_exp_f32_e64 v169, v169 clamp
  v_max_f32 v65, s54, v65
  v_exp_f32_e64 v170, v170 clamp
  v_max_f32 v66, s54, v66
  v_exp_f32_e64 v171, v171 clamp
  v_max_f32 v67, s54, v67
  v_exp_f32_e64 v172, v172 clamp
  v_max_f32 v68, s54, v68
  v_exp_f32_e64 v173, v173 clamp
  v_max_f32 v69, s54, v69
  v_exp_f32_e64 v174, v174 clamp
  v_max_f32 v70, s54, v70
  v_exp_f32_e64 v175, v175 clamp
  v_max_f32 v71, s54, v71
  v_pk_add_f32 v[56:57], v[56:57], v[160:161]
  v_pk_add_f32 v[58:59], v[58:59], v[162:163]
  v_pk_add_f32 v[60:61], v[60:61], v[164:165]
  v_pk_add_f32 v[62:63], v[62:63], v[166:167]
  v_pk_add_f32 v[64:65], v[64:65], v[168:169]
  v_pk_add_f32 v[66:67], v[66:67], v[170:171]
  v_pk_add_f32 v[68:69], v[68:69], v[172:173]
  v_pk_add_f32 v[70:71], v[70:71], v[174:175]
qkv_np1_0:
  v_cvt_pk_bf16_f32 v128, v56, v57
  v_cvt_pk_bf16_f32 v129, v58, v59
  v_cvt_pk_bf16_f32 v130, v60, v61
  v_cvt_pk_bf16_f32 v131, v62, v63
  s_nop 0
  v_permlane32_swap_b32 v128, v130
  v_permlane32_swap_b32 v129, v131
  buffer_store_dwordx4 v[128:131], v16, s[16:19], s41 offen sc1
  s_add_u32 s56, s41, s44
  v_cvt_pk_bf16_f32 v132, v64, v65
  v_cvt_pk_bf16_f32 v133, v66, v67
  v_cvt_pk_bf16_f32 v134, v68, v69
  v_cvt_pk_bf16_f32 v135, v70, v71
  s_nop 0
  v_permlane32_swap_b32 v132, v134
  v_permlane32_swap_b32 v133, v135
  buffer_store_dwordx4 v[132:135], v16, s[16:19], s56 offen sc1
  s_cmp_eq_u32 s48, 2
  s_cbranch_scc0 qkv_np1_1
  v_pk_fma_f32 v[160:161], v[72:73], s[52:53], v[22:23]
  v_pk_fma_f32 v[162:163], v[74:75], s[52:53], v[22:23]
  v_pk_fma_f32 v[164:165], v[76:77], s[52:53], v[22:23]
  v_pk_fma_f32 v[166:167], v[78:79], s[52:53], v[22:23]
  v_pk_fma_f32 v[168:169], v[80:81], s[52:53], v[22:23]
  v_pk_fma_f32 v[170:171], v[82:83], s[52:53], v[22:23]
  v_pk_fma_f32 v[172:173], v[84:85], s[52:53], v[22:23]
  v_pk_fma_f32 v[174:175], v[86:87], s[52:53], v[22:23]
  v_exp_f32_e64 v160, v160 clamp
  v_max_f32 v72, s54, v72
  v_exp_f32_e64 v161, v161 clamp
  v_max_f32 v73, s54, v73
  v_exp_f32_e64 v162, v162 clamp
  v_max_f32 v74, s54, v74
  v_exp_f32_e64 v163, v163 clamp
  v_max_f32 v75, s54, v75
  v_exp_f32_e64 v164, v164 clamp
  v_max_f32 v76, s54, v76
  v_exp_f32_e64 v165, v165 clamp
  v_max_f32 v77, s54, v77
  v_exp_f32_e64 v166, v166 clamp
  v_max_f32 v78, s54, v78
  v_exp_f32_e64 v167, v167 clamp
  v_max_f32 v79, s54, v79
  v_exp_f32_e64 v168, v168 clamp
  v_max_f32 v80, s54, v80
  v_exp_f32_e64 v169, v169 clamp
  v_max_f32 v81, s54, v81
  v_exp_f32_e64 v170, v170 clamp
  v_max_f32 v82, s54, v82
  v_exp_f32_e64 v171, v171 clamp
  v_max_f32 v83, s54, v83
  v_exp_f32_e64 v172, v172 clamp
  v_max_f32 v84, s54, v84
  v_exp_f32_e64 v173, v173 clamp
  v_max_f32 v85, s54, v85
  v_exp_f32_e64 v174, v174 clamp
  v_max_f32 v86, s54, v86
  v_exp_f32_e64 v175, v175 clamp
  v_max_f32 v87, s54, v87
  v_pk_add_f32 v[72:73], v[72:73], v[160:161]
  v_pk_add_f32 v[74:75], v[74:75], v[162:163]
  v_pk_add_f32 v[76:77], v[76:77], v[164:165]
  v_pk_add_f32 v[78:79], v[78:79], v[166:167]
  v_pk_add_f32 v[80:81], v[80:81], v[168:169]
  v_pk_add_f32 v[82:83], v[82:83], v[170:171]
  v_pk_add_f32 v[84:85], v[84:85], v[172:173]
  v_pk_add_f32 v[86:87], v[86:87], v[174:175]
qkv_np1_1:
  v_cvt_pk_bf16_f32 v136, v72, v73
  v_cvt_pk_bf16_f32 v137, v74, v75
  v_cvt_pk_bf16_f32 v138, v76, v77
  v_cvt_pk_bf16_f32 v139, v78, v79
  s_nop 0
  v_permlane32_swap_b32 v136, v138
  v_permlane32_swap_b32 v137, v139
  buffer_store_dwordx4 v[136:139], v17, s[16:19], s42 offen sc1
  s_add_u32 s56, s42, s45
  v_cvt_pk_bf16_f32 v140, v80, v81
  v_cvt_pk_bf16_f32 v141, v82, v83
  v_cvt_pk_bf16_f32 v142, v84, v85
  v_cvt_pk_bf16_f32 v143, v86, v87
  s_nop 0
  v_permlane32_swap_b32 v140, v142
  v_permlane32_swap_b32 v141, v143
  buffer_store_dwordx4 v[140:143], v17, s[16:19], s56 offen sc1
  s_cmp_eq_u32 s49, 2
  s_cbranch_scc0 qkv_np1_2
  v_pk_fma_f32 v[160:161], v[88:89], s[52:53], v[22:23]
  v_pk_fma_f32 v[162:163], v[90:91], s[52:53], v[22:23]
  v_pk_fma_f32 v[164:165], v[92:93], s[52:53], v[22:23]
  v_pk_fma_f32 v[166:167], v[94:95], s[52:53], v[22:23]
  v_pk_fma_f32 v[168:169], v[96:97], s[52:53], v[22:23]
  v_pk_fma_f32 v[170:171], v[98:99], s[52:53], v[22:23]
  v_pk_fma_f32 v[172:173], v[100:101], s[52:53], v[22:23]
  v_pk_fma_f32 v[174:175], v[102:103], s[52:53], v[22:23]
  v_exp_f32_e64 v160, v160 clamp
  v_max_f32 v88, s54, v88
  v_exp_f32_e64 v161, v161 clamp
  v_max_f32 v89, s54, v89
  v_exp_f32_e64 v162, v162 clamp
  v_max_f32 v90, s54, v90
  v_exp_f32_e64 v163, v163 clamp
  v_max_f32 v91, s54, v91
  v_exp_f32_e64 v164, v164 clamp
  v_max_f32 v92, s54, v92
  v_exp_f32_e64 v165, v165 clamp
  v_max_f32 v93, s54, v93
  v_exp_f32_e64 v166, v166 clamp
  v_max_f32 v94, s54, v94
  v_exp_f32_e64 v167, v167 clamp
  v_max_f32 v95, s54, v95
  v_exp_f32_e64 v168, v168 clamp
  v_max_f32 v96, s54, v96
  v_exp_f32_e64 v169, v169 clamp
  v_max_f32 v97, s54, v97
  v_exp_f32_e64 v170, v170 clamp
  v_max_f32 v98, s54, v98
  v_exp_f32_e64 v171, v171 clamp
  v_max_f32 v99, s54, v99
  v_exp_f32_e64 v172, v172 clamp
  v_max_f32 v100, s54, v100
  v_exp_f32_e64 v173, v173 clamp
  v_max_f32 v101, s54, v101
  v_exp_f32_e64 v174, v174 clamp
  v_max_f32 v102, s54, v102
  v_exp_f32_e64 v175, v175 clamp
  v_max_f32 v103, s54, v103
  v_pk_add_f32 v[88:89], v[88:89], v[160:161]
  v_pk_add_f32 v[90:91], v[90:91], v[162:163]
  v_pk_add_f32 v[92:93], v[92:93], v[164:165]
  v_pk_add_f32 v[94:95], v[94:95], v[166:167]
  v_pk_add_f32 v[96:97], v[96:97], v[168:169]
  v_pk_add_f32 v[98:99], v[98:99], v[170:171]
  v_pk_add_f32 v[100:101], v[100:101], v[172:173]
  v_pk_add_f32 v[102:103], v[102:103], v[174:175]
qkv_np1_2:
  v_cvt_pk_bf16_f32 v144, v88, v89
  v_cvt_pk_bf16_f32 v145, v90, v91
  v_cvt_pk_bf16_f32 v146, v92, v93
  v_cvt_pk_bf16_f32 v147, v94, v95
  s_nop 0
  v_permlane32_swap_b32 v144, v146
  v_permlane32_swap_b32 v145, v147
  buffer_store_dwordx4 v[144:147], v17, s[16:19], s43 offen sc1
  s_add_u32 s56, s43, s46
  v_cvt_pk_bf16_f32 v148, v96, v97
  v_cvt_pk_bf16_f32 v149, v98, v99
  v_cvt_pk_bf16_f32 v150, v100, v101
  v_cvt_pk_bf16_f32 v151, v102, v103
  s_nop 0
  v_permlane32_swap_b32 v148, v150
  v_permlane32_swap_b32 v149, v151
  buffer_store_dwordx4 v[148:151], v17, s[16:19], s56 offen sc1
  v_mul_f32 v104, v20, v104
  v_mul_f32 v105, v20, v105
  v_mul_f32 v106, v20, v106
  v_mul_f32 v107, v20, v107
  v_mul_f32 v108, v20, v108
  v_mul_f32 v109, v20, v109
  v_mul_f32 v110, v20, v110
  v_mul_f32 v111, v20, v111
  s_cmp_eq_u32 s20, 0
  s_cbranch_scc1 qkv_xp1
  v_pk_mul_f32 v[176:177], v[104:105], 1.0 op_sel_hi:[1,0]
  v_pk_mul_f32 v[178:179], v[106:107], 1.0 op_sel_hi:[1,0]
  v_pk_mul_f32 v[180:181], v[108:109], 1.0 op_sel_hi:[1,0]
  v_pk_mul_f32 v[182:183], v[110:111], 1.0 op_sel_hi:[1,0]
  v_pk_fma_f32 v[160:161], v[176:177], s[52:53], v[22:23]
  v_pk_fma_f32 v[162:163], v[178:179], s[52:53], v[22:23]
  v_pk_fma_f32 v[164:165], v[180:181], s[52:53], v[22:23]
  v_pk_fma_f32 v[166:167], v[182:183], s[52:53], v[22:23]
  v_exp_f32_e64 v160, v160 clamp
  v_max_f32 v176, s54, v176
  v_exp_f32_e64 v161, v161 clamp
  v_max_f32 v177, s54, v177
  v_exp_f32_e64 v162, v162 clamp
  v_max_f32 v178, s54, v178
  v_exp_f32_e64 v163, v163 clamp
  v_max_f32 v179, s54, v179
  v_exp_f32_e64 v164, v164 clamp
  v_max_f32 v180, s54, v180
  v_exp_f32_e64 v165, v165 clamp
  v_max_f32 v181, s54, v181
  v_exp_f32_e64 v166, v166 clamp
  v_max_f32 v182, s54, v182
  v_exp_f32_e64 v167, v167 clamp
  v_max_f32 v183, s54, v183
  v_pk_add_f32 v[176:177], v[176:177], v[160:161]
  v_pk_add_f32 v[178:179], v[178:179], v[162:163]
  v_pk_add_f32 v[180:181], v[180:181], v[164:165]
  v_pk_add_f32 v[182:183], v[182:183], v[166:167]
  v_cmp_eq_u32 vcc, 1, v21
  s_nop 1
  v_cndmask_b32 v104, v104, v176, vcc
  v_cndmask_b32 v105, v105, v177, vcc
  v_cndmask_b32 v106, v106, v178, vcc
  v_cndmask_b32 v107, v107, v179, vcc
  v_cndmask_b32 v108, v108, v180, vcc
  v_cndmask_b32 v109, v109, v181, vcc
  v_cndmask_b32 v110, v110, v182, vcc
  v_cndmask_b32 v111, v111, v183, vcc
qkv_xp1:
  v_cvt_pk_bf16_f32 v152, v104, v105
  v_cvt_pk_bf16_f32 v153, v106, v107
  v_cvt_pk_bf16_f32 v154, v108, v109
  v_cvt_pk_bf16_f32 v155, v110, v111
  s_nop 0
  v_permlane32_swap_b32 v152, v154
  v_permlane32_swap_b32 v153, v155
  buffer_store_dwordx4 v[152:155], v19, s[16:19], 0 offen sc1
  v_cmp_ne_u32 vcc, 0, v52
  s_nop 1
  v_cndmask_b32 v128, v104, v108, vcc
  v_cndmask_b32 v132, v108, v104, vcc
  v_cndmask_b32 v129, v105, v109, vcc
  v_cndmask_b32 v133, v109, v105, vcc
  v_cndmask_b32 v130, v106, v110, vcc
  v_cndmask_b32 v134, v110, v106, vcc
  v_cndmask_b32 v131, v107, v111, vcc
  v_cndmask_b32 v135, v111, v107, vcc
  s_nop 0
  v_mov_b32_dpp v156, v132 quad_perm:[1,0,3,2] row_mask:0xf bank_mask:0xf
  v_mov_b32_dpp v157, v133 quad_perm:[1,0,3,2] row_mask:0xf bank_mask:0xf
  v_mov_b32_dpp v158, v134 quad_perm:[1,0,3,2] row_mask:0xf bank_mask:0xf
  v_mov_b32_dpp v159, v135 quad_perm:[1,0,3,2] row_mask:0xf bank_mask:0xf
  v_cndmask_b32 v132, v128, v156, vcc
  v_cndmask_b32 v128, v156, v128, vcc
  v_cndmask_b32 v133, v129, v157, vcc
  v_cndmask_b32 v129, v157, v129, vcc
  v_cndmask_b32 v134, v130, v158, vcc
  v_cndmask_b32 v130, v158, v130, vcc
  v_cndmask_b32 v135, v131, v159, vcc
  v_cndmask_b32 v131, v159, v131, vcc
  v_cvt_pk_bf16_f32 v136, v132, v128
  v_cvt_pk_bf16_f32 v137, v133, v129
  v_cvt_pk_bf16_f32 v138, v134, v130
  v_cvt_pk_bf16_f32 v139, v135, v131
  buffer_store_dwordx4 v[136:139], v18, s[16:19], 0 offen sc1
  s_branch qkv_passend
qkv_v2:
  s_waitcnt lgkmcnt(0)
  s_barrier
  ds_read_b64_tr_b16 v[24:25], v1 offset:0
  ds_read_b64_tr_b16 v[26:27], v1 offset:1536
  ds_read_b128 v[112:115], v8 offset:0
  ds_read_b128 v[116:119], v8 offset:2048
  ds_read_b64_tr_b16 v[28:29], v2 offset:0
  ds_read_b64_tr_b16 v[30:31], v2 offset:1536
  ds_read_b64_tr_b16 v[32:33], v3 offset:0
  ds_read_b64_tr_b16 v[34:35], v3 offset:1536
  ds_read_b64_tr_b16 v[36:37], v4 offset:0
  ds_read_b64_tr_b16 v[38:39], v4 offset:1536
  ds_read_b128 v[120:123], v9 offset:0
  ds_read_b128 v[124:127], v9 offset:2048
  ds_read_b64_tr_b16 v[40:41], v5 offset:0
  ds_read_b64_tr_b16 v[42:43], v5 offset:1536
  s_waitcnt lgkmcnt(10)
  v_mfma_f32_16x16x32_bf16 v[56:59], v[24:27], v[112:115], v[208:211]
  v_mfma_f32_16x16x32_bf16 v[60:63], v[24:27], v[116:119], v[208:211]
  ds_read_b64_tr_b16 v[44:45], v6 offset:0
  ds_read_b64_tr_b16 v[46:47], v6 offset:1536
  s_waitcnt lgkmcnt(10)
  v_mfma_f32_16x16x32_bf16 v[64:67], v[28:31], v[112:115], v[208:211]
  v_mfma_f32_16x16x32_bf16 v[68:71], v[28:31], v[116:119], v[208:211]
  ds_read_b64_tr_b16 v[48:49], v7 offset:0
  ds_read_b64_tr_b16 v[50:51], v7 offset:1536
  s_waitcnt lgkmcnt(10)
  v_mfma_f32_16x16x32_bf16 v[72:75], v[32:35], v[112:115], v[212:215]
  v_mfma_f32_16x16x32_bf16 v[76:79], v[32:35], v[116:119], v[212:215]
  ds_read_b64_tr_b16 v[24:25], v1 offset:12288
  ds_read_b64_tr_b16 v[26:27], v1 offset:13824
  s_waitcnt lgkmcnt(10)
  v_mfma_f32_16x16x32_bf16 v[80:83], v[36:39], v[112:115], v[212:215]
  v_mfma_f32_16x16x32_bf16 v[84:87], v[36:39], v[116:119], v[212:215]
  ds_read_b64_tr_b16 v[28:29], v2 offset:12288
  ds_read_b64_tr_b16 v[30:31], v2 offset:13824
  s_waitcnt lgkmcnt(8)
  v_mfma_f32_16x16x32_bf16 v[88:91], v[112:115], v[40:43], v[216:219]
  v_mfma_f32_16x16x32_bf16 v[92:95], v[116:119], v[40:43], v[216:219]
  ds_read_b64_tr_b16 v[32:33], v3 offset:12288
  ds_read_b64_tr_b16 v[34:35], v3 offset:13824
  s_waitcnt lgkmcnt(8)
  v_mfma_f32_16x16x32_bf16 v[96:99], v[112:115], v[44:47], v[216:219]
  v_mfma_f32_16x16x32_bf16 v[100:103], v[116:119], v[44:47], v[216:219]
  ds_read_b64_tr_b16 v[36:37], v4 offset:12288
  ds_read_b64_tr_b16 v[38:39], v4 offset:13824
  s_waitcnt lgkmcnt(8)
  v_mfma_f32_16x16x32_bf16 v[104:107], v[112:115], v[48:51], v[220:223]
  v_mfma_f32_16x16x32_bf16 v[108:111], v[116:119], v[48:51], v[220:223]
  ds_read_b64_tr_b16 v[40:41], v5 offset:12288
  ds_read_b64_tr_b16 v[42:43], v5 offset:13824
  s_waitcnt lgkmcnt(8)
  v_mfma_f32_16x16x32_bf16 v[56:59], v[24:27], v[120:123], v[56:59]
  v_mfma_f32_16x16x32_bf16 v[60:63], v[24:27], v[124:127], v[60:63]
  ds_read_b64_tr_b16 v[44:45], v6 offset:12288
  ds_read_b64_tr_b16 v[46:47], v6 offset:13824
  s_waitcnt lgkmcnt(8)
  v_mfma_f32_16x16x32_bf16 v[64:67], v[28:31], v[120:123], v[64:67]
  v_mfma_f32_16x16x32_bf16 v[68:71], v[28:31], v[124:127], v[68:71]
  ds_read_b64_tr_b16 v[48:49], v7 offset:12288
  ds_read_b64_tr_b16 v[50:51], v7 offset:13824
  s_waitcnt lgkmcnt(8)
  v_mfma_f32_16x16x32_bf16 v[72:75], v[32:35], v[120:123], v[72:75]
  v_mfma_f32_16x16x32_bf16 v[76:79], v[32:35], v[124:127], v[76:79]
  s_waitcnt lgkmcnt(0)
  s_barrier
  ds_read_b64_tr_b16 v[24:25], v1 offset:24576
  ds_read_b64_tr_b16 v[26:27], v1 offset:26112
  ds_read_b128 v[112:115], v10 offset:0
  ds_read_b128 v[116:119], v10 offset:2048
  v_mfma_f32_16x16x32_bf16 v[80:83], v[36:39], v[120:123], v[80:83]
  v_mfma_f32_16x16x32_bf16 v[84:87], v[36:39], v[124:127], v[84:87]
  v_lshrrev_b32 v160, 2, v14
  v_cmp_eq_u32 vcc, 1, v160
  v_cmp_le_u32 s[58:59], 2, v160
  s_nop 0
  v_mov_b32 v161, s41
  ds_read_b64_tr_b16 v[28:29], v2 offset:24576
  ds_read_b64_tr_b16 v[30:31], v2 offset:26112
  v_mfma_f32_16x16x32_bf16 v[88:91], v[120:123], v[40:43], v[88:91]
  v_mfma_f32_16x16x32_bf16 v[92:95], v[124:127], v[40:43], v[92:95]
  v_mov_b32 v166, s42
  v_cndmask_b32 v161, v161, v166, vcc
  v_mov_b32 v166, s43
  v_cndmask_b32 v161, v161, v166, s[58:59]
  v_mov_b32 v162, s44
  ds_read_b64_tr_b16 v[32:33], v3 offset:24576
  ds_read_b64_tr_b16 v[34:35], v3 offset:26112
  v_mfma_f32_16x16x32_bf16 v[96:99], v[120:123], v[44:47], v[96:99]
  v_mfma_f32_16x16x32_bf16 v[100:103], v[124:127], v[44:47], v[100:103]
  v_mov_b32 v166, s45
  v_cndmask_b32 v162, v162, v166, vcc
  v_mov_b32 v166, s46
  v_cndmask_b32 v162, v162, v166, s[58:59]
  v_mov_b32 v163, s47
  ds_read_b64_tr_b16 v[36:37], v4 offset:24576
  ds_read_b64_tr_b16 v[38:39], v4 offset:26112
  v_mfma_f32_16x16x32_bf16 v[104:107], v[120:123], v[48:51], v[104:107]
  v_mfma_f32_16x16x32_bf16 v[108:111], v[124:127], v[48:51], v[108:111]
  v_mov_b32 v166, s48
  v_cndmask_b32 v163, v163, v166, vcc
  v_mov_b32 v166, s49
  v_cndmask_b32 v163, v163, v166, s[58:59]
  v_cmp_eq_u32 vcc, 2, v163
  ds_read_b128 v[120:123], v11 offset:0
  ds_read_b128 v[124:127], v11 offset:2048
  ds_read_b64_tr_b16 v[40:41], v5 offset:24576
  ds_read_b64_tr_b16 v[42:43], v5 offset:26112
  s_waitcnt lgkmcnt(10)
  v_mfma_f32_16x16x32_bf16 v[56:59], v[24:27], v[112:115], v[56:59]
  v_mfma_f32_16x16x32_bf16 v[60:63], v[24:27], v[116:119], v[60:63]
  v_mov_b32 v166, s50
  s_nop 0
  v_cndmask_b32 v21, 0, 1, vcc
  v_cmp_eq_u32 vcc, 1, v163
  v_and_b32 v160, 1, v15
  ds_read_b64_tr_b16 v[44:45], v6 offset:24576
  ds_read_b64_tr_b16 v[46:47], v6 offset:26112
  s_waitcnt lgkmcnt(10)
  v_mfma_f32_16x16x32_bf16 v[64:67], v[28:31], v[112:115], v[64:67]
  v_mfma_f32_16x16x32_bf16 v[68:71], v[28:31], v[116:119], v[68:71]
  v_lshrrev_b32 v164, 1, v15
  v_cndmask_b32 v20, 1.0, v166, vcc
  v_lshlrev_b32 v165, 9, v160
  v_lshl_add_u32 v165, v164, 8, v165
  v_lshl_add_u32 v16, v14, 4, v165
  ds_read_b64_tr_b16 v[48:49], v7 offset:24576
  ds_read_b64_tr_b16 v[50:51], v7 offset:26112
  s_waitcnt lgkmcnt(10)
  v_mfma_f32_16x16x32_bf16 v[72:75], v[32:35], v[112:115], v[72:75]
  v_mfma_f32_16x16x32_bf16 v[76:79], v[32:35], v[116:119], v[76:79]
  v_lshlrev_b32 v165, 8, v160
  v_lshl_add_u32 v165, v164, 9, v165
  v_lshl_add_u32 v17, v14, 4, v165
  v_lshlrev_b32 v165, 5, v160
  v_lshl_add_u32 v165, v164, 6, v165
  ds_read_b64_tr_b16 v[24:25], v1 offset:36864
  ds_read_b64_tr_b16 v[26:27], v1 offset:38400
  s_waitcnt lgkmcnt(10)
  v_mfma_f32_16x16x32_bf16 v[80:83], v[36:39], v[112:115], v[80:83]
  v_mfma_f32_16x16x32_bf16 v[84:87], v[36:39], v[116:119], v[84:87]
  v_bfe_u32 v166, v14, 1, 1
  v_mul_lo_u32 v167, v166, v162
  v_add_u32 v167, v167, v161
  v_and_b32 v168, 1, v14
  v_lshl_add_u32 v169, v168, 4, v165
  ds_read_b64_tr_b16 v[28:29], v2 offset:36864
  ds_read_b64_tr_b16 v[30:31], v2 offset:38400
  s_waitcnt lgkmcnt(8)
  v_mfma_f32_16x16x32_bf16 v[88:91], v[112:115], v[40:43], v[88:91]
  v_mfma_f32_16x16x32_bf16 v[92:95], v[116:119], v[40:43], v[92:95]
  v_add_u32 v169, 1024, v169
  v_add_u32 v169, v169, v167
  v_mov_b32 v170, 65536
  v_cmp_ne_u32 vcc, v162, v170
  v_cmp_gt_u32 s[58:59], 12, v14
  ds_read_b64_tr_b16 v[32:33], v3 offset:36864
  ds_read_b64_tr_b16 v[34:35], v3 offset:38400
  s_waitcnt lgkmcnt(8)
  v_mfma_f32_16x16x32_bf16 v[96:99], v[112:115], v[44:47], v[96:99]
  v_mfma_f32_16x16x32_bf16 v[100:103], v[116:119], v[44:47], v[100:103]
  v_mov_b32 v170, 2146435072
  s_and_b64 vcc, vcc, s[58:59]
  v_cndmask_b32 v19, v170, v169, vcc
  v_lshrrev_b32 v169, 3, v167
  v_lshrrev_b32 v171, 21, v167
  ds_read_b64_tr_b16 v[36:37], v4 offset:36864
  ds_read_b64_tr_b16 v[38:39], v4 offset:38400
  s_waitcnt lgkmcnt(8)
  v_mfma_f32_16x16x32_bf16 v[104:107], v[112:115], v[48:51], v[104:107]
  v_mfma_f32_16x16x32_bf16 v[108:111], v[116:119], v[48:51], v[108:111]
  v_mov_b32 v172, 0x400000
  v_mov_b32 v173, 0x820000
  v_cmp_le_u32 vcc, 3, v171
  v_lshl_add_u32 v169, v15, 4, v169
  v_mov_b32 v171, 65536
  ds_read_b64_tr_b16 v[40:41], v5 offset:36864
  ds_read_b64_tr_b16 v[42:43], v5 offset:38400
  s_waitcnt lgkmcnt(8)
  v_mfma_f32_16x16x32_bf16 v[56:59], v[24:27], v[120:123], v[56:59]
  v_mfma_f32_16x16x32_bf16 v[60:63], v[24:27], v[124:127], v[60:63]
  v_cndmask_b32 v172, v172, v173, vcc
  v_add_u32 v169, v169, v172
  v_lshl_add_u32 v169, v168, 6, v169
  v_cmp_eq_u32 vcc, v162, v171
  v_cmp_eq_u32 s[56:57], 1, v168
  ds_read_b64_tr_b16 v[44:45], v6 offset:36864
  ds_read_b64_tr_b16 v[46:47], v6 offset:38400
  s_waitcnt lgkmcnt(8)
  v_mfma_f32_16x16x32_bf16 v[64:67], v[28:31], v[120:123], v[64:67]
  v_mfma_f32_16x16x32_bf16 v[68:71], v[28:31], v[124:127], v[68:71]
  s_nop 0
  s_and_b64 vcc, vcc, s[58:59]
  v_cndmask_b32 v18, v170, v169, vcc
  v_cndmask_b32 v52, 0, -1, s[56:57]
  v_mov_b32 v22, 0xb5c1a2a0
  ds_read_b64_tr_b16 v[48:49], v7 offset:36864
  ds_read_b64_tr_b16 v[50:51], v7 offset:38400
  s_waitcnt lgkmcnt(8)
  v_mfma_f32_16x16x32_bf16 v[72:75], v[32:35], v[120:123], v[72:75]
  v_mfma_f32_16x16x32_bf16 v[76:79], v[32:35], v[124:127], v[76:79]
  v_mov_b32 v23, 0xb5c1a2a0
  s_cmp_eq_u32 s14, 2
  s_cselect_b32 s32, s54, 0
  v_mov_b32 v208, s32
  v_mov_b32 v209, s32
  s_waitcnt lgkmcnt(0)
  s_barrier
  ds_read_b64_tr_b16 v[24:25], v1 offset:49152
  ds_read_b64_tr_b16 v[26:27], v1 offset:50688
  ds_read_b128 v[112:115], v12 offset:0
  ds_read_b128 v[116:119], v12 offset:2048
  v_mfma_f32_16x16x32_bf16 v[80:83], v[36:39], v[120:123], v[80:83]
  v_mfma_f32_16x16x32_bf16 v[84:87], v[36:39], v[124:127], v[84:87]
  v_mov_b32 v210, s32
  v_mov_b32 v211, s32
  s_cmp_eq_u32 s15, 2
  s_cselect_b32 s32, s54, 0
  v_mov_b32 v212, s32
  ds_read_b64_tr_b16 v[28:29], v2 offset:49152
  ds_read_b64_tr_b16 v[30:31], v2 offset:50688
  v_mfma_f32_16x16x32_bf16 v[88:91], v[120:123], v[40:43], v[88:91]
  v_mfma_f32_16x16x32_bf16 v[92:95], v[124:127], v[40:43], v[92:95]
  v_mov_b32 v213, s32
  v_mov_b32 v214, s32
  v_mov_b32 v215, s32
  s_cmp_eq_u32 s55, 2
  s_cselect_b32 s32, s54, 0
  ds_read_b64_tr_b16 v[32:33], v3 offset:49152
  ds_read_b64_tr_b16 v[34:35], v3 offset:50688
  v_mfma_f32_16x16x32_bf16 v[96:99], v[120:123], v[44:47], v[96:99]
  v_mfma_f32_16x16x32_bf16 v[100:103], v[124:127], v[44:47], v[100:103]
  v_mov_b32 v216, s32
  v_mov_b32 v217, s32
  v_mov_b32 v218, s32
  v_mov_b32 v219, s32
  v_lshrrev_b32 v192, 2, v14
  ds_read_b64_tr_b16 v[36:37], v4 offset:49152
  ds_read_b64_tr_b16 v[38:39], v4 offset:50688
  v_mfma_f32_16x16x32_bf16 v[104:107], v[120:123], v[48:51], v[104:107]
  v_mfma_f32_16x16x32_bf16 v[108:111], v[124:127], v[48:51], v[108:111]
  v_cmp_eq_u32 vcc, 1, v192
  v_cmp_le_u32 s[58:59], 2, v192
  s_nop 0
  v_mov_b32 v193, s14
  v_mov_b32 v194, s15
  ds_read_b128 v[120:123], v13 offset:0
  ds_read_b128 v[124:127], v13 offset:2048
  ds_read_b64_tr_b16 v[40:41], v5 offset:49152
  ds_read_b64_tr_b16 v[42:43], v5 offset:50688
  s_waitcnt lgkmcnt(10)
  v_mfma_f32_16x16x32_bf16 v[56:59], v[24:27], v[112:115], v[56:59]
  v_mfma_f32_16x16x32_bf16 v[60:63], v[24:27], v[116:119], v[60:63]
  v_cndmask_b32 v193, v193, v194, vcc
  v_mov_b32 v194, s55
  v_cndmask_b32 v193, v193, v194, s[58:59]
  v_cmp_eq_u32 vcc, 2, v193
  v_mov_b32 v194, s54
  ds_read_b64_tr_b16 v[44:45], v6 offset:49152
  ds_read_b64_tr_b16 v[46:47], v6 offset:50688
  s_waitcnt lgkmcnt(10)
  v_mfma_f32_16x16x32_bf16 v[64:67], v[28:31], v[112:115], v[64:67]
  v_mfma_f32_16x16x32_bf16 v[68:71], v[28:31], v[116:119], v[68:71]
  s_nop 0
  v_cndmask_b32 v220, 0, v194, vcc
  v_mov_b32 v221, v220
  v_mov_b32 v222, v220
  v_mov_b32 v223, v220
  ds_read_b64_tr_b16 v[48:49], v7 offset:49152
  ds_read_b64_tr_b16 v[50:51], v7 offset:50688
  s_waitcnt lgkmcnt(10)
  v_mfma_f32_16x16x32_bf16 v[72:75], v[32:35], v[112:115], v[72:75]
  v_mfma_f32_16x16x32_bf16 v[76:79], v[32:35], v[116:119], v[76:79]
  ds_read_b64_tr_b16 v[24:25], v1 offset:61440
  ds_read_b64_tr_b16 v[26:27], v1 offset:62976
  s_waitcnt lgkmcnt(10)
  v_mfma_f32_16x16x32_bf16 v[80:83], v[36:39], v[112:115], v[80:83]
  v_mfma_f32_16x16x32_bf16 v[84:87], v[36:39], v[116:119], v[84:87]
  ds_read_b64_tr_b16 v[28:29], v2 offset:61440
  ds_read_b64_tr_b16 v[30:31], v2 offset:62976
  s_waitcnt lgkmcnt(8)
  v_mfma_f32_16x16x32_bf16 v[88:91], v[112:115], v[40:43], v[88:91]
  v_mfma_f32_16x16x32_bf16 v[92:95], v[116:119], v[40:43], v[92:95]
  ds_read_b64_tr_b16 v[32:33], v3 offset:61440
  ds_read_b64_tr_b16 v[34:35], v3 offset:62976
  s_waitcnt lgkmcnt(8)
  v_mfma_f32_16x16x32_bf16 v[96:99], v[112:115], v[44:47], v[96:99]
  v_mfma_f32_16x16x32_bf16 v[100:103], v[116:119], v[44:47], v[100:103]
  ds_read_b64_tr_b16 v[36:37], v4 offset:61440
  ds_read_b64_tr_b16 v[38:39], v4 offset:62976
  s_waitcnt lgkmcnt(8)
  v_mfma_f32_16x16x32_bf16 v[104:107], v[112:115], v[48:51], v[104:107]
  v_mfma_f32_16x16x32_bf16 v[108:111], v[116:119], v[48:51], v[108:111]
  ds_read_b64_tr_b16 v[40:41], v5 offset:61440
  ds_read_b64_tr_b16 v[42:43], v5 offset:62976
  s_waitcnt lgkmcnt(8)
  v_mfma_f32_16x16x32_bf16 v[56:59], v[24:27], v[120:123], v[56:59]
  v_mfma_f32_16x16x32_bf16 v[60:63], v[24:27], v[124:127], v[60:63]
  ds_read_b64_tr_b16 v[44:45], v6 offset:61440
  ds_read_b64_tr_b16 v[46:47], v6 offset:62976
  s_waitcnt lgkmcnt(8)
  v_mfma_f32_16x16x32_bf16 v[64:67], v[28:31], v[120:123], v[64:67]
  v_mfma_f32_16x16x32_bf16 v[68:71], v[28:31], v[124:127], v[68:71]
  ds_read_b64_tr_b16 v[48:49], v7 offset:61440
  ds_read_b64_tr_b16 v[50:51], v7 offset:62976
  s_waitcnt lgkmcnt(8)
  v_mfma_f32_16x16x32_bf16 v[72:75], v[32:35], v[120:123], v[72:75]
  v_mfma_f32_16x16x32_bf16 v[76:79], v[32:35], v[124:127], v[76:79]
  s_waitcnt lgkmcnt(0)
  s_barrier
  s_cmp_eq_u32 s20, 1
  s_cbranch_scc1 qkv_nopfm2
  s_mov_b32 s64, s26
  s_and_b32 s65, s27, 0xffff
  s_mov_b32 s66, 1990656
  s_mov_b32 s67, 0x00020000
  buffer_load_dword v204, v203, s[64:67], s34 offen
  s_mov_b32 s68, s24
  s_and_b32 s69, s25, 0xffff
  s_mov_b32 s70, 2359296
  s_mov_b32 s71, 0x00020000
  buffer_load_dword v205, v202, s[68:71], s35 offen
qkv_nopfm2:
  ds_read_b64_tr_b16 v[24:25], v1 offset:0
  ds_read_b64_tr_b16 v[26:27], v1 offset:1536
  ds_read_b128 v[112:115], v8 offset:0
  ds_read_b128 v[116:119], v8 offset:2048
  v_mfma_f32_16x16x32_bf16 v[80:83], v[36:39], v[120:123], v[80:83]
  v_mfma_f32_16x16x32_bf16 v[84:87], v[36:39], v[124:127], v[84:87]
  ds_read_b64_tr_b16 v[28:29], v2 offset:0
  ds_read_b64_tr_b16 v[30:31], v2 offset:1536
  v_mfma_f32_16x16x32_bf16 v[88:91], v[120:123], v[40:43], v[88:91]
  v_mfma_f32_16x16x32_bf16 v[92:95], v[124:127], v[40:43], v[92:95]
  ds_read_b64_tr_b16 v[32:33], v3 offset:0
  ds_read_b64_tr_b16 v[34:35], v3 offset:1536
  v_mfma_f32_16x16x32_bf16 v[96:99], v[120:123], v[44:47], v[96:99]
  v_mfma_f32_16x16x32_bf16 v[100:103], v[124:127], v[44:47], v[100:103]
  ds_read_b64_tr_b16 v[36:37], v4 offset:0
  ds_read_b64_tr_b16 v[38:39], v4 offset:1536
  v_mfma_f32_16x16x32_bf16 v[104:107], v[120:123], v[48:51], v[104:107]
  v_mfma_f32_16x16x32_bf16 v[108:111], v[124:127], v[48:51], v[108:111]
  ds_read_b128 v[120:123], v9 offset:0
  ds_read_b128 v[124:127], v9 offset:2048
  ds_read_b64_tr_b16 v[40:41], v5 offset:0
  ds_read_b64_tr_b16 v[42:43], v5 offset:1536
  s_waitcnt lgkmcnt(10)
  v_mfma_f32_16x16x32_bf16 v[56:59], v[24:27], v[112:115], v[56:59]
  v_mfma_f32_16x16x32_bf16 v[60:63], v[24:27], v[116:119], v[60:63]
  ds_read_b64_tr_b16 v[44:45], v6 offset:0
  ds_read_b64_tr_b16 v[46:47], v6 offset:1536
  s_waitcnt lgkmcnt(10)
  v_mfma_f32_16x16x32_bf16 v[64:67], v[28:31], v[112:115], v[64:67]
  v_mfma_f32_16x16x32_bf16 v[68:71], v[28:31], v[116:119], v[68:71]
  ds_read_b64_tr_b16 v[48:49], v7 offset:0
  ds_read_b64_tr_b16 v[50:51], v7 offset:1536
  s_waitcnt lgkmcnt(10)
  v_mfma_f32_16x16x32_bf16 v[72:75], v[32:35], v[112:115], v[72:75]
  v_mfma_f32_16x16x32_bf16 v[76:79], v[32:35], v[116:119], v[76:79]
  ds_read_b64_tr_b16 v[24:25], v1 offset:12288
  ds_read_b64_tr_b16 v[26:27], v1 offset:13824
  s_waitcnt lgkmcnt(10)
  v_mfma_f32_16x16x32_bf16 v[80:83], v[36:39], v[112:115], v[80:83]
  v_mfma_f32_16x16x32_bf16 v[84:87], v[36:39], v[116:119], v[84:87]
  ds_read_b64_tr_b16 v[28:29], v2 offset:12288
  ds_read_b64_tr_b16 v[30:31], v2 offset:13824
  s_waitcnt lgkmcnt(8)
  v_mfma_f32_16x16x32_bf16 v[88:91], v[112:115], v[40:43], v[88:91]
  v_mfma_f32_16x16x32_bf16 v[92:95], v[116:119], v[40:43], v[92:95]
  ds_read_b64_tr_b16 v[32:33], v3 offset:12288
  ds_read_b64_tr_b16 v[34:35], v3 offset:13824
  s_waitcnt lgkmcnt(8)
  v_mfma_f32_16x16x32_bf16 v[96:99], v[112:115], v[44:47], v[96:99]
  v_mfma_f32_16x16x32_bf16 v[100:103], v[116:119], v[44:47], v[100:103]
  ds_read_b64_tr_b16 v[36:37], v4 offset:12288
  ds_read_b64_tr_b16 v[38:39], v4 offset:13824
  s_waitcnt lgkmcnt(8)
  v_mfma_f32_16x16x32_bf16 v[104:107], v[112:115], v[48:51], v[104:107]
  v_mfma_f32_16x16x32_bf16 v[108:111], v[116:119], v[48:51], v[108:111]
  ds_read_b64_tr_b16 v[40:41], v5 offset:12288
  ds_read_b64_tr_b16 v[42:43], v5 offset:13824
  s_waitcnt lgkmcnt(8)
  v_mfma_f32_16x16x32_bf16 v[56:59], v[24:27], v[120:123], v[56:59]
  v_mfma_f32_16x16x32_bf16 v[60:63], v[24:27], v[124:127], v[60:63]
  ds_read_b64_tr_b16 v[44:45], v6 offset:12288
  ds_read_b64_tr_b16 v[46:47], v6 offset:13824
  s_waitcnt lgkmcnt(8)
  v_mfma_f32_16x16x32_bf16 v[64:67], v[28:31], v[120:123], v[64:67]
  v_mfma_f32_16x16x32_bf16 v[68:71], v[28:31], v[124:127], v[68:71]
  ds_read_b64_tr_b16 v[48:49], v7 offset:12288
  ds_read_b64_tr_b16 v[50:51], v7 offset:13824
  s_waitcnt lgkmcnt(8)
  v_mfma_f32_16x16x32_bf16 v[72:75], v[32:35], v[120:123], v[72:75]
  v_mfma_f32_16x16x32_bf16 v[76:79], v[32:35], v[124:127], v[76:79]
  s_waitcnt vmcnt(0) lgkmcnt(0)
  s_barrier
  s_cmp_eq_u32 s20, 0
  s_cbranch_scc1 qkv_pa2
  s_cmp_lg_u32 s23, 0
  s_cbranch_scc1 qkv_pa2
  v_readfirstlane_b32 s100, v55
  s_mov_b32 s31, 131072
  s_nop 2
qkv_ns2:
  s_cmp_lg_u32 s100, 0
  s_cbranch_scc1 qkv_nk2
  s_sub_u32 s31, s31, 1
  s_cmp_eq_u32 s31, 0
  s_cbranch_scc1 qkv_nk2
  global_load_dword v55, v54, s[60:61] sc1
  s_waitcnt vmcnt(0)
  v_readfirstlane_b32 s100, v55
  s_nop 3
  s_branch qkv_ns2
qkv_nk2:
  v_mov_b32 v53, 151552
  v_mov_b32 v55, s100
  ds_write_b32 v53, v55
  s_lshl_b32 s30, s22, 7
  s_lshl_b32 s31, s21, 2
  s_add_u32 s30, s30, s31
  s_add_u32 s30, s30, 19922944
  v_mul_u32_u24 v200, 2048, v0
  v_add_u32 v200, s30, v200
  v_mov_b32 v201, s100
  s_mov_b64 exec, 255
  global_store_dword v200, v201, s[28:29] sc1
  s_mov_b64 exec, -1
  s_waitcnt lgkmcnt(0)
qkv_pa2:
  ds_read_b64_tr_b16 v[24:25], v1 offset:24576
  ds_read_b64_tr_b16 v[26:27], v1 offset:26112
  ds_read_b128 v[112:115], v10 offset:0
  ds_read_b128 v[116:119], v10 offset:2048
  v_mfma_f32_16x16x32_bf16 v[80:83], v[36:39], v[120:123], v[80:83]
  v_mfma_f32_16x16x32_bf16 v[84:87], v[36:39], v[124:127], v[84:87]
  ds_read_b64_tr_b16 v[28:29], v2 offset:24576
  ds_read_b64_tr_b16 v[30:31], v2 offset:26112
  v_mfma_f32_16x16x32_bf16 v[88:91], v[120:123], v[40:43], v[88:91]
  v_mfma_f32_16x16x32_bf16 v[92:95], v[124:127], v[40:43], v[92:95]
  ds_read_b64_tr_b16 v[32:33], v3 offset:24576
  ds_read_b64_tr_b16 v[34:35], v3 offset:26112
  v_mfma_f32_16x16x32_bf16 v[96:99], v[120:123], v[44:47], v[96:99]
  v_mfma_f32_16x16x32_bf16 v[100:103], v[124:127], v[44:47], v[100:103]
  ds_read_b64_tr_b16 v[36:37], v4 offset:24576
  ds_read_b64_tr_b16 v[38:39], v4 offset:26112
  v_mfma_f32_16x16x32_bf16 v[104:107], v[120:123], v[48:51], v[104:107]
  v_mfma_f32_16x16x32_bf16 v[108:111], v[124:127], v[48:51], v[108:111]
  ds_read_b128 v[120:123], v11 offset:0
  ds_read_b128 v[124:127], v11 offset:2048
  ds_read_b64_tr_b16 v[40:41], v5 offset:24576
  ds_read_b64_tr_b16 v[42:43], v5 offset:26112
  s_waitcnt lgkmcnt(10)
  v_mfma_f32_16x16x32_bf16 v[56:59], v[24:27], v[112:115], v[56:59]
  v_mfma_f32_16x16x32_bf16 v[60:63], v[24:27], v[116:119], v[60:63]
  ds_read_b64_tr_b16 v[44:45], v6 offset:24576
  ds_read_b64_tr_b16 v[46:47], v6 offset:26112
  s_waitcnt lgkmcnt(10)
  v_mfma_f32_16x16x32_bf16 v[64:67], v[28:31], v[112:115], v[64:67]
  v_mfma_f32_16x16x32_bf16 v[68:71], v[28:31], v[116:119], v[68:71]
  ds_read_b64_tr_b16 v[48:49], v7 offset:24576
  ds_read_b64_tr_b16 v[50:51], v7 offset:26112
  s_waitcnt lgkmcnt(10)
  v_mfma_f32_16x16x32_bf16 v[72:75], v[32:35], v[112:115], v[72:75]
  v_mfma_f32_16x16x32_bf16 v[76:79], v[32:35], v[116:119], v[76:79]
  ds_read_b64_tr_b16 v[24:25], v1 offset:36864
  ds_read_b64_tr_b16 v[26:27], v1 offset:38400
  s_waitcnt lgkmcnt(10)
  v_mfma_f32_16x16x32_bf16 v[80:83], v[36:39], v[112:115], v[80:83]
  v_mfma_f32_16x16x32_bf16 v[84:87], v[36:39], v[116:119], v[84:87]
  ds_read_b64_tr_b16 v[28:29], v2 offset:36864
  ds_read_b64_tr_b16 v[30:31], v2 offset:38400
  s_waitcnt lgkmcnt(8)
  v_mfma_f32_16x16x32_bf16 v[88:91], v[112:115], v[40:43], v[88:91]
  v_mfma_f32_16x16x32_bf16 v[92:95], v[116:119], v[40:43], v[92:95]
  ds_read_b64_tr_b16 v[32:33], v3 offset:36864
  ds_read_b64_tr_b16 v[34:35], v3 offset:38400
  s_waitcnt lgkmcnt(8)
  v_mfma_f32_16x16x32_bf16 v[96:99], v[112:115], v[44:47], v[96:99]
  v_mfma_f32_16x16x32_bf16 v[100:103], v[116:119], v[44:47], v[100:103]
  ds_read_b64_tr_b16 v[36:37], v4 offset:36864
  ds_read_b64_tr_b16 v[38:39], v4 offset:38400
  s_waitcnt lgkmcnt(8)
  v_mfma_f32_16x16x32_bf16 v[104:107], v[112:115], v[48:51], v[104:107]
  v_mfma_f32_16x16x32_bf16 v[108:111], v[116:119], v[48:51], v[108:111]
  ds_read_b64_tr_b16 v[40:41], v5 offset:36864
  ds_read_b64_tr_b16 v[42:43], v5 offset:38400
  s_waitcnt lgkmcnt(8)
  v_mfma_f32_16x16x32_bf16 v[56:59], v[24:27], v[120:123], v[56:59]
  v_mfma_f32_16x16x32_bf16 v[60:63], v[24:27], v[124:127], v[60:63]
  ds_read_b64_tr_b16 v[44:45], v6 offset:36864
  ds_read_b64_tr_b16 v[46:47], v6 offset:38400
  s_waitcnt lgkmcnt(8)
  v_mfma_f32_16x16x32_bf16 v[64:67], v[28:31], v[120:123], v[64:67]
  v_mfma_f32_16x16x32_bf16 v[68:71], v[28:31], v[124:127], v[68:71]
  ds_read_b64_tr_b16 v[48:49], v7 offset:36864
  ds_read_b64_tr_b16 v[50:51], v7 offset:38400
  s_waitcnt lgkmcnt(8)
  v_mfma_f32_16x16x32_bf16 v[72:75], v[32:35], v[120:123], v[72:75]
  v_mfma_f32_16x16x32_bf16 v[76:79], v[32:35], v[124:127], v[76:79]
  s_waitcnt lgkmcnt(0)
  s_barrier
  ds_read_b64_tr_b16 v[24:25], v1 offset:49152
  ds_read_b64_tr_b16 v[26:27], v1 offset:50688
  ds_read_b128 v[112:115], v12 offset:0
  ds_read_b128 v[116:119], v12 offset:2048
  v_mfma_f32_16x16x32_bf16 v[80:83], v[36:39], v[120:123], v[80:83]
  v_mfma_f32_16x16x32_bf16 v[84:87], v[36:39], v[124:127], v[84:87]
  ds_read_b64_tr_b16 v[28:29], v2 offset:49152
  ds_read_b64_tr_b16 v[30:31], v2 offset:50688
  v_mfma_f32_16x16x32_bf16 v[88:91], v[120:123], v[40:43], v[88:91]
  v_mfma_f32_16x16x32_bf16 v[92:95], v[124:127], v[40:43], v[92:95]
  ds_read_b64_tr_b16 v[32:33], v3 offset:49152
  ds_read_b64_tr_b16 v[34:35], v3 offset:50688
  v_mfma_f32_16x16x32_bf16 v[96:99], v[120:123], v[44:47], v[96:99]
  v_mfma_f32_16x16x32_bf16 v[100:103], v[124:127], v[44:47], v[100:103]
  ds_read_b64_tr_b16 v[36:37], v4 offset:49152
  ds_read_b64_tr_b16 v[38:39], v4 offset:50688
  v_mfma_f32_16x16x32_bf16 v[104:107], v[120:123], v[48:51], v[104:107]
  v_mfma_f32_16x16x32_bf16 v[108:111], v[124:127], v[48:51], v[108:111]
  ds_read_b128 v[120:123], v13 offset:0
  ds_read_b128 v[124:127], v13 offset:2048
  ds_read_b64_tr_b16 v[40:41], v5 offset:49152
  ds_read_b64_tr_b16 v[42:43], v5 offset:50688
  s_waitcnt lgkmcnt(10)
  v_mfma_f32_16x16x32_bf16 v[56:59], v[24:27], v[112:115], v[56:59]
  v_mfma_f32_16x16x32_bf16 v[60:63], v[24:27], v[116:119], v[60:63]
  ds_read_b64_tr_b16 v[44:45], v6 offset:49152
  ds_read_b64_tr_b16 v[46:47], v6 offset:50688
  s_waitcnt lgkmcnt(10)
  v_mfma_f32_16x16x32_bf16 v[64:67], v[28:31], v[112:115], v[64:67]
  v_mfma_f32_16x16x32_bf16 v[68:71], v[28:31], v[116:119], v[68:71]
  ds_read_b64_tr_b16 v[48:49], v7 offset:49152
  ds_read_b64_tr_b16 v[50:51], v7 offset:50688
  s_waitcnt lgkmcnt(10)
  v_mfma_f32_16x16x32_bf16 v[72:75], v[32:35], v[112:115], v[72:75]
  v_mfma_f32_16x16x32_bf16 v[76:79], v[32:35], v[116:119], v[76:79]
  ds_read_b64_tr_b16 v[24:25], v1 offset:61440
  ds_read_b64_tr_b16 v[26:27], v1 offset:62976
  s_waitcnt lgkmcnt(10)
  v_mfma_f32_16x16x32_bf16 v[80:83], v[36:39], v[112:115], v[80:83]
  v_mfma_f32_16x16x32_bf16 v[84:87], v[36:39], v[116:119], v[84:87]
  ds_read_b64_tr_b16 v[28:29], v2 offset:61440
  ds_read_b64_tr_b16 v[30:31], v2 offset:62976
  s_waitcnt lgkmcnt(8)
  v_mfma_f32_16x16x32_bf16 v[88:91], v[112:115], v[40:43], v[88:91]
  v_mfma_f32_16x16x32_bf16 v[92:95], v[116:119], v[40:43], v[92:95]
  ds_read_b64_tr_b16 v[32:33], v3 offset:61440
  ds_read_b64_tr_b16 v[34:35], v3 offset:62976
  s_waitcnt lgkmcnt(8)
  v_mfma_f32_16x16x32_bf16 v[96:99], v[112:115], v[44:47], v[96:99]
  v_mfma_f32_16x16x32_bf16 v[100:103], v[116:119], v[44:47], v[100:103]
  ds_read_b64_tr_b16 v[36:37], v4 offset:61440
  ds_read_b64_tr_b16 v[38:39], v4 offset:62976
  s_waitcnt lgkmcnt(8)
  v_mfma_f32_16x16x32_bf16 v[104:107], v[112:115], v[48:51], v[104:107]
  v_mfma_f32_16x16x32_bf16 v[108:111], v[116:119], v[48:51], v[108:111]
  ds_read_b64_tr_b16 v[40:41], v5 offset:61440
  ds_read_b64_tr_b16 v[42:43], v5 offset:62976
  s_waitcnt lgkmcnt(8)
  v_mfma_f32_16x16x32_bf16 v[56:59], v[24:27], v[120:123], v[56:59]
  v_mfma_f32_16x16x32_bf16 v[60:63], v[24:27], v[124:127], v[60:63]
  ds_read_b64_tr_b16 v[44:45], v6 offset:61440
  ds_read_b64_tr_b16 v[46:47], v6 offset:62976
  s_waitcnt lgkmcnt(8)
  v_mfma_f32_16x16x32_bf16 v[64:67], v[28:31], v[120:123], v[64:67]
  v_mfma_f32_16x16x32_bf16 v[68:71], v[28:31], v[124:127], v[68:71]
  ds_read_b64_tr_b16 v[48:49], v7 offset:61440
  ds_read_b64_tr_b16 v[50:51], v7 offset:62976
  s_waitcnt lgkmcnt(8)
  v_mfma_f32_16x16x32_bf16 v[72:75], v[32:35], v[120:123], v[72:75]
  v_mfma_f32_16x16x32_bf16 v[76:79], v[32:35], v[124:127], v[76:79]
  s_waitcnt lgkmcnt(0)
  s_barrier
  ds_read_b64_tr_b16 v[24:25], v1 offset:0
  ds_read_b64_tr_b16 v[26:27], v1 offset:1536
  ds_read_b128 v[112:115], v8 offset:0
  ds_read_b128 v[116:119], v8 offset:2048
  v_mfma_f32_16x16x32_bf16 v[80:83], v[36:39], v[120:123], v[80:83]
  v_mfma_f32_16x16x32_bf16 v[84:87], v[36:39], v[124:127], v[84:87]
  ds_read_b64_tr_b16 v[28:29], v2 offset:0
  ds_read_b64_tr_b16 v[30:31], v2 offset:1536
  v_mfma_f32_16x16x32_bf16 v[88:91], v[120:123], v[40:43], v[88:91]
  v_mfma_f32_16x16x32_bf16 v[92:95], v[124:127], v[40:43], v[92:95]
  ds_read_b64_tr_b16 v[32:33], v3 offset:0
  ds_read_b64_tr_b16 v[34:35], v3 offset:1536
  v_mfma_f32_16x16x32_bf16 v[96:99], v[120:123], v[44:47], v[96:99]
  v_mfma_f32_16x16x32_bf16 v[100:103], v[124:127], v[44:47], v[100:103]
  ds_read_b64_tr_b16 v[36:37], v4 offset:0
  ds_read_b64_tr_b16 v[38:39], v4 offset:1536
  v_mfma_f32_16x16x32_bf16 v[104:107], v[120:123], v[48:51], v[104:107]
  v_mfma_f32_16x16x32_bf16 v[108:111], v[124:127], v[48:51], v[108:111]
  ds_read_b128 v[120:123], v9 offset:0
  ds_read_b128 v[124:127], v9 offset:2048
  ds_read_b64_tr_b16 v[40:41], v5 offset:0
  ds_read_b64_tr_b16 v[42:43], v5 offset:1536
  s_waitcnt lgkmcnt(10)
  v_mfma_f32_16x16x32_bf16 v[56:59], v[24:27], v[112:115], v[56:59]
  v_mfma_f32_16x16x32_bf16 v[60:63], v[24:27], v[116:119], v[60:63]
  ds_read_b64_tr_b16 v[44:45], v6 offset:0
  ds_read_b64_tr_b16 v[46:47], v6 offset:1536
  s_waitcnt lgkmcnt(10)
  v_mfma_f32_16x16x32_bf16 v[64:67], v[28:31], v[112:115], v[64:67]
  v_mfma_f32_16x16x32_bf16 v[68:71], v[28:31], v[116:119], v[68:71]
  ds_read_b64_tr_b16 v[48:49], v7 offset:0
  ds_read_b64_tr_b16 v[50:51], v7 offset:1536
  s_waitcnt lgkmcnt(10)
  v_mfma_f32_16x16x32_bf16 v[72:75], v[32:35], v[112:115], v[72:75]
  v_mfma_f32_16x16x32_bf16 v[76:79], v[32:35], v[116:119], v[76:79]
  ds_read_b64_tr_b16 v[24:25], v1 offset:12288
  ds_read_b64_tr_b16 v[26:27], v1 offset:13824
  s_waitcnt lgkmcnt(10)
  v_mfma_f32_16x16x32_bf16 v[80:83], v[36:39], v[112:115], v[80:83]
  v_mfma_f32_16x16x32_bf16 v[84:87], v[36:39], v[116:119], v[84:87]
  ds_read_b64_tr_b16 v[28:29], v2 offset:12288
  ds_read_b64_tr_b16 v[30:31], v2 offset:13824
  s_waitcnt lgkmcnt(8)
  v_mfma_f32_16x16x32_bf16 v[88:91], v[112:115], v[40:43], v[88:91]
  v_mfma_f32_16x16x32_bf16 v[92:95], v[116:119], v[40:43], v[92:95]
  ds_read_b64_tr_b16 v[32:33], v3 offset:12288
  ds_read_b64_tr_b16 v[34:35], v3 offset:13824
  s_waitcnt lgkmcnt(8)
  v_mfma_f32_16x16x32_bf16 v[96:99], v[112:115], v[44:47], v[96:99]
  v_mfma_f32_16x16x32_bf16 v[100:103], v[116:119], v[44:47], v[100:103]
  ds_read_b64_tr_b16 v[36:37], v4 offset:12288
  ds_read_b64_tr_b16 v[38:39], v4 offset:13824
  s_waitcnt lgkmcnt(8)
  v_mfma_f32_16x16x32_bf16 v[104:107], v[112:115], v[48:51], v[104:107]
  v_mfma_f32_16x16x32_bf16 v[108:111], v[116:119], v[48:51], v[108:111]
  ds_read_b64_tr_b16 v[40:41], v5 offset:12288
  ds_read_b64_tr_b16 v[42:43], v5 offset:13824
  s_waitcnt lgkmcnt(8)
  v_mfma_f32_16x16x32_bf16 v[56:59], v[24:27], v[120:123], v[56:59]
  v_mfma_f32_16x16x32_bf16 v[60:63], v[24:27], v[124:127], v[60:63]
  ds_read_b64_tr_b16 v[44:45], v6 offset:12288
  ds_read_b64_tr_b16 v[46:47], v6 offset:13824
  s_waitcnt lgkmcnt(8)
  v_mfma_f32_16x16x32_bf16 v[64:67], v[28:31], v[120:123], v[64:67]
  v_mfma_f32_16x16x32_bf16 v[68:71], v[28:31], v[124:127], v[68:71]
  ds_read_b64_tr_b16 v[48:49], v7 offset:12288
  ds_read_b64_tr_b16 v[50:51], v7 offset:13824
  s_waitcnt lgkmcnt(8)
  v_mfma_f32_16x16x32_bf16 v[72:75], v[32:35], v[120:123], v[72:75]
  v_mfma_f32_16x16x32_bf16 v[76:79], v[32:35], v[124:127], v[76:79]
  s_waitcnt lgkmcnt(0)
  s_barrier
  ds_read_b64_tr_b16 v[24:25], v1 offset:24576
  ds_read_b64_tr_b16 v[26:27], v1 offset:26112
  ds_read_b128 v[112:115], v10 offset:0
  ds_read_b128 v[116:119], v10 offset:2048
  v_mfma_f32_16x16x32_bf16 v[80:83], v[36:39], v[120:123], v[80:83]
  v_mfma_f32_16x16x32_bf16 v[84:87], v[36:39], v[124:127], v[84:87]
  ds_read_b64_tr_b16 v[28:29], v2 offset:24576
  ds_read_b64_tr_b16 v[30:31], v2 offset:26112
  v_mfma_f32_16x16x32_bf16 v[88:91], v[120:123], v[40:43], v[88:91]
  v_mfma_f32_16x16x32_bf16 v[92:95], v[124:127], v[40:43], v[92:95]
  ds_read_b64_tr_b16 v[32:33], v3 offset:24576
  ds_read_b64_tr_b16 v[34:35], v3 offset:26112
  v_mfma_f32_16x16x32_bf16 v[96:99], v[120:123], v[44:47], v[96:99]
  v_mfma_f32_16x16x32_bf16 v[100:103], v[124:127], v[44:47], v[100:103]
  ds_read_b64_tr_b16 v[36:37], v4 offset:24576
  ds_read_b64_tr_b16 v[38:39], v4 offset:26112
  v_mfma_f32_16x16x32_bf16 v[104:107], v[120:123], v[48:51], v[104:107]
  v_mfma_f32_16x16x32_bf16 v[108:111], v[124:127], v[48:51], v[108:111]
  ds_read_b128 v[120:123], v11 offset:0
  ds_read_b128 v[124:127], v11 offset:2048
  ds_read_b64_tr_b16 v[40:41], v5 offset:24576
  ds_read_b64_tr_b16 v[42:43], v5 offset:26112
  s_waitcnt lgkmcnt(10)
  v_mfma_f32_16x16x32_bf16 v[56:59], v[24:27], v[112:115], v[56:59]
  v_mfma_f32_16x16x32_bf16 v[60:63], v[24:27], v[116:119], v[60:63]
  ds_read_b64_tr_b16 v[44:45], v6 offset:24576
  ds_read_b64_tr_b16 v[46:47], v6 offset:26112
  s_waitcnt lgkmcnt(10)
  v_mfma_f32_16x16x32_bf16 v[64:67], v[28:31], v[112:115], v[64:67]
  v_mfma_f32_16x16x32_bf16 v[68:71], v[28:31], v[116:119], v[68:71]
  ds_read_b64_tr_b16 v[48:49], v7 offset:24576
  ds_read_b64_tr_b16 v[50:51], v7 offset:26112
  s_waitcnt lgkmcnt(10)
  v_mfma_f32_16x16x32_bf16 v[72:75], v[32:35], v[112:115], v[72:75]
  v_mfma_f32_16x16x32_bf16 v[76:79], v[32:35], v[116:119], v[76:79]
  ds_read_b64_tr_b16 v[24:25], v1 offset:36864
  ds_read_b64_tr_b16 v[26:27], v1 offset:38400
  s_waitcnt lgkmcnt(10)
  v_mfma_f32_16x16x32_bf16 v[80:83], v[36:39], v[112:115], v[80:83]
  v_mfma_f32_16x16x32_bf16 v[84:87], v[36:39], v[116:119], v[84:87]
  ds_read_b64_tr_b16 v[28:29], v2 offset:36864
  ds_read_b64_tr_b16 v[30:31], v2 offset:38400
  s_waitcnt lgkmcnt(8)
  v_mfma_f32_16x16x32_bf16 v[88:91], v[112:115], v[40:43], v[88:91]
  v_mfma_f32_16x16x32_bf16 v[92:95], v[116:119], v[40:43], v[92:95]
  ds_read_b64_tr_b16 v[32:33], v3 offset:36864
  ds_read_b64_tr_b16 v[34:35], v3 offset:38400
  s_waitcnt lgkmcnt(8)
  v_mfma_f32_16x16x32_bf16 v[96:99], v[112:115], v[44:47], v[96:99]
  v_mfma_f32_16x16x32_bf16 v[100:103], v[116:119], v[44:47], v[100:103]
  ds_read_b64_tr_b16 v[36:37], v4 offset:36864
  ds_read_b64_tr_b16 v[38:39], v4 offset:38400
  s_waitcnt lgkmcnt(8)
  v_mfma_f32_16x16x32_bf16 v[104:107], v[112:115], v[48:51], v[104:107]
  v_mfma_f32_16x16x32_bf16 v[108:111], v[116:119], v[48:51], v[108:111]
  ds_read_b64_tr_b16 v[40:41], v5 offset:36864
  ds_read_b64_tr_b16 v[42:43], v5 offset:38400
  s_waitcnt lgkmcnt(8)
  v_mfma_f32_16x16x32_bf16 v[56:59], v[24:27], v[120:123], v[56:59]
  v_mfma_f32_16x16x32_bf16 v[60:63], v[24:27], v[124:127], v[60:63]
  ds_read_b64_tr_b16 v[44:45], v6 offset:36864
  ds_read_b64_tr_b16 v[46:47], v6 offset:38400
  s_waitcnt lgkmcnt(8)
  v_mfma_f32_16x16x32_bf16 v[64:67], v[28:31], v[120:123], v[64:67]
  v_mfma_f32_16x16x32_bf16 v[68:71], v[28:31], v[124:127], v[68:71]
  ds_read_b64_tr_b16 v[48:49], v7 offset:36864
  ds_read_b64_tr_b16 v[50:51], v7 offset:38400
  s_waitcnt lgkmcnt(8)
  v_mfma_f32_16x16x32_bf16 v[72:75], v[32:35], v[120:123], v[72:75]
  v_mfma_f32_16x16x32_bf16 v[76:79], v[32:35], v[124:127], v[76:79]
  s_waitcnt lgkmcnt(0)
  s_barrier
  ds_read_b64_tr_b16 v[24:25], v1 offset:49152
  ds_read_b64_tr_b16 v[26:27], v1 offset:50688
  ds_read_b128 v[112:115], v12 offset:0
  ds_read_b128 v[116:119], v12 offset:2048
  v_mfma_f32_16x16x32_bf16 v[80:83], v[36:39], v[120:123], v[80:83]
  v_mfma_f32_16x16x32_bf16 v[84:87], v[36:39], v[124:127], v[84:87]
  ds_read_b64_tr_b16 v[28:29], v2 offset:49152
  ds_read_b64_tr_b16 v[30:31], v2 offset:50688
  v_mfma_f32_16x16x32_bf16 v[88:91], v[120:123], v[40:43], v[88:91]
  v_mfma_f32_16x16x32_bf16 v[92:95], v[124:127], v[40:43], v[92:95]
  ds_read_b64_tr_b16 v[32:33], v3 offset:49152
  ds_read_b64_tr_b16 v[34:35], v3 offset:50688
  v_mfma_f32_16x16x32_bf16 v[96:99], v[120:123], v[44:47], v[96:99]
  v_mfma_f32_16x16x32_bf16 v[100:103], v[124:127], v[44:47], v[100:103]
  ds_read_b64_tr_b16 v[36:37], v4 offset:49152
  ds_read_b64_tr_b16 v[38:39], v4 offset:50688
  v_mfma_f32_16x16x32_bf16 v[104:107], v[120:123], v[48:51], v[104:107]
  v_mfma_f32_16x16x32_bf16 v[108:111], v[124:127], v[48:51], v[108:111]
  ds_read_b128 v[120:123], v13 offset:0
  ds_read_b128 v[124:127], v13 offset:2048
  ds_read_b64_tr_b16 v[40:41], v5 offset:49152
  ds_read_b64_tr_b16 v[42:43], v5 offset:50688
  s_waitcnt lgkmcnt(10)
  v_mfma_f32_16x16x32_bf16 v[56:59], v[24:27], v[112:115], v[56:59]
  v_mfma_f32_16x16x32_bf16 v[60:63], v[24:27], v[116:119], v[60:63]
  ds_read_b64_tr_b16 v[44:45], v6 offset:49152
  ds_read_b64_tr_b16 v[46:47], v6 offset:50688
  s_waitcnt lgkmcnt(10)
  v_mfma_f32_16x16x32_bf16 v[64:67], v[28:31], v[112:115], v[64:67]
  v_mfma_f32_16x16x32_bf16 v[68:71], v[28:31], v[116:119], v[68:71]
  ds_read_b64_tr_b16 v[48:49], v7 offset:49152
  ds_read_b64_tr_b16 v[50:51], v7 offset:50688
  s_waitcnt lgkmcnt(10)
  v_mfma_f32_16x16x32_bf16 v[72:75], v[32:35], v[112:115], v[72:75]
  v_mfma_f32_16x16x32_bf16 v[76:79], v[32:35], v[116:119], v[76:79]
  ds_read_b64_tr_b16 v[24:25], v1 offset:61440
  ds_read_b64_tr_b16 v[26:27], v1 offset:62976
  s_waitcnt lgkmcnt(10)
  v_mfma_f32_16x16x32_bf16 v[80:83], v[36:39], v[112:115], v[80:83]
  v_mfma_f32_16x16x32_bf16 v[84:87], v[36:39], v[116:119], v[84:87]
  ds_read_b64_tr_b16 v[28:29], v2 offset:61440
  ds_read_b64_tr_b16 v[30:31], v2 offset:62976
  s_waitcnt lgkmcnt(8)
  v_mfma_f32_16x16x32_bf16 v[88:91], v[112:115], v[40:43], v[88:91]
  v_mfma_f32_16x16x32_bf16 v[92:95], v[116:119], v[40:43], v[92:95]
  ds_read_b64_tr_b16 v[32:33], v3 offset:61440
  ds_read_b64_tr_b16 v[34:35], v3 offset:62976
  s_waitcnt lgkmcnt(8)
  v_mfma_f32_16x16x32_bf16 v[96:99], v[112:115], v[44:47], v[96:99]
  v_mfma_f32_16x16x32_bf16 v[100:103], v[116:119], v[44:47], v[100:103]
  ds_read_b64_tr_b16 v[36:37], v4 offset:61440
  ds_read_b64_tr_b16 v[38:39], v4 offset:62976
  s_waitcnt lgkmcnt(8)
  v_mfma_f32_16x16x32_bf16 v[104:107], v[112:115], v[48:51], v[104:107]
  v_mfma_f32_16x16x32_bf16 v[108:111], v[116:119], v[48:51], v[108:111]
  ds_read_b64_tr_b16 v[40:41], v5 offset:61440
  ds_read_b64_tr_b16 v[42:43], v5 offset:62976
  s_waitcnt lgkmcnt(8)
  v_mfma_f32_16x16x32_bf16 v[56:59], v[24:27], v[120:123], v[56:59]
  v_mfma_f32_16x16x32_bf16 v[60:63], v[24:27], v[124:127], v[60:63]
  ds_read_b64_tr_b16 v[44:45], v6 offset:61440
  ds_read_b64_tr_b16 v[46:47], v6 offset:62976
  s_waitcnt lgkmcnt(8)
  v_mfma_f32_16x16x32_bf16 v[64:67], v[28:31], v[120:123], v[64:67]
  v_mfma_f32_16x16x32_bf16 v[68:71], v[28:31], v[124:127], v[68:71]
  ds_read_b64_tr_b16 v[48:49], v7 offset:61440
  ds_read_b64_tr_b16 v[50:51], v7 offset:62976
  s_waitcnt lgkmcnt(8)
  v_mfma_f32_16x16x32_bf16 v[72:75], v[32:35], v[120:123], v[72:75]
  v_mfma_f32_16x16x32_bf16 v[76:79], v[32:35], v[124:127], v[76:79]
  s_waitcnt lgkmcnt(0)
  v_mfma_f32_16x16x32_bf16 v[80:83], v[36:39], v[120:123], v[80:83]
  v_mfma_f32_16x16x32_bf16 v[84:87], v[36:39], v[124:127], v[84:87]
  v_mfma_f32_16x16x32_bf16 v[88:91], v[120:123], v[40:43], v[88:91]
  v_mfma_f32_16x16x32_bf16 v[92:95], v[124:127], v[40:43], v[92:95]
  v_mfma_f32_16x16x32_bf16 v[96:99], v[120:123], v[44:47], v[96:99]
  v_mfma_f32_16x16x32_bf16 v[100:103], v[124:127], v[44:47], v[100:103]
  v_mfma_f32_16x16x32_bf16 v[104:107], v[120:123], v[48:51], v[104:107]
  v_mfma_f32_16x16x32_bf16 v[108:111], v[124:127], v[48:51], v[108:111]
  s_nop 7
  s_cmp_eq_u32 s47, 1
  s_cbranch_scc0 qkv_ns2_0
  v_pk_mul_f32 v[56:57], v[56:57], s[50:51]
  v_pk_mul_f32 v[58:59], v[58:59], s[50:51]
  v_pk_mul_f32 v[60:61], v[60:61], s[50:51]
  v_pk_mul_f32 v[62:63], v[62:63], s[50:51]
  v_pk_mul_f32 v[64:65], v[64:65], s[50:51]
  v_pk_mul_f32 v[66:67], v[66:67], s[50:51]
  v_pk_mul_f32 v[68:69], v[68:69], s[50:51]
  v_pk_mul_f32 v[70:71], v[70:71], s[50:51]
qkv_ns2_0:
  s_cmp_eq_u32 s47, 2
  s_cbranch_scc0 qkv_np2_0
  v_pk_fma_f32 v[160:161], v[56:57], s[52:53], v[22:23]
  v_pk_fma_f32 v[162:163], v[58:59], s[52:53], v[22:23]
  v_pk_fma_f32 v[164:165], v[60:61], s[52:53], v[22:23]
  v_pk_fma_f32 v[166:167], v[62:63], s[52:53], v[22:23]
  v_pk_fma_f32 v[168:169], v[64:65], s[52:53], v[22:23]
  v_pk_fma_f32 v[170:171], v[66:67], s[52:53], v[22:23]
  v_pk_fma_f32 v[172:173], v[68:69], s[52:53], v[22:23]
  v_pk_fma_f32 v[174:175], v[70:71], s[52:53], v[22:23]
  v_exp_f32_e64 v160, v160 clamp
  v_max_f32 v56, s54, v56
  v_exp_f32_e64 v161, v161 clamp
  v_max_f32 v57, s54, v57
  v_exp_f32_e64 v162, v162 clamp
  v_max_f32 v58, s54, v58
  v_exp_f32_e64 v163, v163 clamp
  v_max_f32 v59, s54, v59
  v_exp_f32_e64 v164, v164 clamp
  v_max_f32 v60, s54, v60
  v_exp_f32_e64 v165, v165 clamp
  v_max_f32 v61, s54, v61
  v_exp_f32_e64 v166, v166 clamp
  v_max_f32 v62, s54, v62
  v_exp_f32_e64 v167, v167 clamp
  v_max_f32 v63, s54, v63
  v_exp_f32_e64 v168, v168 clamp
  v_max_f32 v64, s54, v64
  v_exp_f32_e64 v169, v169 clamp
  v_max_f32 v65, s54, v65
  v_exp_f32_e64 v170, v170 clamp
  v_max_f32 v66, s54, v66
  v_exp_f32_e64 v171, v171 clamp
  v_max_f32 v67, s54, v67
  v_exp_f32_e64 v172, v172 clamp
  v_max_f32 v68, s54, v68
  v_exp_f32_e64 v173, v173 clamp
  v_max_f32 v69, s54, v69
  v_exp_f32_e64 v174, v174 clamp
  v_max_f32 v70, s54, v70
  v_exp_f32_e64 v175, v175 clamp
  v_max_f32 v71, s54, v71
  v_pk_add_f32 v[56:57], v[56:57], v[160:161]
  v_pk_add_f32 v[58:59], v[58:59], v[162:163]
  v_pk_add_f32 v[60:61], v[60:61], v[164:165]
  v_pk_add_f32 v[62:63], v[62:63], v[166:167]
  v_pk_add_f32 v[64:65], v[64:65], v[168:169]
  v_pk_add_f32 v[66:67], v[66:67], v[170:171]
  v_pk_add_f32 v[68:69], v[68:69], v[172:173]
  v_pk_add_f32 v[70:71], v[70:71], v[174:175]
qkv_np2_0:
  v_cvt_pk_bf16_f32 v128, v56, v57
  v_cvt_pk_bf16_f32 v129, v58, v59
  v_cvt_pk_bf16_f32 v130, v60, v61
  v_cvt_pk_bf16_f32 v131, v62, v63
  s_nop 0
  v_permlane32_swap_b32 v128, v130
  v_permlane32_swap_b32 v129, v131
  buffer_store_dwordx4 v[128:131], v16, s[16:19], s41 offen sc1
  s_add_u32 s56, s41, s44
  v_cvt_pk_bf16_f32 v132, v64, v65
  v_cvt_pk_bf16_f32 v133, v66, v67
  v_cvt_pk_bf16_f32 v134, v68, v69
  v_cvt_pk_bf16_f32 v135, v70, v71
  s_nop 0
  v_permlane32_swap_b32 v132, v134
  v_permlane32_swap_b32 v133, v135
  buffer_store_dwordx4 v[132:135], v16, s[16:19], s56 offen sc1
  s_cmp_eq_u32 s48, 1
  s_cbranch_scc0 qkv_ns2_1
  v_pk_mul_f32 v[72:73], v[72:73], s[50:51]
  v_pk_mul_f32 v[74:75], v[74:75], s[50:51]
  v_pk_mul_f32 v[76:77], v[76:77], s[50:51]
  v_pk_mul_f32 v[78:79], v[78:79], s[50:51]
  v_pk_mul_f32 v[80:81], v[80:81], s[50:51]
  v_pk_mul_f32 v[82:83], v[82:83], s[50:51]
  v_pk_mul_f32 v[84:85], v[84:85], s[50:51]
  v_pk_mul_f32 v[86:87], v[86:87], s[50:51]
qkv_ns2_1:
  s_cmp_eq_u32 s48, 2
  s_cbranch_scc0 qkv_np2_1
  v_pk_fma_f32 v[160:161], v[72:73], s[52:53], v[22:23]
  v_pk_fma_f32 v[162:163], v[74:75], s[52:53], v[22:23]
  v_pk_fma_f32 v[164:165], v[76:77], s[52:53], v[22:23]
  v_pk_fma_f32 v[166:167], v[78:79], s[52:53], v[22:23]
  v_pk_fma_f32 v[168:169], v[80:81], s[52:53], v[22:23]
  v_pk_fma_f32 v[170:171], v[82:83], s[52:53], v[22:23]
  v_pk_fma_f32 v[172:173], v[84:85], s[52:53], v[22:23]
  v_pk_fma_f32 v[174:175], v[86:87], s[52:53], v[22:23]
  v_exp_f32_e64 v160, v160 clamp
  v_max_f32 v72, s54, v72
  v_exp_f32_e64 v161, v161 clamp
  v_max_f32 v73, s54, v73
  v_exp_f32_e64 v162, v162 clamp
  v_max_f32 v74, s54, v74
  v_exp_f32_e64 v163, v163 clamp
  v_max_f32 v75, s54, v75
  v_exp_f32_e64 v164, v164 clamp
  v_max_f32 v76, s54, v76
  v_exp_f32_e64 v165, v165 clamp
  v_max_f32 v77, s54, v77
  v_exp_f32_e64 v166, v166 clamp
  v_max_f32 v78, s54, v78
  v_exp_f32_e64 v167, v167 clamp
  v_max_f32 v79, s54, v79
  v_exp_f32_e64 v168, v168 clamp
  v_max_f32 v80, s54, v80
  v_exp_f32_e64 v169, v169 clamp
  v_max_f32 v81, s54, v81
  v_exp_f32_e64 v170, v170 clamp
  v_max_f32 v82, s54, v82
  v_exp_f32_e64 v171, v171 clamp
  v_max_f32 v83, s54, v83
  v_exp_f32_e64 v172, v172 clamp
  v_max_f32 v84, s54, v84
  v_exp_f32_e64 v173, v173 clamp
  v_max_f32 v85, s54, v85
  v_exp_f32_e64 v174, v174 clamp
  v_max_f32 v86, s54, v86
  v_exp_f32_e64 v175, v175 clamp
  v_max_f32 v87, s54, v87
  v_pk_add_f32 v[72:73], v[72:73], v[160:161]
  v_pk_add_f32 v[74:75], v[74:75], v[162:163]
  v_pk_add_f32 v[76:77], v[76:77], v[164:165]
  v_pk_add_f32 v[78:79], v[78:79], v[166:167]
  v_pk_add_f32 v[80:81], v[80:81], v[168:169]
  v_pk_add_f32 v[82:83], v[82:83], v[170:171]
  v_pk_add_f32 v[84:85], v[84:85], v[172:173]
  v_pk_add_f32 v[86:87], v[86:87], v[174:175]
qkv_np2_1:
  v_cvt_pk_bf16_f32 v136, v72, v73
  v_cvt_pk_bf16_f32 v137, v74, v75
  v_cvt_pk_bf16_f32 v138, v76, v77
  v_cvt_pk_bf16_f32 v139, v78, v79
  s_nop 0
  v_permlane32_swap_b32 v136, v138
  v_permlane32_swap_b32 v137, v139
  buffer_store_dwordx4 v[136:139], v16, s[16:19], s42 offen sc1
  s_add_u32 s56, s42, s45
  v_cvt_pk_bf16_f32 v140, v80, v81
  v_cvt_pk_bf16_f32 v141, v82, v83
  v_cvt_pk_bf16_f32 v142, v84, v85
  v_cvt_pk_bf16_f32 v143, v86, v87
  s_nop 0
  v_permlane32_swap_b32 v140, v142
  v_permlane32_swap_b32 v141, v143
  buffer_store_dwordx4 v[140:143], v16, s[16:19], s56 offen sc1
  s_cmp_eq_u32 s49, 2
  s_cbranch_scc0 qkv_np2_2
  v_pk_fma_f32 v[160:161], v[88:89], s[52:53], v[22:23]
  v_pk_fma_f32 v[162:163], v[90:91], s[52:53], v[22:23]
  v_pk_fma_f32 v[164:165], v[92:93], s[52:53], v[22:23]
  v_pk_fma_f32 v[166:167], v[94:95], s[52:53], v[22:23]
  v_pk_fma_f32 v[168:169], v[96:97], s[52:53], v[22:23]
  v_pk_fma_f32 v[170:171], v[98:99], s[52:53], v[22:23]
  v_pk_fma_f32 v[172:173], v[100:101], s[52:53], v[22:23]
  v_pk_fma_f32 v[174:175], v[102:103], s[52:53], v[22:23]
  v_exp_f32_e64 v160, v160 clamp
  v_max_f32 v88, s54, v88
  v_exp_f32_e64 v161, v161 clamp
  v_max_f32 v89, s54, v89
  v_exp_f32_e64 v162, v162 clamp
  v_max_f32 v90, s54, v90
  v_exp_f32_e64 v163, v163 clamp
  v_max_f32 v91, s54, v91
  v_exp_f32_e64 v164, v164 clamp
  v_max_f32 v92, s54, v92
  v_exp_f32_e64 v165, v165 clamp
  v_max_f32 v93, s54, v93
  v_exp_f32_e64 v166, v166 clamp
  v_max_f32 v94, s54, v94
  v_exp_f32_e64 v167, v167 clamp
  v_max_f32 v95, s54, v95
  v_exp_f32_e64 v168, v168 clamp
  v_max_f32 v96, s54, v96
  v_exp_f32_e64 v169, v169 clamp
  v_max_f32 v97, s54, v97
  v_exp_f32_e64 v170, v170 clamp
  v_max_f32 v98, s54, v98
  v_exp_f32_e64 v171, v171 clamp
  v_max_f32 v99, s54, v99
  v_exp_f32_e64 v172, v172 clamp
  v_max_f32 v100, s54, v100
  v_exp_f32_e64 v173, v173 clamp
  v_max_f32 v101, s54, v101
  v_exp_f32_e64 v174, v174 clamp
  v_max_f32 v102, s54, v102
  v_exp_f32_e64 v175, v175 clamp
  v_max_f32 v103, s54, v103
  v_pk_add_f32 v[88:89], v[88:89], v[160:161]
  v_pk_add_f32 v[90:91], v[90:91], v[162:163]
  v_pk_add_f32 v[92:93], v[92:93], v[164:165]
  v_pk_add_f32 v[94:95], v[94:95], v[166:167]
  v_pk_add_f32 v[96:97], v[96:97], v[168:169]
  v_pk_add_f32 v[98:99], v[98:99], v[170:171]
  v_pk_add_f32 v[100:101], v[100:101], v[172:173]
  v_pk_add_f32 v[102:103], v[102:103], v[174:175]
qkv_np2_2:
  v_cvt_pk_bf16_f32 v144, v88, v89
  v_cvt_pk_bf16_f32 v145, v90, v91
  v_cvt_pk_bf16_f32 v146, v92, v93
  v_cvt_pk_bf16_f32 v147, v94, v95
  s_nop 0
  v_permlane32_swap_b32 v144, v146
  v_permlane32_swap_b32 v145, v147
  buffer_store_dwordx4 v[144:147], v17, s[16:19], s43 offen sc1
  s_add_u32 s56, s43, s46
  v_cvt_pk_bf16_f32 v148, v96, v97
  v_cvt_pk_bf16_f32 v149, v98, v99
  v_cvt_pk_bf16_f32 v150, v100, v101
  v_cvt_pk_bf16_f32 v151, v102, v103
  s_nop 0
  v_permlane32_swap_b32 v148, v150
  v_permlane32_swap_b32 v149, v151
  buffer_store_dwordx4 v[148:151], v17, s[16:19], s56 offen sc1
  v_mul_f32 v104, v20, v104
  v_mul_f32 v105, v20, v105
  v_mul_f32 v106, v20, v106
  v_mul_f32 v107, v20, v107
  v_mul_f32 v108, v20, v108
  v_mul_f32 v109, v20, v109
  v_mul_f32 v110, v20, v110
  v_mul_f32 v111, v20, v111
  s_cmp_eq_u32 s20, 0
  s_cbranch_scc1 qkv_xp2
  v_pk_mul_f32 v[176:177], v[104:105], 1.0 op_sel_hi:[1,0]
  v_pk_mul_f32 v[178:179], v[106:107], 1.0 op_sel_hi:[1,0]
  v_pk_mul_f32 v[180:181], v[108:109], 1.0 op_sel_hi:[1,0]
  v_pk_mul_f32 v[182:183], v[110:111], 1.0 op_sel_hi:[1,0]
  v_pk_fma_f32 v[160:161], v[176:177], s[52:53], v[22:23]
  v_pk_fma_f32 v[162:163], v[178:179], s[52:53], v[22:23]
  v_pk_fma_f32 v[164:165], v[180:181], s[52:53], v[22:23]
  v_pk_fma_f32 v[166:167], v[182:183], s[52:53], v[22:23]
  v_exp_f32_e64 v160, v160 clamp
  v_max_f32 v176, s54, v176
  v_exp_f32_e64 v161, v161 clamp
  v_max_f32 v177, s54, v177
  v_exp_f32_e64 v162, v162 clamp
  v_max_f32 v178, s54, v178
  v_exp_f32_e64 v163, v163 clamp
  v_max_f32 v179, s54, v179
  v_exp_f32_e64 v164, v164 clamp
  v_max_f32 v180, s54, v180
  v_exp_f32_e64 v165, v165 clamp
  v_max_f32 v181, s54, v181
  v_exp_f32_e64 v166, v166 clamp
  v_max_f32 v182, s54, v182
  v_exp_f32_e64 v167, v167 clamp
  v_max_f32 v183, s54, v183
  v_pk_add_f32 v[176:177], v[176:177], v[160:161]
  v_pk_add_f32 v[178:179], v[178:179], v[162:163]
  v_pk_add_f32 v[180:181], v[180:181], v[164:165]
  v_pk_add_f32 v[182:183], v[182:183], v[166:167]
  v_cmp_eq_u32 vcc, 1, v21
  s_nop 1
  v_cndmask_b32 v104, v104, v176, vcc
  v_cndmask_b32 v105, v105, v177, vcc
  v_cndmask_b32 v106, v106, v178, vcc
  v_cndmask_b32 v107, v107, v179, vcc
  v_cndmask_b32 v108, v108, v180, vcc
  v_cndmask_b32 v109, v109, v181, vcc
  v_cndmask_b32 v110, v110, v182, vcc
  v_cndmask_b32 v111, v111, v183, vcc
qkv_xp2:
  v_cvt_pk_bf16_f32 v152, v104, v105
  v_cvt_pk_bf16_f32 v153, v106, v107
  v_cvt_pk_bf16_f32 v154, v108, v109
  v_cvt_pk_bf16_f32 v155, v110, v111
  s_nop 0
  v_permlane32_swap_b32 v152, v154
  v_permlane32_swap_b32 v153, v155
  buffer_store_dwordx4 v[152:155], v19, s[16:19], 0 offen sc1
  v_cmp_ne_u32 vcc, 0, v52
  s_nop 1
  v_cndmask_b32 v128, v104, v108, vcc
  v_cndmask_b32 v132, v108, v104, vcc
  v_cndmask_b32 v129, v105, v109, vcc
  v_cndmask_b32 v133, v109, v105, vcc
  v_cndmask_b32 v130, v106, v110, vcc
  v_cndmask_b32 v134, v110, v106, vcc
  v_cndmask_b32 v131, v107, v111, vcc
  v_cndmask_b32 v135, v111, v107, vcc
  s_nop 0
  v_mov_b32_dpp v156, v132 quad_perm:[1,0,3,2] row_mask:0xf bank_mask:0xf
  v_mov_b32_dpp v157, v133 quad_perm:[1,0,3,2] row_mask:0xf bank_mask:0xf
  v_mov_b32_dpp v158, v134 quad_perm:[1,0,3,2] row_mask:0xf bank_mask:0xf
  v_mov_b32_dpp v159, v135 quad_perm:[1,0,3,2] row_mask:0xf bank_mask:0xf
  v_cndmask_b32 v132, v128, v156, vcc
  v_cndmask_b32 v128, v156, v128, vcc
  v_cndmask_b32 v133, v129, v157, vcc
  v_cndmask_b32 v129, v157, v129, vcc
  v_cndmask_b32 v134, v130, v158, vcc
  v_cndmask_b32 v130, v158, v130, vcc
  v_cndmask_b32 v135, v131, v159, vcc
  v_cndmask_b32 v131, v159, v131, vcc
  v_cvt_pk_bf16_f32 v136, v132, v128
  v_cvt_pk_bf16_f32 v137, v133, v129
  v_cvt_pk_bf16_f32 v138, v134, v130
  v_cvt_pk_bf16_f32 v139, v135, v131
  buffer_store_dwordx4 v[136:139], v18, s[16:19], 0 offen sc1
  s_branch qkv_passend
qkv_v3:
  s_waitcnt lgkmcnt(0)
  s_barrier
  ds_read_b64_tr_b16 v[24:25], v1 offset:0
  ds_read_b64_tr_b16 v[26:27], v1 offset:1536
  ds_read_b128 v[112:115], v8 offset:0
  ds_read_b128 v[116:119], v8 offset:2048
  ds_read_b64_tr_b16 v[28:29], v2 offset:0
  ds_read_b64_tr_b16 v[30:31], v2 offset:1536
  ds_read_b64_tr_b16 v[32:33], v3 offset:0
  ds_read_b64_tr_b16 v[34:35], v3 offset:1536
  ds_read_b64_tr_b16 v[36:37], v4 offset:0
  ds_read_b64_tr_b16 v[38:39], v4 offset:1536
  ds_read_b128 v[120:123], v9 offset:0
  ds_read_b128 v[124:127], v9 offset:2048
  ds_read_b64_tr_b16 v[40:41], v5 offset:0
  ds_read_b64_tr_b16 v[42:43], v5 offset:1536
  s_waitcnt lgkmcnt(10)
  v_mfma_f32_16x16x32_bf16 v[56:59], v[24:27], v[112:115], v[208:211]
  v_mfma_f32_16x16x32_bf16 v[60:63], v[24:27], v[116:119], v[208:211]
  ds_read_b64_tr_b16 v[44:45], v6 offset:0
  ds_read_b64_tr_b16 v[46:47], v6 offset:1536
  s_waitcnt lgkmcnt(10)
  v_mfma_f32_16x16x32_bf16 v[64:67], v[28:31], v[112:115], v[208:211]
  v_mfma_f32_16x16x32_bf16 v[68:71], v[28:31], v[116:119], v[208:211]
  ds_read_b64_tr_b16 v[48:49], v7 offset:0
  ds_read_b64_tr_b16 v[50:51], v7 offset:1536
  s_waitcnt lgkmcnt(10)
  v_mfma_f32_16x16x32_bf16 v[72:75], v[32:35], v[112:115], v[212:215]
  v_mfma_f32_16x16x32_bf16 v[76:79], v[32:35], v[116:119], v[212:215]
  ds_read_b64_tr_b16 v[24:25], v1 offset:12288
  ds_read_b64_tr_b16 v[26:27], v1 offset:13824
  s_waitcnt lgkmcnt(10)
  v_mfma_f32_16x16x32_bf16 v[80:83], v[36:39], v[112:115], v[212:215]
  v_mfma_f32_16x16x32_bf16 v[84:87], v[36:39], v[116:119], v[212:215]
  ds_read_b64_tr_b16 v[28:29], v2 offset:12288
  ds_read_b64_tr_b16 v[30:31], v2 offset:13824
  s_waitcnt lgkmcnt(8)
  v_mfma_f32_16x16x32_bf16 v[88:91], v[40:43], v[112:115], v[216:219]
  v_mfma_f32_16x16x32_bf16 v[92:95], v[40:43], v[116:119], v[216:219]
  ds_read_b64_tr_b16 v[32:33], v3 offset:12288
  ds_read_b64_tr_b16 v[34:35], v3 offset:13824
  s_waitcnt lgkmcnt(8)
  v_mfma_f32_16x16x32_bf16 v[96:99], v[44:47], v[112:115], v[216:219]
  v_mfma_f32_16x16x32_bf16 v[100:103], v[44:47], v[116:119], v[216:219]
  ds_read_b64_tr_b16 v[36:37], v4 offset:12288
  ds_read_b64_tr_b16 v[38:39], v4 offset:13824
  s_waitcnt lgkmcnt(8)
  v_mfma_f32_16x16x32_bf16 v[104:107], v[112:115], v[48:51], v[220:223]
  v_mfma_f32_16x16x32_bf16 v[108:111], v[116:119], v[48:51], v[220:223]
  ds_read_b64_tr_b16 v[40:41], v5 offset:12288
  ds_read_b64_tr_b16 v[42:43], v5 offset:13824
  s_waitcnt lgkmcnt(8)
  v_mfma_f32_16x16x32_bf16 v[56:59], v[24:27], v[120:123], v[56:59]
  v_mfma_f32_16x16x32_bf16 v[60:63], v[24:27], v[124:127], v[60:63]
  ds_read_b64_tr_b16 v[44:45], v6 offset:12288
  ds_read_b64_tr_b16 v[46:47], v6 offset:13824
  s_waitcnt lgkmcnt(8)
  v_mfma_f32_16x16x32_bf16 v[64:67], v[28:31], v[120:123], v[64:67]
  v_mfma_f32_16x16x32_bf16 v[68:71], v[28:31], v[124:127], v[68:71]
  ds_read_b64_tr_b16 v[48:49], v7 offset:12288
  ds_read_b64_tr_b16 v[50:51], v7 offset:13824
  s_waitcnt lgkmcnt(8)
  v_mfma_f32_16x16x32_bf16 v[72:75], v[32:35], v[120:123], v[72:75]
  v_mfma_f32_16x16x32_bf16 v[76:79], v[32:35], v[124:127], v[76:79]
  s_waitcnt lgkmcnt(0)
  s_barrier
  ds_read_b64_tr_b16 v[24:25], v1 offset:24576
  ds_read_b64_tr_b16 v[26:27], v1 offset:26112
  ds_read_b128 v[112:115], v10 offset:0
  ds_read_b128 v[116:119], v10 offset:2048
  v_mfma_f32_16x16x32_bf16 v[80:83], v[36:39], v[120:123], v[80:83]
  v_mfma_f32_16x16x32_bf16 v[84:87], v[36:39], v[124:127], v[84:87]
  v_lshrrev_b32 v160, 2, v14
  v_cmp_eq_u32 vcc, 1, v160
  v_cmp_le_u32 s[58:59], 2, v160
  s_nop 0
  v_mov_b32 v161, s41
  ds_read_b64_tr_b16 v[28:29], v2 offset:24576
  ds_read_b64_tr_b16 v[30:31], v2 offset:26112
  v_mfma_f32_16x16x32_bf16 v[88:91], v[40:43], v[120:123], v[88:91]
  v_mfma_f32_16x16x32_bf16 v[92:95], v[40:43], v[124:127], v[92:95]
  v_mov_b32 v166, s42
  v_cndmask_b32 v161, v161, v166, vcc
  v_mov_b32 v166, s43
  v_cndmask_b32 v161, v161, v166, s[58:59]
  v_mov_b32 v162, s44
  ds_read_b64_tr_b16 v[32:33], v3 offset:24576
  ds_read_b64_tr_b16 v[34:35], v3 offset:26112
  v_mfma_f32_16x16x32_bf16 v[96:99], v[44:47], v[120:123], v[96:99]
  v_mfma_f32_16x16x32_bf16 v[100:103], v[44:47], v[124:127], v[100:103]
  v_mov_b32 v166, s45
  v_cndmask_b32 v162, v162, v166, vcc
  v_mov_b32 v166, s46
  v_cndmask_b32 v162, v162, v166, s[58:59]
  v_mov_b32 v163, s47
  ds_read_b64_tr_b16 v[36:37], v4 offset:24576
  ds_read_b64_tr_b16 v[38:39], v4 offset:26112
  v_mfma_f32_16x16x32_bf16 v[104:107], v[120:123], v[48:51], v[104:107]
  v_mfma_f32_16x16x32_bf16 v[108:111], v[124:127], v[48:51], v[108:111]
  v_mov_b32 v166, s48
  v_cndmask_b32 v163, v163, v166, vcc
  v_mov_b32 v166, s49
  v_cndmask_b32 v163, v163, v166, s[58:59]
  v_cmp_eq_u32 vcc, 2, v163
  ds_read_b128 v[120:123], v11 offset:0
  ds_read_b128 v[124:127], v11 offset:2048
  ds_read_b64_tr_b16 v[40:41], v5 offset:24576
  ds_read_b64_tr_b16 v[42:43], v5 offset:26112
  s_waitcnt lgkmcnt(10)
  v_mfma_f32_16x16x32_bf16 v[56:59], v[24:27], v[112:115], v[56:59]
  v_mfma_f32_16x16x32_bf16 v[60:63], v[24:27], v[116:119], v[60:63]
  v_mov_b32 v166, s50
  s_nop 0
  v_cndmask_b32 v21, 0, 1, vcc
  v_cmp_eq_u32 vcc, 1, v163
  v_and_b32 v160, 1, v15
  ds_read_b64_tr_b16 v[44:45], v6 offset:24576
  ds_read_b64_tr_b16 v[46:47], v6 offset:26112
  s_waitcnt lgkmcnt(10)
  v_mfma_f32_16x16x32_bf16 v[64:67], v[28:31], v[112:115], v[64:67]
  v_mfma_f32_16x16x32_bf16 v[68:71], v[28:31], v[116:119], v[68:71]
  v_lshrrev_b32 v164, 1, v15
  v_cndmask_b32 v20, 1.0, v166, vcc
  v_lshlrev_b32 v165, 9, v160
  v_lshl_add_u32 v165, v164, 8, v165
  v_lshl_add_u32 v16, v14, 4, v165
  ds_read_b64_tr_b16 v[48:49], v7 offset:24576
  ds_read_b64_tr_b16 v[50:51], v7 offset:26112
  s_waitcnt lgkmcnt(10)
  v_mfma_f32_16x16x32_bf16 v[72:75], v[32:35], v[112:115], v[72:75]
  v_mfma_f32_16x16x32_bf16 v[76:79], v[32:35], v[116:119], v[76:79]
  v_lshlrev_b32 v165, 8, v160
  v_lshl_add_u32 v165, v164, 9, v165
  v_lshl_add_u32 v17, v14, 4, v165
  v_lshlrev_b32 v165, 5, v160
  v_lshl_add_u32 v165, v164, 6, v165
  ds_read_b64_tr_b16 v[24:25], v1 offset:36864
  ds_read_b64_tr_b16 v[26:27], v1 offset:38400
  s_waitcnt lgkmcnt(10)
  v_mfma_f32_16x16x32_bf16 v[80:83], v[36:39], v[112:115], v[80:83]
  v_mfma_f32_16x16x32_bf16 v[84:87], v[36:39], v[116:119], v[84:87]
  v_bfe_u32 v166, v14, 1, 1
  v_mul_lo_u32 v167, v166, v162
  v_add_u32 v167, v167, v161
  v_and_b32 v168, 1, v14
  v_lshl_add_u32 v169, v168, 4, v165
  ds_read_b64_tr_b16 v[28:29], v2 offset:36864
  ds_read_b64_tr_b16 v[30:31], v2 offset:38400
  s_waitcnt lgkmcnt(8)
  v_mfma_f32_16x16x32_bf16 v[88:91], v[40:43], v[112:115], v[88:91]
  v_mfma_f32_16x16x32_bf16 v[92:95], v[40:43], v[116:119], v[92:95]
  v_add_u32 v169, 1024, v169
  v_add_u32 v169, v169, v167
  v_mov_b32 v170, 65536
  v_cmp_ne_u32 vcc, v162, v170
  v_cmp_gt_u32 s[58:59], 12, v14
  ds_read_b64_tr_b16 v[32:33], v3 offset:36864
  ds_read_b64_tr_b16 v[34:35], v3 offset:38400
  s_waitcnt lgkmcnt(8)
  v_mfma_f32_16x16x32_bf16 v[96:99], v[44:47], v[112:115], v[96:99]
  v_mfma_f32_16x16x32_bf16 v[100:103], v[44:47], v[116:119], v[100:103]
  v_mov_b32 v170, 2146435072
  s_and_b64 vcc, vcc, s[58:59]
  v_cndmask_b32 v19, v170, v169, vcc
  v_lshrrev_b32 v169, 3, v167
  v_lshrrev_b32 v171, 21, v167
  ds_read_b64_tr_b16 v[36:37], v4 offset:36864
  ds_read_b64_tr_b16 v[38:39], v4 offset:38400
  s_waitcnt lgkmcnt(8)
  v_mfma_f32_16x16x32_bf16 v[104:107], v[112:115], v[48:51], v[104:107]
  v_mfma_f32_16x16x32_bf16 v[108:111], v[116:119], v[48:51], v[108:111]
  v_mov_b32 v172, 0x400000
  v_mov_b32 v173, 0x820000
  v_cmp_le_u32 vcc, 3, v171
  v_lshl_add_u32 v169, v15, 4, v169
  v_mov_b32 v171, 65536
  ds_read_b64_tr_b16 v[40:41], v5 offset:36864
  ds_read_b64_tr_b16 v[42:43], v5 offset:38400
  s_waitcnt lgkmcnt(8)
  v_mfma_f32_16x16x32_bf16 v[56:59], v[24:27], v[120:123], v[56:59]
  v_mfma_f32_16x16x32_bf16 v[60:63], v[24:27], v[124:127], v[60:63]
  v_cndmask_b32 v172, v172, v173, vcc
  v_add_u32 v169, v169, v172
  v_lshl_add_u32 v169, v168, 6, v169
  v_cmp_eq_u32 vcc, v162, v171
  v_cmp_eq_u32 s[56:57], 1, v168
  ds_read_b64_tr_b16 v[44:45], v6 offset:36864
  ds_read_b64_tr_b16 v[46:47], v6 offset:38400
  s_waitcnt lgkmcnt(8)
  v_mfma_f32_16x16x32_bf16 v[64:67], v[28:31], v[120:123], v[64:67]
  v_mfma_f32_16x16x32_bf16 v[68:71], v[28:31], v[124:127], v[68:71]
  s_nop 0
  s_and_b64 vcc, vcc, s[58:59]
  v_cndmask_b32 v18, v170, v169, vcc
  v_cndmask_b32 v52, 0, -1, s[56:57]
  v_mov_b32 v22, 0xb5c1a2a0
  ds_read_b64_tr_b16 v[48:49], v7 offset:36864
  ds_read_b64_tr_b16 v[50:51], v7 offset:38400
  s_waitcnt lgkmcnt(8)
  v_mfma_f32_16x16x32_bf16 v[72:75], v[32:35], v[120:123], v[72:75]
  v_mfma_f32_16x16x32_bf16 v[76:79], v[32:35], v[124:127], v[76:79]
  v_mov_b32 v23, 0xb5c1a2a0
  s_cmp_eq_u32 s14, 2
  s_cselect_b32 s32, s54, 0
  v_mov_b32 v208, s32
  v_mov_b32 v209, s32
  s_waitcnt lgkmcnt(0)
  s_barrier
  ds_read_b64_tr_b16 v[24:25], v1 offset:49152
  ds_read_b64_tr_b16 v[26:27], v1 offset:50688
  ds_read_b128 v[112:115], v12 offset:0
  ds_read_b128 v[116:119], v12 offset:2048
  v_mfma_f32_16x16x32_bf16 v[80:83], v[36:39], v[120:123], v[80:83]
  v_mfma_f32_16x16x32_bf16 v[84:87], v[36:39], v[124:127], v[84:87]
  v_mov_b32 v210, s32
  v_mov_b32 v211, s32
  s_cmp_eq_u32 s15, 2
  s_cselect_b32 s32, s54, 0
  v_mov_b32 v212, s32
  ds_read_b64_tr_b16 v[28:29], v2 offset:49152
  ds_read_b64_tr_b16 v[30:31], v2 offset:50688
  v_mfma_f32_16x16x32_bf16 v[88:91], v[40:43], v[120:123], v[88:91]
  v_mfma_f32_16x16x32_bf16 v[92:95], v[40:43], v[124:127], v[92:95]
  v_mov_b32 v213, s32
  v_mov_b32 v214, s32
  v_mov_b32 v215, s32
  s_cmp_eq_u32 s55, 2
  s_cselect_b32 s32, s54, 0
  ds_read_b64_tr_b16 v[32:33], v3 offset:49152
  ds_read_b64_tr_b16 v[34:35], v3 offset:50688
  v_mfma_f32_16x16x32_bf16 v[96:99], v[44:47], v[120:123], v[96:99]
  v_mfma_f32_16x16x32_bf16 v[100:103], v[44:47], v[124:127], v[100:103]
  v_mov_b32 v216, s32
  v_mov_b32 v217, s32
  v_mov_b32 v218, s32
  v_mov_b32 v219, s32
  v_lshrrev_b32 v192, 2, v14
  ds_read_b64_tr_b16 v[36:37], v4 offset:49152
  ds_read_b64_tr_b16 v[38:39], v4 offset:50688
  v_mfma_f32_16x16x32_bf16 v[104:107], v[120:123], v[48:51], v[104:107]
  v_mfma_f32_16x16x32_bf16 v[108:111], v[124:127], v[48:51], v[108:111]
  v_cmp_eq_u32 vcc, 1, v192
  v_cmp_le_u32 s[58:59], 2, v192
  s_nop 0
  v_mov_b32 v193, s14
  v_mov_b32 v194, s15
  ds_read_b128 v[120:123], v13 offset:0
  ds_read_b128 v[124:127], v13 offset:2048
  ds_read_b64_tr_b16 v[40:41], v5 offset:49152
  ds_read_b64_tr_b16 v[42:43], v5 offset:50688
  s_waitcnt lgkmcnt(10)
  v_mfma_f32_16x16x32_bf16 v[56:59], v[24:27], v[112:115], v[56:59]
  v_mfma_f32_16x16x32_bf16 v[60:63], v[24:27], v[116:119], v[60:63]
  v_cndmask_b32 v193, v193, v194, vcc
  v_mov_b32 v194, s55
  v_cndmask_b32 v193, v193, v194, s[58:59]
  v_cmp_eq_u32 vcc, 2, v193
  v_mov_b32 v194, s54
  ds_read_b64_tr_b16 v[44:45], v6 offset:49152
  ds_read_b64_tr_b16 v[46:47], v6 offset:50688
  s_waitcnt lgkmcnt(10)
  v_mfma_f32_16x16x32_bf16 v[64:67], v[28:31], v[112:115], v[64:67]
  v_mfma_f32_16x16x32_bf16 v[68:71], v[28:31], v[116:119], v[68:71]
  s_nop 0
  v_cndmask_b32 v220, 0, v194, vcc
  v_mov_b32 v221, v220
  v_mov_b32 v222, v220
  v_mov_b32 v223, v220
  ds_read_b64_tr_b16 v[48:49], v7 offset:49152
  ds_read_b64_tr_b16 v[50:51], v7 offset:50688
  s_waitcnt lgkmcnt(10)
  v_mfma_f32_16x16x32_bf16 v[72:75], v[32:35], v[112:115], v[72:75]
  v_mfma_f32_16x16x32_bf16 v[76:79], v[32:35], v[116:119], v[76:79]
  ds_read_b64_tr_b16 v[24:25], v1 offset:61440
  ds_read_b64_tr_b16 v[26:27], v1 offset:62976
  s_waitcnt lgkmcnt(10)
  v_mfma_f32_16x16x32_bf16 v[80:83], v[36:39], v[112:115], v[80:83]
  v_mfma_f32_16x16x32_bf16 v[84:87], v[36:39], v[116:119], v[84:87]
  ds_read_b64_tr_b16 v[28:29], v2 offset:61440
  ds_read_b64_tr_b16 v[30:31], v2 offset:62976
  s_waitcnt lgkmcnt(8)
  v_mfma_f32_16x16x32_bf16 v[88:91], v[40:43], v[112:115], v[88:91]
  v_mfma_f32_16x16x32_bf16 v[92:95], v[40:43], v[116:119], v[92:95]
  ds_read_b64_tr_b16 v[32:33], v3 offset:61440
  ds_read_b64_tr_b16 v[34:35], v3 offset:62976
  s_waitcnt lgkmcnt(8)
  v_mfma_f32_16x16x32_bf16 v[96:99], v[44:47], v[112:115], v[96:99]
  v_mfma_f32_16x16x32_bf16 v[100:103], v[44:47], v[116:119], v[100:103]
  ds_read_b64_tr_b16 v[36:37], v4 offset:61440
  ds_read_b64_tr_b16 v[38:39], v4 offset:62976
  s_waitcnt lgkmcnt(8)
  v_mfma_f32_16x16x32_bf16 v[104:107], v[112:115], v[48:51], v[104:107]
  v_mfma_f32_16x16x32_bf16 v[108:111], v[116:119], v[48:51], v[108:111]
  ds_read_b64_tr_b16 v[40:41], v5 offset:61440
  ds_read_b64_tr_b16 v[42:43], v5 offset:62976
  s_waitcnt lgkmcnt(8)
  v_mfma_f32_16x16x32_bf16 v[56:59], v[24:27], v[120:123], v[56:59]
  v_mfma_f32_16x16x32_bf16 v[60:63], v[24:27], v[124:127], v[60:63]
  ds_read_b64_tr_b16 v[44:45], v6 offset:61440
  ds_read_b64_tr_b16 v[46:47], v6 offset:62976
  s_waitcnt lgkmcnt(8)
  v_mfma_f32_16x16x32_bf16 v[64:67], v[28:31], v[120:123], v[64:67]
  v_mfma_f32_16x16x32_bf16 v[68:71], v[28:31], v[124:127], v[68:71]
  ds_read_b64_tr_b16 v[48:49], v7 offset:61440
  ds_read_b64_tr_b16 v[50:51], v7 offset:62976
  s_waitcnt lgkmcnt(8)
  v_mfma_f32_16x16x32_bf16 v[72:75], v[32:35], v[120:123], v[72:75]
  v_mfma_f32_16x16x32_bf16 v[76:79], v[32:35], v[124:127], v[76:79]
  s_waitcnt lgkmcnt(0)
  s_barrier
  s_cmp_eq_u32 s20, 1
  s_cbranch_scc1 qkv_nopfm3
  s_mov_b32 s64, s26
  s_and_b32 s65, s27, 0xffff
  s_mov_b32 s66, 1990656
  s_mov_b32 s67, 0x00020000
  buffer_load_dword v204, v203, s[64:67], s34 offen
  s_mov_b32 s68, s24
  s_and_b32 s69, s25, 0xffff
  s_mov_b32 s70, 2359296
  s_mov_b32 s71, 0x00020000
  buffer_load_dword v205, v202, s[68:71], s35 offen
qkv_nopfm3:
  ds_read_b64_tr_b16 v[24:25], v1 offset:0
  ds_read_b64_tr_b16 v[26:27], v1 offset:1536
  ds_read_b128 v[112:115], v8 offset:0
  ds_read_b128 v[116:119], v8 offset:2048
  v_mfma_f32_16x16x32_bf16 v[80:83], v[36:39], v[120:123], v[80:83]
  v_mfma_f32_16x16x32_bf16 v[84:87], v[36:39], v[124:127], v[84:87]
  ds_read_b64_tr_b16 v[28:29], v2 offset:0
  ds_read_b64_tr_b16 v[30:31], v2 offset:1536
  v_mfma_f32_16x16x32_bf16 v[88:91], v[40:43], v[120:123], v[88:91]
  v_mfma_f32_16x16x32_bf16 v[92:95], v[40:43], v[124:127], v[92:95]
  ds_read_b64_tr_b16 v[32:33], v3 offset:0
  ds_read_b64_tr_b16 v[34:35], v3 offset:1536
  v_mfma_f32_16x16x32_bf16 v[96:99], v[44:47], v[120:123], v[96:99]
  v_mfma_f32_16x16x32_bf16 v[100:103], v[44:47], v[124:127], v[100:103]
  ds_read_b64_tr_b16 v[36:37], v4 offset:0
  ds_read_b64_tr_b16 v[38:39], v4 offset:1536
  v_mfma_f32_16x16x32_bf16 v[104:107], v[120:123], v[48:51], v[104:107]
  v_mfma_f32_16x16x32_bf16 v[108:111], v[124:127], v[48:51], v[108:111]
  ds_read_b128 v[120:123], v9 offset:0
  ds_read_b128 v[124:127], v9 offset:2048
  ds_read_b64_tr_b16 v[40:41], v5 offset:0
  ds_read_b64_tr_b16 v[42:43], v5 offset:1536
  s_waitcnt lgkmcnt(10)
  v_mfma_f32_16x16x32_bf16 v[56:59], v[24:27], v[112:115], v[56:59]
  v_mfma_f32_16x16x32_bf16 v[60:63], v[24:27], v[116:119], v[60:63]
  ds_read_b64_tr_b16 v[44:45], v6 offset:0
  ds_read_b64_tr_b16 v[46:47], v6 offset:1536
  s_waitcnt lgkmcnt(10)
  v_mfma_f32_16x16x32_bf16 v[64:67], v[28:31], v[112:115], v[64:67]
  v_mfma_f32_16x16x32_bf16 v[68:71], v[28:31], v[116:119], v[68:71]
  ds_read_b64_tr_b16 v[48:49], v7 offset:0
  ds_read_b64_tr_b16 v[50:51], v7 offset:1536
  s_waitcnt lgkmcnt(10)
  v_mfma_f32_16x16x32_bf16 v[72:75], v[32:35], v[112:115], v[72:75]
  v_mfma_f32_16x16x32_bf16 v[76:79], v[32:35], v[116:119], v[76:79]
  ds_read_b64_tr_b16 v[24:25], v1 offset:12288
  ds_read_b64_tr_b16 v[26:27], v1 offset:13824
  s_waitcnt lgkmcnt(10)
  v_mfma_f32_16x16x32_bf16 v[80:83], v[36:39], v[112:115], v[80:83]
  v_mfma_f32_16x16x32_bf16 v[84:87], v[36:39], v[116:119], v[84:87]
  ds_read_b64_tr_b16 v[28:29], v2 offset:12288
  ds_read_b64_tr_b16 v[30:31], v2 offset:13824
  s_waitcnt lgkmcnt(8)
  v_mfma_f32_16x16x32_bf16 v[88:91], v[40:43], v[112:115], v[88:91]
  v_mfma_f32_16x16x32_bf16 v[92:95], v[40:43], v[116:119], v[92:95]
  ds_read_b64_tr_b16 v[32:33], v3 offset:12288
  ds_read_b64_tr_b16 v[34:35], v3 offset:13824
  s_waitcnt lgkmcnt(8)
  v_mfma_f32_16x16x32_bf16 v[96:99], v[44:47], v[112:115], v[96:99]
  v_mfma_f32_16x16x32_bf16 v[100:103], v[44:47], v[116:119], v[100:103]
  ds_read_b64_tr_b16 v[36:37], v4 offset:12288
  ds_read_b64_tr_b16 v[38:39], v4 offset:13824
  s_waitcnt lgkmcnt(8)
  v_mfma_f32_16x16x32_bf16 v[104:107], v[112:115], v[48:51], v[104:107]
  v_mfma_f32_16x16x32_bf16 v[108:111], v[116:119], v[48:51], v[108:111]
  ds_read_b64_tr_b16 v[40:41], v5 offset:12288
  ds_read_b64_tr_b16 v[42:43], v5 offset:13824
  s_waitcnt lgkmcnt(8)
  v_mfma_f32_16x16x32_bf16 v[56:59], v[24:27], v[120:123], v[56:59]
  v_mfma_f32_16x16x32_bf16 v[60:63], v[24:27], v[124:127], v[60:63]
  ds_read_b64_tr_b16 v[44:45], v6 offset:12288
  ds_read_b64_tr_b16 v[46:47], v6 offset:13824
  s_waitcnt lgkmcnt(8)
  v_mfma_f32_16x16x32_bf16 v[64:67], v[28:31], v[120:123], v[64:67]
  v_mfma_f32_16x16x32_bf16 v[68:71], v[28:31], v[124:127], v[68:71]
  ds_read_b64_tr_b16 v[48:49], v7 offset:12288
  ds_read_b64_tr_b16 v[50:51], v7 offset:13824
  s_waitcnt lgkmcnt(8)
  v_mfma_f32_16x16x32_bf16 v[72:75], v[32:35], v[120:123], v[72:75]
  v_mfma_f32_16x16x32_bf16 v[76:79], v[32:35], v[124:127], v[76:79]
  s_waitcnt vmcnt(0) lgkmcnt(0)
  s_barrier
  s_cmp_eq_u32 s20, 0
  s_cbranch_scc1 qkv_pa3
  s_cmp_lg_u32 s23, 0
  s_cbranch_scc1 qkv_pa3
  v_readfirstlane_b32 s100, v55
  s_mov_b32 s31, 131072
  s_nop 2
qkv_ns3:
  s_cmp_lg_u32 s100, 0
  s_cbranch_scc1 qkv_nk3
  s_sub_u32 s31, s31, 1
  s_cmp_eq_u32 s31, 0
  s_cbranch_scc1 qkv_nk3
  global_load_dword v55, v54, s[60:61] sc1
  s_waitcnt vmcnt(0)
  v_readfirstlane_b32 s100, v55
  s_nop 3
  s_branch qkv_ns3
qkv_nk3:
  v_mov_b32 v53, 151552
  v_mov_b32 v55, s100
  ds_write_b32 v53, v55
  s_lshl_b32 s30, s22, 7
  s_lshl_b32 s31, s21, 2
  s_add_u32 s30, s30, s31
  s_add_u32 s30, s30, 19922944
  v_mul_u32_u24 v200, 2048, v0
  v_add_u32 v200, s30, v200
  v_mov_b32 v201, s100
  s_mov_b64 exec, 255
  global_store_dword v200, v201, s[28:29] sc1
  s_mov_b64 exec, -1
  s_waitcnt lgkmcnt(0)
qkv_pa3:
  ds_read_b64_tr_b16 v[24:25], v1 offset:24576
  ds_read_b64_tr_b16 v[26:27], v1 offset:26112
  ds_read_b128 v[112:115], v10 offset:0
  ds_read_b128 v[116:119], v10 offset:2048
  v_mfma_f32_16x16x32_bf16 v[80:83], v[36:39], v[120:123], v[80:83]
  v_mfma_f32_16x16x32_bf16 v[84:87], v[36:39], v[124:127], v[84:87]
  ds_read_b64_tr_b16 v[28:29], v2 offset:24576
  ds_read_b64_tr_b16 v[30:31], v2 offset:26112
  v_mfma_f32_16x16x32_bf16 v[88:91], v[40:43], v[120:123], v[88:91]
  v_mfma_f32_16x16x32_bf16 v[92:95], v[40:43], v[124:127], v[92:95]
  ds_read_b64_tr_b16 v[32:33], v3 offset:24576
  ds_read_b64_tr_b16 v[34:35], v3 offset:26112
  v_mfma_f32_16x16x32_bf16 v[96:99], v[44:47], v[120:123], v[96:99]
  v_mfma_f32_16x16x32_bf16 v[100:103], v[44:47], v[124:127], v[100:103]
  ds_read_b64_tr_b16 v[36:37], v4 offset:24576
  ds_read_b64_tr_b16 v[38:39], v4 offset:26112
  v_mfma_f32_16x16x32_bf16 v[104:107], v[120:123], v[48:51], v[104:107]
  v_mfma_f32_16x16x32_bf16 v[108:111], v[124:127], v[48:51], v[108:111]
  ds_read_b128 v[120:123], v11 offset:0
  ds_read_b128 v[124:127], v11 offset:2048
  ds_read_b64_tr_b16 v[40:41], v5 offset:24576
  ds_read_b64_tr_b16 v[42:43], v5 offset:26112
  s_waitcnt lgkmcnt(10)
  v_mfma_f32_16x16x32_bf16 v[56:59], v[24:27], v[112:115], v[56:59]
  v_mfma_f32_16x16x32_bf16 v[60:63], v[24:27], v[116:119], v[60:63]
  ds_read_b64_tr_b16 v[44:45], v6 offset:24576
  ds_read_b64_tr_b16 v[46:47], v6 offset:26112
  s_waitcnt lgkmcnt(10)
  v_mfma_f32_16x16x32_bf16 v[64:67], v[28:31], v[112:115], v[64:67]
  v_mfma_f32_16x16x32_bf16 v[68:71], v[28:31], v[116:119], v[68:71]
  ds_read_b64_tr_b16 v[48:49], v7 offset:24576
  ds_read_b64_tr_b16 v[50:51], v7 offset:26112
  s_waitcnt lgkmcnt(10)
  v_mfma_f32_16x16x32_bf16 v[72:75], v[32:35], v[112:115], v[72:75]
  v_mfma_f32_16x16x32_bf16 v[76:79], v[32:35], v[116:119], v[76:79]
  ds_read_b64_tr_b16 v[24:25], v1 offset:36864
  ds_read_b64_tr_b16 v[26:27], v1 offset:38400
  s_waitcnt lgkmcnt(10)
  v_mfma_f32_16x16x32_bf16 v[80:83], v[36:39], v[112:115], v[80:83]
  v_mfma_f32_16x16x32_bf16 v[84:87], v[36:39], v[116:119], v[84:87]
  ds_read_b64_tr_b16 v[28:29], v2 offset:36864
  ds_read_b64_tr_b16 v[30:31], v2 offset:38400
  s_waitcnt lgkmcnt(8)
  v_mfma_f32_16x16x32_bf16 v[88:91], v[40:43], v[112:115], v[88:91]
  v_mfma_f32_16x16x32_bf16 v[92:95], v[40:43], v[116:119], v[92:95]
  ds_read_b64_tr_b16 v[32:33], v3 offset:36864
  ds_read_b64_tr_b16 v[34:35], v3 offset:38400
  s_waitcnt lgkmcnt(8)
  v_mfma_f32_16x16x32_bf16 v[96:99], v[44:47], v[112:115], v[96:99]
  v_mfma_f32_16x16x32_bf16 v[100:103], v[44:47], v[116:119], v[100:103]
  ds_read_b64_tr_b16 v[36:37], v4 offset:36864
  ds_read_b64_tr_b16 v[38:39], v4 offset:38400
  s_waitcnt lgkmcnt(8)
  v_mfma_f32_16x16x32_bf16 v[104:107], v[112:115], v[48:51], v[104:107]
  v_mfma_f32_16x16x32_bf16 v[108:111], v[116:119], v[48:51], v[108:111]
  ds_read_b64_tr_b16 v[40:41], v5 offset:36864
  ds_read_b64_tr_b16 v[42:43], v5 offset:38400
  s_waitcnt lgkmcnt(8)
  v_mfma_f32_16x16x32_bf16 v[56:59], v[24:27], v[120:123], v[56:59]
  v_mfma_f32_16x16x32_bf16 v[60:63], v[24:27], v[124:127], v[60:63]
  ds_read_b64_tr_b16 v[44:45], v6 offset:36864
  ds_read_b64_tr_b16 v[46:47], v6 offset:38400
  s_waitcnt lgkmcnt(8)
  v_mfma_f32_16x16x32_bf16 v[64:67], v[28:31], v[120:123], v[64:67]
  v_mfma_f32_16x16x32_bf16 v[68:71], v[28:31], v[124:127], v[68:71]
  ds_read_b64_tr_b16 v[48:49], v7 offset:36864
  ds_read_b64_tr_b16 v[50:51], v7 offset:38400
  s_waitcnt lgkmcnt(8)
  v_mfma_f32_16x16x32_bf16 v[72:75], v[32:35], v[120:123], v[72:75]
  v_mfma_f32_16x16x32_bf16 v[76:79], v[32:35], v[124:127], v[76:79]
  s_waitcnt lgkmcnt(0)
  s_barrier
  ds_read_b64_tr_b16 v[24:25], v1 offset:49152
  ds_read_b64_tr_b16 v[26:27], v1 offset:50688
  ds_read_b128 v[112:115], v12 offset:0
  ds_read_b128 v[116:119], v12 offset:2048
  v_mfma_f32_16x16x32_bf16 v[80:83], v[36:39], v[120:123], v[80:83]
  v_mfma_f32_16x16x32_bf16 v[84:87], v[36:39], v[124:127], v[84:87]
  ds_read_b64_tr_b16 v[28:29], v2 offset:49152
  ds_read_b64_tr_b16 v[30:31], v2 offset:50688
  v_mfma_f32_16x16x32_bf16 v[88:91], v[40:43], v[120:123], v[88:91]
  v_mfma_f32_16x16x32_bf16 v[92:95], v[40:43], v[124:127], v[92:95]
  ds_read_b64_tr_b16 v[32:33], v3 offset:49152
  ds_read_b64_tr_b16 v[34:35], v3 offset:50688
  v_mfma_f32_16x16x32_bf16 v[96:99], v[44:47], v[120:123], v[96:99]
  v_mfma_f32_16x16x32_bf16 v[100:103], v[44:47], v[124:127], v[100:103]
  ds_read_b64_tr_b16 v[36:37], v4 offset:49152
  ds_read_b64_tr_b16 v[38:39], v4 offset:50688
  v_mfma_f32_16x16x32_bf16 v[104:107], v[120:123], v[48:51], v[104:107]
  v_mfma_f32_16x16x32_bf16 v[108:111], v[124:127], v[48:51], v[108:111]
  ds_read_b128 v[120:123], v13 offset:0
  ds_read_b128 v[124:127], v13 offset:2048
  ds_read_b64_tr_b16 v[40:41], v5 offset:49152
  ds_read_b64_tr_b16 v[42:43], v5 offset:50688
  s_waitcnt lgkmcnt(10)
  v_mfma_f32_16x16x32_bf16 v[56:59], v[24:27], v[112:115], v[56:59]
  v_mfma_f32_16x16x32_bf16 v[60:63], v[24:27], v[116:119], v[60:63]
  ds_read_b64_tr_b16 v[44:45], v6 offset:49152
  ds_read_b64_tr_b16 v[46:47], v6 offset:50688
  s_waitcnt lgkmcnt(10)
  v_mfma_f32_16x16x32_bf16 v[64:67], v[28:31], v[112:115], v[64:67]
  v_mfma_f32_16x16x32_bf16 v[68:71], v[28:31], v[116:119], v[68:71]
  ds_read_b64_tr_b16 v[48:49], v7 offset:49152
  ds_read_b64_tr_b16 v[50:51], v7 offset:50688
  s_waitcnt lgkmcnt(10)
  v_mfma_f32_16x16x32_bf16 v[72:75], v[32:35], v[112:115], v[72:75]
  v_mfma_f32_16x16x32_bf16 v[76:79], v[32:35], v[116:119], v[76:79]
  ds_read_b64_tr_b16 v[24:25], v1 offset:61440
  ds_read_b64_tr_b16 v[26:27], v1 offset:62976
  s_waitcnt lgkmcnt(10)
  v_mfma_f32_16x16x32_bf16 v[80:83], v[36:39], v[112:115], v[80:83]
  v_mfma_f32_16x16x32_bf16 v[84:87], v[36:39], v[116:119], v[84:87]
  ds_read_b64_tr_b16 v[28:29], v2 offset:61440
  ds_read_b64_tr_b16 v[30:31], v2 offset:62976
  s_waitcnt lgkmcnt(8)
  v_mfma_f32_16x16x32_bf16 v[88:91], v[40:43], v[112:115], v[88:91]
  v_mfma_f32_16x16x32_bf16 v[92:95], v[40:43], v[116:119], v[92:95]
  ds_read_b64_tr_b16 v[32:33], v3 offset:61440
  ds_read_b64_tr_b16 v[34:35], v3 offset:62976
  s_waitcnt lgkmcnt(8)
  v_mfma_f32_16x16x32_bf16 v[96:99], v[44:47], v[112:115], v[96:99]
  v_mfma_f32_16x16x32_bf16 v[100:103], v[44:47], v[116:119], v[100:103]
  ds_read_b64_tr_b16 v[36:37], v4 offset:61440
  ds_read_b64_tr_b16 v[38:39], v4 offset:62976
  s_waitcnt lgkmcnt(8)
  v_mfma_f32_16x16x32_bf16 v[104:107], v[112:115], v[48:51], v[104:107]
  v_mfma_f32_16x16x32_bf16 v[108:111], v[116:119], v[48:51], v[108:111]
  ds_read_b64_tr_b16 v[40:41], v5 offset:61440
  ds_read_b64_tr_b16 v[42:43], v5 offset:62976
  s_waitcnt lgkmcnt(8)
  v_mfma_f32_16x16x32_bf16 v[56:59], v[24:27], v[120:123], v[56:59]
  v_mfma_f32_16x16x32_bf16 v[60:63], v[24:27], v[124:127], v[60:63]
  ds_read_b64_tr_b16 v[44:45], v6 offset:61440
  ds_read_b64_tr_b16 v[46:47], v6 offset:62976
  s_waitcnt lgkmcnt(8)
  v_mfma_f32_16x16x32_bf16 v[64:67], v[28:31], v[120:123], v[64:67]
  v_mfma_f32_16x16x32_bf16 v[68:71], v[28:31], v[124:127], v[68:71]
  ds_read_b64_tr_b16 v[48:49], v7 offset:61440
  ds_read_b64_tr_b16 v[50:51], v7 offset:62976
  s_waitcnt lgkmcnt(8)
  v_mfma_f32_16x16x32_bf16 v[72:75], v[32:35], v[120:123], v[72:75]
  v_mfma_f32_16x16x32_bf16 v[76:79], v[32:35], v[124:127], v[76:79]
  s_waitcnt lgkmcnt(0)
  s_barrier
  ds_read_b64_tr_b16 v[24:25], v1 offset:0
  ds_read_b64_tr_b16 v[26:27], v1 offset:1536
  ds_read_b128 v[112:115], v8 offset:0
  ds_read_b128 v[116:119], v8 offset:2048
  v_mfma_f32_16x16x32_bf16 v[80:83], v[36:39], v[120:123], v[80:83]
  v_mfma_f32_16x16x32_bf16 v[84:87], v[36:39], v[124:127], v[84:87]
  ds_read_b64_tr_b16 v[28:29], v2 offset:0
  ds_read_b64_tr_b16 v[30:31], v2 offset:1536
  v_mfma_f32_16x16x32_bf16 v[88:91], v[40:43], v[120:123], v[88:91]
  v_mfma_f32_16x16x32_bf16 v[92:95], v[40:43], v[124:127], v[92:95]
  ds_read_b64_tr_b16 v[32:33], v3 offset:0
  ds_read_b64_tr_b16 v[34:35], v3 offset:1536
  v_mfma_f32_16x16x32_bf16 v[96:99], v[44:47], v[120:123], v[96:99]
  v_mfma_f32_16x16x32_bf16 v[100:103], v[44:47], v[124:127], v[100:103]
  ds_read_b64_tr_b16 v[36:37], v4 offset:0
  ds_read_b64_tr_b16 v[38:39], v4 offset:1536
  v_mfma_f32_16x16x32_bf16 v[104:107], v[120:123], v[48:51], v[104:107]
  v_mfma_f32_16x16x32_bf16 v[108:111], v[124:127], v[48:51], v[108:111]
  ds_read_b128 v[120:123], v9 offset:0
  ds_read_b128 v[124:127], v9 offset:2048
  ds_read_b64_tr_b16 v[40:41], v5 offset:0
  ds_read_b64_tr_b16 v[42:43], v5 offset:1536
  s_waitcnt lgkmcnt(10)
  v_mfma_f32_16x16x32_bf16 v[56:59], v[24:27], v[112:115], v[56:59]
  v_mfma_f32_16x16x32_bf16 v[60:63], v[24:27], v[116:119], v[60:63]
  ds_read_b64_tr_b16 v[44:45], v6 offset:0
  ds_read_b64_tr_b16 v[46:47], v6 offset:1536
  s_waitcnt lgkmcnt(10)
  v_mfma_f32_16x16x32_bf16 v[64:67], v[28:31], v[112:115], v[64:67]
  v_mfma_f32_16x16x32_bf16 v[68:71], v[28:31], v[116:119], v[68:71]
  ds_read_b64_tr_b16 v[48:49], v7 offset:0
  ds_read_b64_tr_b16 v[50:51], v7 offset:1536
  s_waitcnt lgkmcnt(10)
  v_mfma_f32_16x16x32_bf16 v[72:75], v[32:35], v[112:115], v[72:75]
  v_mfma_f32_16x16x32_bf16 v[76:79], v[32:35], v[116:119], v[76:79]
  ds_read_b64_tr_b16 v[24:25], v1 offset:12288
  ds_read_b64_tr_b16 v[26:27], v1 offset:13824
  s_waitcnt lgkmcnt(10)
  v_mfma_f32_16x16x32_bf16 v[80:83], v[36:39], v[112:115], v[80:83]
  v_mfma_f32_16x16x32_bf16 v[84:87], v[36:39], v[116:119], v[84:87]
  ds_read_b64_tr_b16 v[28:29], v2 offset:12288
  ds_read_b64_tr_b16 v[30:31], v2 offset:13824
  s_waitcnt lgkmcnt(8)
  v_mfma_f32_16x16x32_bf16 v[88:91], v[40:43], v[112:115], v[88:91]
  v_mfma_f32_16x16x32_bf16 v[92:95], v[40:43], v[116:119], v[92:95]
  ds_read_b64_tr_b16 v[32:33], v3 offset:12288
  ds_read_b64_tr_b16 v[34:35], v3 offset:13824
  s_waitcnt lgkmcnt(8)
  v_mfma_f32_16x16x32_bf16 v[96:99], v[44:47], v[112:115], v[96:99]
  v_mfma_f32_16x16x32_bf16 v[100:103], v[44:47], v[116:119], v[100:103]
  ds_read_b64_tr_b16 v[36:37], v4 offset:12288
  ds_read_b64_tr_b16 v[38:39], v4 offset:13824
  s_waitcnt lgkmcnt(8)
  v_mfma_f32_16x16x32_bf16 v[104:107], v[112:115], v[48:51], v[104:107]
  v_mfma_f32_16x16x32_bf16 v[108:111], v[116:119], v[48:51], v[108:111]
  ds_read_b64_tr_b16 v[40:41], v5 offset:12288
  ds_read_b64_tr_b16 v[42:43], v5 offset:13824
  s_waitcnt lgkmcnt(8)
  v_mfma_f32_16x16x32_bf16 v[56:59], v[24:27], v[120:123], v[56:59]
  v_mfma_f32_16x16x32_bf16 v[60:63], v[24:27], v[124:127], v[60:63]
  ds_read_b64_tr_b16 v[44:45], v6 offset:12288
  ds_read_b64_tr_b16 v[46:47], v6 offset:13824
  s_waitcnt lgkmcnt(8)
  v_mfma_f32_16x16x32_bf16 v[64:67], v[28:31], v[120:123], v[64:67]
  v_mfma_f32_16x16x32_bf16 v[68:71], v[28:31], v[124:127], v[68:71]
  ds_read_b64_tr_b16 v[48:49], v7 offset:12288
  ds_read_b64_tr_b16 v[50:51], v7 offset:13824
  s_waitcnt lgkmcnt(8)
  v_mfma_f32_16x16x32_bf16 v[72:75], v[32:35], v[120:123], v[72:75]
  v_mfma_f32_16x16x32_bf16 v[76:79], v[32:35], v[124:127], v[76:79]
  s_waitcnt lgkmcnt(0)
  s_barrier
  ds_read_b64_tr_b16 v[24:25], v1 offset:24576
  ds_read_b64_tr_b16 v[26:27], v1 offset:26112
  ds_read_b128 v[112:115], v10 offset:0
  ds_read_b128 v[116:119], v10 offset:2048
  v_mfma_f32_16x16x32_bf16 v[80:83], v[36:39], v[120:123], v[80:83]
  v_mfma_f32_16x16x32_bf16 v[84:87], v[36:39], v[124:127], v[84:87]
  ds_read_b64_tr_b16 v[28:29], v2 offset:24576
  ds_read_b64_tr_b16 v[30:31], v2 offset:26112
  v_mfma_f32_16x16x32_bf16 v[88:91], v[40:43], v[120:123], v[88:91]
  v_mfma_f32_16x16x32_bf16 v[92:95], v[40:43], v[124:127], v[92:95]
  ds_read_b64_tr_b16 v[32:33], v3 offset:24576
  ds_read_b64_tr_b16 v[34:35], v3 offset:26112
  v_mfma_f32_16x16x32_bf16 v[96:99], v[44:47], v[120:123], v[96:99]
  v_mfma_f32_16x16x32_bf16 v[100:103], v[44:47], v[124:127], v[100:103]
  ds_read_b64_tr_b16 v[36:37], v4 offset:24576
  ds_read_b64_tr_b16 v[38:39], v4 offset:26112
  v_mfma_f32_16x16x32_bf16 v[104:107], v[120:123], v[48:51], v[104:107]
  v_mfma_f32_16x16x32_bf16 v[108:111], v[124:127], v[48:51], v[108:111]
  ds_read_b128 v[120:123], v11 offset:0
  ds_read_b128 v[124:127], v11 offset:2048
  ds_read_b64_tr_b16 v[40:41], v5 offset:24576
  ds_read_b64_tr_b16 v[42:43], v5 offset:26112
  s_waitcnt lgkmcnt(10)
  v_mfma_f32_16x16x32_bf16 v[56:59], v[24:27], v[112:115], v[56:59]
  v_mfma_f32_16x16x32_bf16 v[60:63], v[24:27], v[116:119], v[60:63]
  ds_read_b64_tr_b16 v[44:45], v6 offset:24576
  ds_read_b64_tr_b16 v[46:47], v6 offset:26112
  s_waitcnt lgkmcnt(10)
  v_mfma_f32_16x16x32_bf16 v[64:67], v[28:31], v[112:115], v[64:67]
  v_mfma_f32_16x16x32_bf16 v[68:71], v[28:31], v[116:119], v[68:71]
  ds_read_b64_tr_b16 v[48:49], v7 offset:24576
  ds_read_b64_tr_b16 v[50:51], v7 offset:26112
  s_waitcnt lgkmcnt(10)
  v_mfma_f32_16x16x32_bf16 v[72:75], v[32:35], v[112:115], v[72:75]
  v_mfma_f32_16x16x32_bf16 v[76:79], v[32:35], v[116:119], v[76:79]
  ds_read_b64_tr_b16 v[24:25], v1 offset:36864
  ds_read_b64_tr_b16 v[26:27], v1 offset:38400
  s_waitcnt lgkmcnt(10)
  v_mfma_f32_16x16x32_bf16 v[80:83], v[36:39], v[112:115], v[80:83]
  v_mfma_f32_16x16x32_bf16 v[84:87], v[36:39], v[116:119], v[84:87]
  ds_read_b64_tr_b16 v[28:29], v2 offset:36864
  ds_read_b64_tr_b16 v[30:31], v2 offset:38400
  s_waitcnt lgkmcnt(8)
  v_mfma_f32_16x16x32_bf16 v[88:91], v[40:43], v[112:115], v[88:91]
  v_mfma_f32_16x16x32_bf16 v[92:95], v[40:43], v[116:119], v[92:95]
  ds_read_b64_tr_b16 v[32:33], v3 offset:36864
  ds_read_b64_tr_b16 v[34:35], v3 offset:38400
  s_waitcnt lgkmcnt(8)
  v_mfma_f32_16x16x32_bf16 v[96:99], v[44:47], v[112:115], v[96:99]
  v_mfma_f32_16x16x32_bf16 v[100:103], v[44:47], v[116:119], v[100:103]
  ds_read_b64_tr_b16 v[36:37], v4 offset:36864
  ds_read_b64_tr_b16 v[38:39], v4 offset:38400
  s_waitcnt lgkmcnt(8)
  v_mfma_f32_16x16x32_bf16 v[104:107], v[112:115], v[48:51], v[104:107]
  v_mfma_f32_16x16x32_bf16 v[108:111], v[116:119], v[48:51], v[108:111]
  ds_read_b64_tr_b16 v[40:41], v5 offset:36864
  ds_read_b64_tr_b16 v[42:43], v5 offset:38400
  s_waitcnt lgkmcnt(8)
  v_mfma_f32_16x16x32_bf16 v[56:59], v[24:27], v[120:123], v[56:59]
  v_mfma_f32_16x16x32_bf16 v[60:63], v[24:27], v[124:127], v[60:63]
  ds_read_b64_tr_b16 v[44:45], v6 offset:36864
  ds_read_b64_tr_b16 v[46:47], v6 offset:38400
  s_waitcnt lgkmcnt(8)
  v_mfma_f32_16x16x32_bf16 v[64:67], v[28:31], v[120:123], v[64:67]
  v_mfma_f32_16x16x32_bf16 v[68:71], v[28:31], v[124:127], v[68:71]
  ds_read_b64_tr_b16 v[48:49], v7 offset:36864
  ds_read_b64_tr_b16 v[50:51], v7 offset:38400
  s_waitcnt lgkmcnt(8)
  v_mfma_f32_16x16x32_bf16 v[72:75], v[32:35], v[120:123], v[72:75]
  v_mfma_f32_16x16x32_bf16 v[76:79], v[32:35], v[124:127], v[76:79]
  s_waitcnt lgkmcnt(0)
  s_barrier
  ds_read_b64_tr_b16 v[24:25], v1 offset:49152
  ds_read_b64_tr_b16 v[26:27], v1 offset:50688
  ds_read_b128 v[112:115], v12 offset:0
  ds_read_b128 v[116:119], v12 offset:2048
  v_mfma_f32_16x16x32_bf16 v[80:83], v[36:39], v[120:123], v[80:83]
  v_mfma_f32_16x16x32_bf16 v[84:87], v[36:39], v[124:127], v[84:87]
  ds_read_b64_tr_b16 v[28:29], v2 offset:49152
  ds_read_b64_tr_b16 v[30:31], v2 offset:50688
  v_mfma_f32_16x16x32_bf16 v[88:91], v[40:43], v[120:123], v[88:91]
  v_mfma_f32_16x16x32_bf16 v[92:95], v[40:43], v[124:127], v[92:95]
  ds_read_b64_tr_b16 v[32:33], v3 offset:49152
  ds_read_b64_tr_b16 v[34:35], v3 offset:50688
  v_mfma_f32_16x16x32_bf16 v[96:99], v[44:47], v[120:123], v[96:99]
  v_mfma_f32_16x16x32_bf16 v[100:103], v[44:47], v[124:127], v[100:103]
  ds_read_b64_tr_b16 v[36:37], v4 offset:49152
  ds_read_b64_tr_b16 v[38:39], v4 offset:50688
  v_mfma_f32_16x16x32_bf16 v[104:107], v[120:123], v[48:51], v[104:107]
  v_mfma_f32_16x16x32_bf16 v[108:111], v[124:127], v[48:51], v[108:111]
  ds_read_b128 v[120:123], v13 offset:0
  ds_read_b128 v[124:127], v13 offset:2048
  ds_read_b64_tr_b16 v[40:41], v5 offset:49152
  ds_read_b64_tr_b16 v[42:43], v5 offset:50688
  s_waitcnt lgkmcnt(10)
  v_mfma_f32_16x16x32_bf16 v[56:59], v[24:27], v[112:115], v[56:59]
  v_mfma_f32_16x16x32_bf16 v[60:63], v[24:27], v[116:119], v[60:63]
  ds_read_b64_tr_b16 v[44:45], v6 offset:49152
  ds_read_b64_tr_b16 v[46:47], v6 offset:50688
  s_waitcnt lgkmcnt(10)
  v_mfma_f32_16x16x32_bf16 v[64:67], v[28:31], v[112:115], v[64:67]
  v_mfma_f32_16x16x32_bf16 v[68:71], v[28:31], v[116:119], v[68:71]
  ds_read_b64_tr_b16 v[48:49], v7 offset:49152
  ds_read_b64_tr_b16 v[50:51], v7 offset:50688
  s_waitcnt lgkmcnt(10)
  v_mfma_f32_16x16x32_bf16 v[72:75], v[32:35], v[112:115], v[72:75]
  v_mfma_f32_16x16x32_bf16 v[76:79], v[32:35], v[116:119], v[76:79]
  ds_read_b64_tr_b16 v[24:25], v1 offset:61440
  ds_read_b64_tr_b16 v[26:27], v1 offset:62976
  s_waitcnt lgkmcnt(10)
  v_mfma_f32_16x16x32_bf16 v[80:83], v[36:39], v[112:115], v[80:83]
  v_mfma_f32_16x16x32_bf16 v[84:87], v[36:39], v[116:119], v[84:87]
  ds_read_b64_tr_b16 v[28:29], v2 offset:61440
  ds_read_b64_tr_b16 v[30:31], v2 offset:62976
  s_waitcnt lgkmcnt(8)
  v_mfma_f32_16x16x32_bf16 v[88:91], v[40:43], v[112:115], v[88:91]
  v_mfma_f32_16x16x32_bf16 v[92:95], v[40:43], v[116:119], v[92:95]
  ds_read_b64_tr_b16 v[32:33], v3 offset:61440
  ds_read_b64_tr_b16 v[34:35], v3 offset:62976
  s_waitcnt lgkmcnt(8)
  v_mfma_f32_16x16x32_bf16 v[96:99], v[44:47], v[112:115], v[96:99]
  v_mfma_f32_16x16x32_bf16 v[100:103], v[44:47], v[116:119], v[100:103]
  ds_read_b64_tr_b16 v[36:37], v4 offset:61440
  ds_read_b64_tr_b16 v[38:39], v4 offset:62976
  s_waitcnt lgkmcnt(8)
  v_mfma_f32_16x16x32_bf16 v[104:107], v[112:115], v[48:51], v[104:107]
  v_mfma_f32_16x16x32_bf16 v[108:111], v[116:119], v[48:51], v[108:111]
  ds_read_b64_tr_b16 v[40:41], v5 offset:61440
  ds_read_b64_tr_b16 v[42:43], v5 offset:62976
  s_waitcnt lgkmcnt(8)
  v_mfma_f32_16x16x32_bf16 v[56:59], v[24:27], v[120:123], v[56:59]
  v_mfma_f32_16x16x32_bf16 v[60:63], v[24:27], v[124:127], v[60:63]
  ds_read_b64_tr_b16 v[44:45], v6 offset:61440
  ds_read_b64_tr_b16 v[46:47], v6 offset:62976
  s_waitcnt lgkmcnt(8)
  v_mfma_f32_16x16x32_bf16 v[64:67], v[28:31], v[120:123], v[64:67]
  v_mfma_f32_16x16x32_bf16 v[68:71], v[28:31], v[124:127], v[68:71]
  ds_read_b64_tr_b16 v[48:49], v7 offset:61440
  ds_read_b64_tr_b16 v[50:51], v7 offset:62976
  s_waitcnt lgkmcnt(8)
  v_mfma_f32_16x16x32_bf16 v[72:75], v[32:35], v[120:123], v[72:75]
  v_mfma_f32_16x16x32_bf16 v[76:79], v[32:35], v[124:127], v[76:79]
  s_waitcnt lgkmcnt(0)
  v_mfma_f32_16x16x32_bf16 v[80:83], v[36:39], v[120:123], v[80:83]
  v_mfma_f32_16x16x32_bf16 v[84:87], v[36:39], v[124:127], v[84:87]
  v_mfma_f32_16x16x32_bf16 v[88:91], v[40:43], v[120:123], v[88:91]
  v_mfma_f32_16x16x32_bf16 v[92:95], v[40:43], v[124:127], v[92:95]
  v_mfma_f32_16x16x32_bf16 v[96:99], v[44:47], v[120:123], v[96:99]
  v_mfma_f32_16x16x32_bf16 v[100:103], v[44:47], v[124:127], v[100:103]
  v_mfma_f32_16x16x32_bf16 v[104:107], v[120:123], v[48:51], v[104:107]
  v_mfma_f32_16x16x32_bf16 v[108:111], v[124:127], v[48:51], v[108:111]
  s_nop 7
  s_cmp_eq_u32 s47, 1
  s_cbranch_scc0 qkv_ns3_0
  v_pk_mul_f32 v[56:57], v[56:57], s[50:51]
  v_pk_mul_f32 v[58:59], v[58:59], s[50:51]
  v_pk_mul_f32 v[60:61], v[60:61], s[50:51]
  v_pk_mul_f32 v[62:63], v[62:63], s[50:51]
  v_pk_mul_f32 v[64:65], v[64:65], s[50:51]
  v_pk_mul_f32 v[66:67], v[66:67], s[50:51]
  v_pk_mul_f32 v[68:69], v[68:69], s[50:51]
  v_pk_mul_f32 v[70:71], v[70:71], s[50:51]
qkv_ns3_0:
  s_cmp_eq_u32 s47, 2
  s_cbranch_scc0 qkv_np3_0
  v_pk_fma_f32 v[160:161], v[56:57], s[52:53], v[22:23]
  v_pk_fma_f32 v[162:163], v[58:59], s[52:53], v[22:23]
  v_pk_fma_f32 v[164:165], v[60:61], s[52:53], v[22:23]
  v_pk_fma_f32 v[166:167], v[62:63], s[52:53], v[22:23]
  v_pk_fma_f32 v[168:169], v[64:65], s[52:53], v[22:23]
  v_pk_fma_f32 v[170:171], v[66:67], s[52:53], v[22:23]
  v_pk_fma_f32 v[172:173], v[68:69], s[52:53], v[22:23]
  v_pk_fma_f32 v[174:175], v[70:71], s[52:53], v[22:23]
  v_exp_f32_e64 v160, v160 clamp
  v_max_f32 v56, s54, v56
  v_exp_f32_e64 v161, v161 clamp
  v_max_f32 v57, s54, v57
  v_exp_f32_e64 v162, v162 clamp
  v_max_f32 v58, s54, v58
  v_exp_f32_e64 v163, v163 clamp
  v_max_f32 v59, s54, v59
  v_exp_f32_e64 v164, v164 clamp
  v_max_f32 v60, s54, v60
  v_exp_f32_e64 v165, v165 clamp
  v_max_f32 v61, s54, v61
  v_exp_f32_e64 v166, v166 clamp
  v_max_f32 v62, s54, v62
  v_exp_f32_e64 v167, v167 clamp
  v_max_f32 v63, s54, v63
  v_exp_f32_e64 v168, v168 clamp
  v_max_f32 v64, s54, v64
  v_exp_f32_e64 v169, v169 clamp
  v_max_f32 v65, s54, v65
  v_exp_f32_e64 v170, v170 clamp
  v_max_f32 v66, s54, v66
  v_exp_f32_e64 v171, v171 clamp
  v_max_f32 v67, s54, v67
  v_exp_f32_e64 v172, v172 clamp
  v_max_f32 v68, s54, v68
  v_exp_f32_e64 v173, v173 clamp
  v_max_f32 v69, s54, v69
  v_exp_f32_e64 v174, v174 clamp
  v_max_f32 v70, s54, v70
  v_exp_f32_e64 v175, v175 clamp
  v_max_f32 v71, s54, v71
  v_pk_add_f32 v[56:57], v[56:57], v[160:161]
  v_pk_add_f32 v[58:59], v[58:59], v[162:163]
  v_pk_add_f32 v[60:61], v[60:61], v[164:165]
  v_pk_add_f32 v[62:63], v[62:63], v[166:167]
  v_pk_add_f32 v[64:65], v[64:65], v[168:169]
  v_pk_add_f32 v[66:67], v[66:67], v[170:171]
  v_pk_add_f32 v[68:69], v[68:69], v[172:173]
  v_pk_add_f32 v[70:71], v[70:71], v[174:175]
qkv_np3_0:
  v_cvt_pk_bf16_f32 v128, v56, v57
  v_cvt_pk_bf16_f32 v129, v58, v59
  v_cvt_pk_bf16_f32 v130, v60, v61
  v_cvt_pk_bf16_f32 v131, v62, v63
  s_nop 0
  v_permlane32_swap_b32 v128, v130
  v_permlane32_swap_b32 v129, v131
  buffer_store_dwordx4 v[128:131], v16, s[16:19], s41 offen sc1
  s_add_u32 s56, s41, s44
  v_cvt_pk_bf16_f32 v132, v64, v65
  v_cvt_pk_bf16_f32 v133, v66, v67
  v_cvt_pk_bf16_f32 v134, v68, v69
  v_cvt_pk_bf16_f32 v135, v70, v71
  s_nop 0
  v_permlane32_swap_b32 v132, v134
  v_permlane32_swap_b32 v133, v135
  buffer_store_dwordx4 v[132:135], v16, s[16:19], s56 offen sc1
  s_cmp_eq_u32 s48, 1
  s_cbranch_scc0 qkv_ns3_1
  v_pk_mul_f32 v[72:73], v[72:73], s[50:51]
  v_pk_mul_f32 v[74:75], v[74:75], s[50:51]
  v_pk_mul_f32 v[76:77], v[76:77], s[50:51]
  v_pk_mul_f32 v[78:79], v[78:79], s[50:51]
  v_pk_mul_f32 v[80:81], v[80:81], s[50:51]
  v_pk_mul_f32 v[82:83], v[82:83], s[50:51]
  v_pk_mul_f32 v[84:85], v[84:85], s[50:51]
  v_pk_mul_f32 v[86:87], v[86:87], s[50:51]
qkv_ns3_1:
  s_cmp_eq_u32 s48, 2
  s_cbranch_scc0 qkv_np3_1
  v_pk_fma_f32 v[160:161], v[72:73], s[52:53], v[22:23]
  v_pk_fma_f32 v[162:163], v[74:75], s[52:53], v[22:23]
  v_pk_fma_f32 v[164:165], v[76:77], s[52:53], v[22:23]
  v_pk_fma_f32 v[166:167], v[78:79], s[52:53], v[22:23]
  v_pk_fma_f32 v[168:169], v[80:81], s[52:53], v[22:23]
  v_pk_fma_f32 v[170:171], v[82:83], s[52:53], v[22:23]
  v_pk_fma_f32 v[172:173], v[84:85], s[52:53], v[22:23]
  v_pk_fma_f32 v[174:175], v[86:87], s[52:53], v[22:23]
  v_exp_f32_e64 v160, v160 clamp
  v_max_f32 v72, s54, v72
  v_exp_f32_e64 v161, v161 clamp
  v_max_f32 v73, s54, v73
  v_exp_f32_e64 v162, v162 clamp
  v_max_f32 v74, s54, v74
  v_exp_f32_e64 v163, v163 clamp
  v_max_f32 v75, s54, v75
  v_exp_f32_e64 v164, v164 clamp
  v_max_f32 v76, s54, v76
  v_exp_f32_e64 v165, v165 clamp
  v_max_f32 v77, s54, v77
  v_exp_f32_e64 v166, v166 clamp
  v_max_f32 v78, s54, v78
  v_exp_f32_e64 v167, v167 clamp
  v_max_f32 v79, s54, v79
  v_exp_f32_e64 v168, v168 clamp
  v_max_f32 v80, s54, v80
  v_exp_f32_e64 v169, v169 clamp
  v_max_f32 v81, s54, v81
  v_exp_f32_e64 v170, v170 clamp
  v_max_f32 v82, s54, v82
  v_exp_f32_e64 v171, v171 clamp
  v_max_f32 v83, s54, v83
  v_exp_f32_e64 v172, v172 clamp
  v_max_f32 v84, s54, v84
  v_exp_f32_e64 v173, v173 clamp
  v_max_f32 v85, s54, v85
  v_exp_f32_e64 v174, v174 clamp
  v_max_f32 v86, s54, v86
  v_exp_f32_e64 v175, v175 clamp
  v_max_f32 v87, s54, v87
  v_pk_add_f32 v[72:73], v[72:73], v[160:161]
  v_pk_add_f32 v[74:75], v[74:75], v[162:163]
  v_pk_add_f32 v[76:77], v[76:77], v[164:165]
  v_pk_add_f32 v[78:79], v[78:79], v[166:167]
  v_pk_add_f32 v[80:81], v[80:81], v[168:169]
  v_pk_add_f32 v[82:83], v[82:83], v[170:171]
  v_pk_add_f32 v[84:85], v[84:85], v[172:173]
  v_pk_add_f32 v[86:87], v[86:87], v[174:175]
qkv_np3_1:
  v_cvt_pk_bf16_f32 v136, v72, v73
  v_cvt_pk_bf16_f32 v137, v74, v75
  v_cvt_pk_bf16_f32 v138, v76, v77
  v_cvt_pk_bf16_f32 v139, v78, v79
  s_nop 0
  v_permlane32_swap_b32 v136, v138
  v_permlane32_swap_b32 v137, v139
  buffer_store_dwordx4 v[136:139], v16, s[16:19], s42 offen sc1
  s_add_u32 s56, s42, s45
  v_cvt_pk_bf16_f32 v140, v80, v81
  v_cvt_pk_bf16_f32 v141, v82, v83
  v_cvt_pk_bf16_f32 v142, v84, v85
  v_cvt_pk_bf16_f32 v143, v86, v87
  s_nop 0
  v_permlane32_swap_b32 v140, v142
  v_permlane32_swap_b32 v141, v143
  buffer_store_dwordx4 v[140:143], v16, s[16:19], s56 offen sc1
  s_cmp_eq_u32 s49, 1
  s_cbranch_scc0 qkv_ns3_2
  v_pk_mul_f32 v[88:89], v[88:89], s[50:51]
  v_pk_mul_f32 v[90:91], v[90:91], s[50:51]
  v_pk_mul_f32 v[92:93], v[92:93], s[50:51]
  v_pk_mul_f32 v[94:95], v[94:95], s[50:51]
  v_pk_mul_f32 v[96:97], v[96:97], s[50:51]
  v_pk_mul_f32 v[98:99], v[98:99], s[50:51]
  v_pk_mul_f32 v[100:101], v[100:101], s[50:51]
  v_pk_mul_f32 v[102:103], v[102:103], s[50:51]
qkv_ns3_2:
  s_cmp_eq_u32 s49, 2
  s_cbranch_scc0 qkv_np3_2
  v_pk_fma_f32 v[160:161], v[88:89], s[52:53], v[22:23]
  v_pk_fma_f32 v[162:163], v[90:91], s[52:53], v[22:23]
  v_pk_fma_f32 v[164:165], v[92:93], s[52:53], v[22:23]
  v_pk_fma_f32 v[166:167], v[94:95], s[52:53], v[22:23]
  v_pk_fma_f32 v[168:169], v[96:97], s[52:53], v[22:23]
  v_pk_fma_f32 v[170:171], v[98:99], s[52:53], v[22:23]
  v_pk_fma_f32 v[172:173], v[100:101], s[52:53], v[22:23]
  v_pk_fma_f32 v[174:175], v[102:103], s[52:53], v[22:23]
  v_exp_f32_e64 v160, v160 clamp
  v_max_f32 v88, s54, v88
  v_exp_f32_e64 v161, v161 clamp
  v_max_f32 v89, s54, v89
  v_exp_f32_e64 v162, v162 clamp
  v_max_f32 v90, s54, v90
  v_exp_f32_e64 v163, v163 clamp
  v_max_f32 v91, s54, v91
  v_exp_f32_e64 v164, v164 clamp
  v_max_f32 v92, s54, v92
  v_exp_f32_e64 v165, v165 clamp
  v_max_f32 v93, s54, v93
  v_exp_f32_e64 v166, v166 clamp
  v_max_f32 v94, s54, v94
  v_exp_f32_e64 v167, v167 clamp
  v_max_f32 v95, s54, v95
  v_exp_f32_e64 v168, v168 clamp
  v_max_f32 v96, s54, v96
  v_exp_f32_e64 v169, v169 clamp
  v_max_f32 v97, s54, v97
  v_exp_f32_e64 v170, v170 clamp
  v_max_f32 v98, s54, v98
  v_exp_f32_e64 v171, v171 clamp
  v_max_f32 v99, s54, v99
  v_exp_f32_e64 v172, v172 clamp
  v_max_f32 v100, s54, v100
  v_exp_f32_e64 v173, v173 clamp
  v_max_f32 v101, s54, v101
  v_exp_f32_e64 v174, v174 clamp
  v_max_f32 v102, s54, v102
  v_exp_f32_e64 v175, v175 clamp
  v_max_f32 v103, s54, v103
  v_pk_add_f32 v[88:89], v[88:89], v[160:161]
  v_pk_add_f32 v[90:91], v[90:91], v[162:163]
  v_pk_add_f32 v[92:93], v[92:93], v[164:165]
  v_pk_add_f32 v[94:95], v[94:95], v[166:167]
  v_pk_add_f32 v[96:97], v[96:97], v[168:169]
  v_pk_add_f32 v[98:99], v[98:99], v[170:171]
  v_pk_add_f32 v[100:101], v[100:101], v[172:173]
  v_pk_add_f32 v[102:103], v[102:103], v[174:175]
qkv_np3_2:
  v_cvt_pk_bf16_f32 v144, v88, v89
  v_cvt_pk_bf16_f32 v145, v90, v91
  v_cvt_pk_bf16_f32 v146, v92, v93
  v_cvt_pk_bf16_f32 v147, v94, v95
  s_nop 0
  v_permlane32_swap_b32 v144, v146
  v_permlane32_swap_b32 v145, v147
  buffer_store_dwordx4 v[144:147], v16, s[16:19], s43 offen sc1
  s_add_u32 s56, s43, s46
  v_cvt_pk_bf16_f32 v148, v96, v97
  v_cvt_pk_bf16_f32 v149, v98, v99
  v_cvt_pk_bf16_f32 v150, v100, v101
  v_cvt_pk_bf16_f32 v151, v102, v103
  s_nop 0
  v_permlane32_swap_b32 v148, v150
  v_permlane32_swap_b32 v149, v151
  buffer_store_dwordx4 v[148:151], v16, s[16:19], s56 offen sc1
  v_mul_f32 v104, v20, v104
  v_mul_f32 v105, v20, v105
  v_mul_f32 v106, v20, v106
  v_mul_f32 v107, v20, v107
  v_mul_f32 v108, v20, v108
  v_mul_f32 v109, v20, v109
  v_mul_f32 v110, v20, v110
  v_mul_f32 v111, v20, v111
  s_cmp_eq_u32 s20, 0
  s_cbranch_scc1 qkv_xp3
  v_pk_mul_f32 v[176:177], v[104:105], 1.0 op_sel_hi:[1,0]
  v_pk_mul_f32 v[178:179], v[106:107], 1.0 op_sel_hi:[1,0]
  v_pk_mul_f32 v[180:181], v[108:109], 1.0 op_sel_hi:[1,0]
  v_pk_mul_f32 v[182:183], v[110:111], 1.0 op_sel_hi:[1,0]
  v_pk_fma_f32 v[160:161], v[176:177], s[52:53], v[22:23]
  v_pk_fma_f32 v[162:163], v[178:179], s[52:53], v[22:23]
  v_pk_fma_f32 v[164:165], v[180:181], s[52:53], v[22:23]
  v_pk_fma_f32 v[166:167], v[182:183], s[52:53], v[22:23]
  v_exp_f32_e64 v160, v160 clamp
  v_max_f32 v176, s54, v176
  v_exp_f32_e64 v161, v161 clamp
  v_max_f32 v177, s54, v177
  v_exp_f32_e64 v162, v162 clamp
  v_max_f32 v178, s54, v178
  v_exp_f32_e64 v163, v163 clamp
  v_max_f32 v179, s54, v179
  v_exp_f32_e64 v164, v164 clamp
  v_max_f32 v180, s54, v180
  v_exp_f32_e64 v165, v165 clamp
  v_max_f32 v181, s54, v181
  v_exp_f32_e64 v166, v166 clamp
  v_max_f32 v182, s54, v182
  v_exp_f32_e64 v167, v167 clamp
  v_max_f32 v183, s54, v183
  v_pk_add_f32 v[176:177], v[176:177], v[160:161]
  v_pk_add_f32 v[178:179], v[178:179], v[162:163]
  v_pk_add_f32 v[180:181], v[180:181], v[164:165]
  v_pk_add_f32 v[182:183], v[182:183], v[166:167]
  v_cmp_eq_u32 vcc, 1, v21
  s_nop 1
  v_cndmask_b32 v104, v104, v176, vcc
  v_cndmask_b32 v105, v105, v177, vcc
  v_cndmask_b32 v106, v106, v178, vcc
  v_cndmask_b32 v107, v107, v179, vcc
  v_cndmask_b32 v108, v108, v180, vcc
  v_cndmask_b32 v109, v109, v181, vcc
  v_cndmask_b32 v110, v110, v182, vcc
  v_cndmask_b32 v111, v111, v183, vcc
qkv_xp3:
  v_cmp_ne_u32 vcc, 0, v52
  s_nop 1
  v_cndmask_b32 v156, v104, v108, vcc
  v_cndmask_b32 v128, v108, v104, vcc
  v_cndmask_b32 v157, v105, v109, vcc
  v_cndmask_b32 v129, v109, v105, vcc
  v_cndmask_b32 v158, v106, v110, vcc
  v_cndmask_b32 v130, v110, v106, vcc
  v_cndmask_b32 v159, v107, v111, vcc
  v_cndmask_b32 v131, v111, v107, vcc
  s_nop 0
  v_mov_b32_dpp v152, v128 quad_perm:[1,0,3,2] row_mask:0xf bank_mask:0xf
  v_mov_b32_dpp v153, v129 quad_perm:[1,0,3,2] row_mask:0xf bank_mask:0xf
  v_mov_b32_dpp v154, v130 quad_perm:[1,0,3,2] row_mask:0xf bank_mask:0xf
  v_mov_b32_dpp v155, v131 quad_perm:[1,0,3,2] row_mask:0xf bank_mask:0xf
  v_cndmask_b32 v128, v156, v152, vcc
  v_cndmask_b32 v156, v152, v156, vcc
  v_cndmask_b32 v129, v157, v153, vcc
  v_cndmask_b32 v157, v153, v157, vcc
  v_cndmask_b32 v130, v158, v154, vcc
  v_cndmask_b32 v158, v154, v158, vcc
  v_cndmask_b32 v131, v159, v155, vcc
  v_cndmask_b32 v159, v155, v159, vcc
  v_cvt_pk_bf16_f32 v132, v128, v156
  v_cvt_pk_bf16_f32 v133, v129, v157
  v_cvt_pk_bf16_f32 v134, v130, v158
  v_cvt_pk_bf16_f32 v135, v131, v159
  buffer_store_dwordx4 v[132:135], v18, s[16:19], 0 offen sc1
  s_branch qkv_passend
qkv_passend:
  s_cmp_eq_u32 s20, 1
  s_cbranch_scc1 qkv_p1end
  s_mov_b32 s41, s8
  s_mov_b32 s42, s9
  s_mov_b32 s43, s10
  s_mov_b32 s44, s11
  s_mov_b32 s45, s12
  s_mov_b32 s46, s13
  s_mov_b32 s47, s14
  s_mov_b32 s48, s15
  s_mov_b32 s49, s55
  s_mov_b32 s20, 1
  s_cmp_lg_u32 s23, 0
  s_cbranch_scc1 qkv_pass
  global_load_dword v55, v54, s[60:61] sc1
  s_branch qkv_pass
qkv_p1end:
  s_branch fused_p1_done
qkv_loader:
  s_sub_u32 s23, s23, 4
  s_and_b32 s31, s30, 0xffffff80
  s_mov_b32 s32, s40
  s_lshl_b32 s33, s21, 7
  s_lshl_b32 s35, s23, 5
  s_add_u32 s33, s33, s35
  s_mul_i32 s38, s23, 6144
  s_lshl_b32 s39, s23, 12
  s_add_u32 s39, s39, 73728
  v_lshrrev_b32 v20, 3, v0
  v_and_b32 v21, 7, v0
  v_lshrrev_b32 v22, 1, v20
  v_xor_b32 v22, v22, v21
  v_add_u32 v23, s33, v20
  v_mul_u32_u24 v23, 1152, v23
  v_lshl_add_u32 v1, v22, 4, v23
  v_xor_b32 v2, 64, v1
  v_add_u32 v2, 9216, v2
  v_add_u32 v3, 18432, v1
  v_add_u32 v4, 18432, v2
  s_cmp_gt_u32 s32, 40
  s_cselect_b32 s32, 24, 16
  s_mul_i32 s35, s23, 55296
  s_add_u32 s31, s31, s35
  v_mov_b32 v25, 2146435072
  v_add_u32 v20, 0, v0
  v_mul_u32_u24 v21, 2731, v20
  v_lshrrev_b32 v21, 16, v21
  v_mul_u32_u24 v22, 24, v21
  v_sub_u32 v22, v20, v22
  v_and_b32 v23, 2, v21
  v_bfe_u32 v24, v21, 3, 1
  v_lshl_or_b32 v23, v24, 2, v23
  v_cmp_gt_u32 vcc, s32, v22
  v_xor_b32 v23, v23, v22
  v_mul_u32_u24 v21, 3456, v21
  v_lshl_add_u32 v23, v23, 4, v21
  v_add_u32 v23, s31, v23
  v_cndmask_b32 v9, v25, v23, vcc
  v_add_u32 v20, 64, v0
  v_mul_u32_u24 v21, 2731, v20
  v_lshrrev_b32 v21, 16, v21
  v_mul_u32_u24 v22, 24, v21
  v_sub_u32 v22, v20, v22
  v_and_b32 v23, 2, v21
  v_bfe_u32 v24, v21, 3, 1
  v_lshl_or_b32 v23, v24, 2, v23
  v_cmp_gt_u32 vcc, s32, v22
  v_xor_b32 v23, v23, v22
  v_mul_u32_u24 v21, 3456, v21
  v_lshl_add_u32 v23, v23, 4, v21
  v_add_u32 v23, s31, v23
  v_cndmask_b32 v10, v25, v23, vcc
  v_add_u32 v20, 128, v0
  v_mul_u32_u24 v21, 2731, v20
  v_lshrrev_b32 v21, 16, v21
  v_mul_u32_u24 v22, 24, v21
  v_sub_u32 v22, v20, v22
  v_and_b32 v23, 2, v21
  v_bfe_u32 v24, v21, 3, 1
  v_lshl_or_b32 v23, v24, 2, v23
  v_cmp_gt_u32 vcc, s32, v22
  v_xor_b32 v23, v23, v22
  v_mul_u32_u24 v21, 3456, v21
  v_lshl_add_u32 v23, v23, 4, v21
  v_add_u32 v23, s31, v23
  v_cndmask_b32 v11, v25, v23, vcc
  v_add_u32 v20, 192, v0
  v_mul_u32_u24 v21, 2731, v20
  v_lshrrev_b32 v21, 16, v21
  v_mul_u32_u24 v22, 24, v21
  v_sub_u32 v22, v20, v22
  v_and_b32 v23, 2, v21
  v_bfe_u32 v24, v21, 3, 1
  v_lshl_or_b32 v23, v24, 2, v23
  v_cmp_gt_u32 vcc, s32, v22
  v_xor_b32 v23, v23, v22
  v_mul_u32_u24 v21, 3456, v21
  v_lshl_add_u32 v23, v23, 4, v21
  v_add_u32 v23, s31, v23
  v_cndmask_b32 v12, v25, v23, vcc
  v_add_u32 v20, 256, v0
  v_mul_u32_u24 v21, 2731, v20
  v_lshrrev_b32 v21, 16, v21
  v_mul_u32_u24 v22, 24, v21
  v_sub_u32 v22, v20, v22
  v_and_b32 v23, 2, v21
  v_bfe_u32 v24, v21, 3, 1
  v_lshl_or_b32 v23, v24, 2, v23
  v_cmp_gt_u32 vcc, s32, v22
  v_xor_b32 v23, v23, v22
  v_mul_u32_u24 v21, 3456, v21
  v_lshl_add_u32 v23, v23, 4, v21
  v_add_u32 v23, s31, v23
  v_cndmask_b32 v13, v25, v23, vcc
  v_add_u32 v20, 320, v0
  v_mul_u32_u24 v21, 2731, v20
  v_lshrrev_b32 v21, 16, v21
  v_mul_u32_u24 v22, 24, v21
  v_sub_u32 v22, v20, v22
  v_and_b32 v23, 2, v21
  v_bfe_u32 v24, v21, 3, 1
  v_lshl_or_b32 v23, v24, 2, v23
  v_cmp_gt_u32 vcc, s32, v22
  v_xor_b32 v23, v23, v22
  v_mul_u32_u24 v21, 3456, v21
  v_lshl_add_u32 v23, v23, 4, v21
  v_add_u32 v23, s31, v23
  v_cndmask_b32 v14, v25, v23, vcc
  s_waitcnt lgkmcnt(0)
  s_mov_b32 s8, s4
  s_and_b32 s9, s5, 0xffff
  s_mov_b32 s10, 2359296
  s_mov_b32 s11, 0x00020000
  s_mov_b32 s12, s6
  s_and_b32 s13, s7, 0xffff
  s_mov_b32 s14, 1990656
  s_mov_b32 s15, 0x00020000
  s_mov_b32 s52, s34
  s_mov_b32 s53, s34
  s_mul_i32 s36, s53, 221184
  s_add_u32 s53, s53, 1
  s_cmp_eq_u32 s53, 9
  s_cselect_b32 s53, 0, s53
  s_add_u32 m0, s38, 0
  s_nop 0
  buffer_load_dwordx4 v9, s[12:15], s36 offen lds
  s_add_u32 m0, s38, 1024
  s_nop 0
  buffer_load_dwordx4 v10, s[12:15], s36 offen lds
  s_add_u32 m0, s38, 2048
  s_nop 0
  buffer_load_dwordx4 v11, s[12:15], s36 offen lds
  s_add_u32 m0, s38, 3072
  s_nop 0
  buffer_load_dwordx4 v12, s[12:15], s36 offen lds
  s_add_u32 m0, s38, 4096
  s_nop 0
  buffer_load_dwordx4 v13, s[12:15], s36 offen lds
  s_add_u32 m0, s38, 5120
  s_nop 0
  buffer_load_dwordx4 v14, s[12:15], s36 offen lds
  s_lshl_b32 s37, s52, 7
  s_add_u32 s52, s52, 1
  s_cmp_eq_u32 s52, 9
  s_cselect_b32 s52, 0, s52
  s_add_u32 m0, s39, 0
  s_nop 0
  buffer_load_dwordx4 v1, s[8:11], s37 offen lds
  s_add_u32 m0, s39, 1024
  s_nop 0
  buffer_load_dwordx4 v2, s[8:11], s37 offen lds
  s_add_u32 m0, s39, 2048
  s_nop 0
  buffer_load_dwordx4 v3, s[8:11], s37 offen lds
  s_add_u32 m0, s39, 3072
  s_nop 0
  buffer_load_dwordx4 v4, s[8:11], s37 offen lds
  s_mov_b32 s40, s24
  s_and_b32 s41, s25, 0xffff
  s_mov_b32 s42, 2359296
  s_mov_b32 s43, 0x00020000
  s_mov_b32 s44, s26
  s_and_b32 s45, s27, 0xffff
  s_mov_b32 s46, 1990656
  s_mov_b32 s47, 0x00020000
  s_lshl_b32 s37, s52, 7
  s_add_u32 s52, s52, 1
  s_cmp_eq_u32 s52, 9
  s_cselect_b32 s52, 0, s52
  s_add_u32 m0, s39, 16384
  s_nop 0
  buffer_load_dwordx4 v1, s[8:11], s37 offen lds
  s_add_u32 m0, s39, 17408
  s_nop 0
  buffer_load_dwordx4 v2, s[8:11], s37 offen lds
  s_add_u32 m0, s39, 18432
  s_nop 0
  buffer_load_dwordx4 v3, s[8:11], s37 offen lds
  s_add_u32 m0, s39, 19456
  s_nop 0
  buffer_load_dwordx4 v4, s[8:11], s37 offen lds
  s_mul_i32 s36, s53, 221184
  s_add_u32 s53, s53, 1
  s_cmp_eq_u32 s53, 9
  s_cselect_b32 s53, 0, s53
  s_add_u32 m0, s38, 24576
  s_nop 0
  buffer_load_dwordx4 v9, s[12:15], s36 offen lds
  s_add_u32 m0, s38, 25600
  s_nop 0
  buffer_load_dwordx4 v10, s[12:15], s36 offen lds
  s_add_u32 m0, s38, 26624
  s_nop 0
  buffer_load_dwordx4 v11, s[12:15], s36 offen lds
  s_add_u32 m0, s38, 27648
  s_nop 0
  buffer_load_dwordx4 v12, s[12:15], s36 offen lds
  s_add_u32 m0, s38, 28672
  s_nop 0
  buffer_load_dwordx4 v13, s[12:15], s36 offen lds
  s_add_u32 m0, s38, 29696
  s_nop 0
  buffer_load_dwordx4 v14, s[12:15], s36 offen lds
  s_waitcnt vmcnt(10)
  s_barrier
  s_mul_i32 s36, s53, 221184
  s_add_u32 s53, s53, 1
  s_cmp_eq_u32 s53, 9
  s_cselect_b32 s53, 0, s53
  s_add_u32 m0, s38, 49152
  s_nop 0
  buffer_load_dwordx4 v9, s[12:15], s36 offen lds
  s_add_u32 m0, s38, 50176
  s_nop 0
  buffer_load_dwordx4 v10, s[12:15], s36 offen lds
  s_add_u32 m0, s38, 51200
  s_nop 0
  buffer_load_dwordx4 v11, s[12:15], s36 offen lds
  s_add_u32 m0, s38, 52224
  s_nop 0
  buffer_load_dwordx4 v12, s[12:15], s36 offen lds
  s_add_u32 m0, s38, 53248
  s_nop 0
  buffer_load_dwordx4 v13, s[12:15], s36 offen lds
  s_add_u32 m0, s38, 54272
  s_nop 0
  buffer_load_dwordx4 v14, s[12:15], s36 offen lds
  s_lshl_b32 s37, s52, 7
  s_add_u32 s52, s52, 1
  s_cmp_eq_u32 s52, 9
  s_cselect_b32 s52, 0, s52
  s_add_u32 m0, s39, 32768
  s_nop 0
  buffer_load_dwordx4 v1, s[8:11], s37 offen lds
  s_add_u32 m0, s39, 33792
  s_nop 0
  buffer_load_dwordx4 v2, s[8:11], s37 offen lds
  s_add_u32 m0, s39, 34816
  s_nop 0
  buffer_load_dwordx4 v3, s[8:11], s37 offen lds
  s_add_u32 m0, s39, 35840
  s_nop 0
  buffer_load_dwordx4 v4, s[8:11], s37 offen lds
  s_waitcnt vmcnt(10)
  s_barrier
  s_mul_i32 s36, s53, 221184
  s_add_u32 s53, s53, 1
  s_cmp_eq_u32 s53, 9
  s_cselect_b32 s53, 0, s53
  s_add_u32 m0, s38, 0
  s_nop 0
  buffer_load_dwordx4 v9, s[12:15], s36 offen lds
  s_add_u32 m0, s38, 1024
  s_nop 0
  buffer_load_dwordx4 v10, s[12:15], s36 offen lds
  s_add_u32 m0, s38, 2048
  s_nop 0
  buffer_load_dwordx4 v11, s[12:15], s36 offen lds
  s_add_u32 m0, s38, 3072
  s_nop 0
  buffer_load_dwordx4 v12, s[12:15], s36 offen lds
  s_add_u32 m0, s38, 4096
  s_nop 0
  buffer_load_dwordx4 v13, s[12:15], s36 offen lds
  s_add_u32 m0, s38, 5120
  s_nop 0
  buffer_load_dwordx4 v14, s[12:15], s36 offen lds
  s_lshl_b32 s37, s52, 7
  s_add_u32 s52, s52, 1
  s_cmp_eq_u32 s52, 9
  s_cselect_b32 s52, 0, s52
  s_add_u32 m0, s39, 0
  s_nop 0
  buffer_load_dwordx4 v1, s[8:11], s37 offen lds
  s_add_u32 m0, s39, 1024
  s_nop 0
  buffer_load_dwordx4 v2, s[8:11], s37 offen lds
  s_add_u32 m0, s39, 2048
  s_nop 0
  buffer_load_dwordx4 v3, s[8:11], s37 offen lds
  s_add_u32 m0, s39, 3072
  s_nop 0
  buffer_load_dwordx4 v4, s[8:11], s37 offen lds
  s_waitcnt vmcnt(10)
  s_barrier
  s_mul_i32 s36, s53, 221184
  s_add_u32 s53, s53, 1
  s_cmp_eq_u32 s53, 9
  s_cselect_b32 s53, 0, s53
  s_add_u32 m0, s38, 24576
  s_nop 0
  buffer_load_dwordx4 v9, s[12:15], s36 offen lds
  s_add_u32 m0, s38, 25600
  s_nop 0
  buffer_load_dwordx4 v10, s[12:15], s36 offen lds
  s_add_u32 m0, s38, 26624
  s_nop 0
  buffer_load_dwordx4 v11, s[12:15], s36 offen lds
  s_add_u32 m0, s38, 27648
  s_nop 0
  buffer_load_dwordx4 v12, s[12:15], s36 offen lds
  s_add_u32 m0, s38, 28672
  s_nop 0
  buffer_load_dwordx4 v13, s[12:15], s36 offen lds
  s_add_u32 m0, s38, 29696
  s_nop 0
  buffer_load_dwordx4 v14, s[12:15], s36 offen lds
  s_lshl_b32 s37, s52, 7
  s_add_u32 s52, s52, 1
  s_cmp_eq_u32 s52, 9
  s_cselect_b32 s52, 0, s52
  s_add_u32 m0, s39, 16384
  s_nop 0
  buffer_load_dwordx4 v1, s[8:11], s37 offen lds
  s_add_u32 m0, s39, 17408
  s_nop 0
  buffer_load_dwordx4 v2, s[8:11], s37 offen lds
  s_add_u32 m0, s39, 18432
  s_nop 0
  buffer_load_dwordx4 v3, s[8:11], s37 offen lds
  s_add_u32 m0, s39, 19456
  s_nop 0
  buffer_load_dwordx4 v4, s[8:11], s37 offen lds
  s_waitcnt vmcnt(10)
  s_barrier
  s_mul_i32 s36, s53, 221184
  s_add_u32 s53, s53, 1
  s_cmp_eq_u32 s53, 9
  s_cselect_b32 s53, 0, s53
  s_add_u32 m0, s38, 49152
  s_nop 0
  buffer_load_dwordx4 v9, s[12:15], s36 offen lds
  s_add_u32 m0, s38, 50176
  s_nop 0
  buffer_load_dwordx4 v10, s[12:15], s36 offen lds
  s_add_u32 m0, s38, 51200
  s_nop 0
  buffer_load_dwordx4 v11, s[12:15], s36 offen lds
  s_add_u32 m0, s38, 52224
  s_nop 0
  buffer_load_dwordx4 v12, s[12:15], s36 offen lds
  s_add_u32 m0, s38, 53248
  s_nop 0
  buffer_load_dwordx4 v13, s[12:15], s36 offen lds
  s_add_u32 m0, s38, 54272
  s_nop 0
  buffer_load_dwordx4 v14, s[12:15], s36 offen lds
  s_lshl_b32 s37, s52, 7
  s_add_u32 s52, s52, 1
  s_cmp_eq_u32 s52, 9
  s_cselect_b32 s52, 0, s52
  s_add_u32 m0, s39, 32768
  s_nop 0
  buffer_load_dwordx4 v1, s[8:11], s37 offen lds
  s_add_u32 m0, s39, 33792
  s_nop 0
  buffer_load_dwordx4 v2, s[8:11], s37 offen lds
  s_add_u32 m0, s39, 34816
  s_nop 0
  buffer_load_dwordx4 v3, s[8:11], s37 offen lds
  s_add_u32 m0, s39, 35840
  s_nop 0
  buffer_load_dwordx4 v4, s[8:11], s37 offen lds
  s_waitcnt vmcnt(10)
  s_barrier
  s_mul_i32 s36, s53, 221184
  s_add_u32 s53, s53, 1
  s_cmp_eq_u32 s53, 9
  s_cselect_b32 s53, 0, s53
  s_add_u32 m0, s38, 0
  s_nop 0
  buffer_load_dwordx4 v9, s[12:15], s36 offen lds
  s_add_u32 m0, s38, 1024
  s_nop 0
  buffer_load_dwordx4 v10, s[12:15], s36 offen lds
  s_add_u32 m0, s38, 2048
  s_nop 0
  buffer_load_dwordx4 v11, s[12:15], s36 offen lds
  s_add_u32 m0, s38, 3072
  s_nop 0
  buffer_load_dwordx4 v12, s[12:15], s36 offen lds
  s_add_u32 m0, s38, 4096
  s_nop 0
  buffer_load_dwordx4 v13, s[12:15], s36 offen lds
  s_add_u32 m0, s38, 5120
  s_nop 0
  buffer_load_dwordx4 v14, s[12:15], s36 offen lds
  s_lshl_b32 s37, s52, 7
  s_add_u32 s52, s52, 1
  s_cmp_eq_u32 s52, 9
  s_cselect_b32 s52, 0, s52
  s_add_u32 m0, s39, 0
  s_nop 0
  buffer_load_dwordx4 v1, s[8:11], s37 offen lds
  s_add_u32 m0, s39, 1024
  s_nop 0
  buffer_load_dwordx4 v2, s[8:11], s37 offen lds
  s_add_u32 m0, s39, 2048
  s_nop 0
  buffer_load_dwordx4 v3, s[8:11], s37 offen lds
  s_add_u32 m0, s39, 3072
  s_nop 0
  buffer_load_dwordx4 v4, s[8:11], s37 offen lds
  s_waitcnt vmcnt(10)
  s_barrier
  s_mul_i32 s36, s53, 221184
  s_add_u32 s53, s53, 1
  s_cmp_eq_u32 s53, 9
  s_cselect_b32 s53, 0, s53
  s_add_u32 m0, s38, 24576
  s_nop 0
  buffer_load_dwordx4 v9, s[12:15], s36 offen lds
  s_add_u32 m0, s38, 25600
  s_nop 0
  buffer_load_dwordx4 v10, s[12:15], s36 offen lds
  s_add_u32 m0, s38, 26624
  s_nop 0
  buffer_load_dwordx4 v11, s[12:15], s36 offen lds
  s_add_u32 m0, s38, 27648
  s_nop 0
  buffer_load_dwordx4 v12, s[12:15], s36 offen lds
  s_add_u32 m0, s38, 28672
  s_nop 0
  buffer_load_dwordx4 v13, s[12:15], s36 offen lds
  s_add_u32 m0, s38, 29696
  s_nop 0
  buffer_load_dwordx4 v14, s[12:15], s36 offen lds
  s_lshl_b32 s37, s52, 7
  s_add_u32 s52, s52, 1
  s_cmp_eq_u32 s52, 9
  s_cselect_b32 s52, 0, s52
  s_add_u32 m0, s39, 16384
  s_nop 0
  buffer_load_dwordx4 v1, s[8:11], s37 offen lds
  s_add_u32 m0, s39, 17408
  s_nop 0
  buffer_load_dwordx4 v2, s[8:11], s37 offen lds
  s_add_u32 m0, s39, 18432
  s_nop 0
  buffer_load_dwordx4 v3, s[8:11], s37 offen lds
  s_add_u32 m0, s39, 19456
  s_nop 0
  buffer_load_dwordx4 v4, s[8:11], s37 offen lds
  s_waitcnt vmcnt(10)
  s_barrier
  s_mul_i32 s36, s53, 221184
  s_add_u32 s53, s53, 1
  s_cmp_eq_u32 s53, 9
  s_cselect_b32 s53, 0, s53
  s_add_u32 m0, s38, 49152
  s_nop 0
  buffer_load_dwordx4 v9, s[12:15], s36 offen lds
  s_add_u32 m0, s38, 50176
  s_nop 0
  buffer_load_dwordx4 v10, s[12:15], s36 offen lds
  s_add_u32 m0, s38, 51200
  s_nop 0
  buffer_load_dwordx4 v11, s[12:15], s36 offen lds
  s_add_u32 m0, s38, 52224
  s_nop 0
  buffer_load_dwordx4 v12, s[12:15], s36 offen lds
  s_add_u32 m0, s38, 53248
  s_nop 0
  buffer_load_dwordx4 v13, s[12:15], s36 offen lds
  s_add_u32 m0, s38, 54272
  s_nop 0
  buffer_load_dwordx4 v14, s[12:15], s36 offen lds
  s_lshl_b32 s37, s52, 7
  s_add_u32 s52, s52, 1
  s_cmp_eq_u32 s52, 9
  s_cselect_b32 s52, 0, s52
  s_add_u32 m0, s39, 32768
  s_nop 0
  buffer_load_dwordx4 v1, s[8:11], s37 offen lds
  s_add_u32 m0, s39, 33792
  s_nop 0
  buffer_load_dwordx4 v2, s[8:11], s37 offen lds
  s_add_u32 m0, s39, 34816
  s_nop 0
  buffer_load_dwordx4 v3, s[8:11], s37 offen lds
  s_add_u32 m0, s39, 35840
  s_nop 0
  buffer_load_dwordx4 v4, s[8:11], s37 offen lds
  s_waitcnt vmcnt(10)
  s_barrier
  s_mul_i32 s36, s53, 221184
  s_add_u32 s53, s53, 1
  s_cmp_eq_u32 s53, 9
  s_cselect_b32 s53, 0, s53
  s_add_u32 m0, s38, 0
  s_nop 0
  buffer_load_dwordx4 v9, s[44:47], s36 offen lds
  s_add_u32 m0, s38, 1024
  s_nop 0
  buffer_load_dwordx4 v10, s[44:47], s36 offen lds
  s_add_u32 m0, s38, 2048
  s_nop 0
  buffer_load_dwordx4 v11, s[44:47], s36 offen lds
  s_add_u32 m0, s38, 3072
  s_nop 0
  buffer_load_dwordx4 v12, s[44:47], s36 offen lds
  s_add_u32 m0, s38, 4096
  s_nop 0
  buffer_load_dwordx4 v13, s[44:47], s36 offen lds
  s_add_u32 m0, s38, 5120
  s_nop 0
  buffer_load_dwordx4 v14, s[44:47], s36 offen lds
  s_lshl_b32 s37, s52, 7
  s_add_u32 s52, s52, 1
  s_cmp_eq_u32 s52, 9
  s_cselect_b32 s52, 0, s52
  s_add_u32 m0, s39, 0
  s_nop 0
  buffer_load_dwordx4 v1, s[40:43], s37 offen lds
  s_add_u32 m0, s39, 1024
  s_nop 0
  buffer_load_dwordx4 v2, s[40:43], s37 offen lds
  s_add_u32 m0, s39, 2048
  s_nop 0
  buffer_load_dwordx4 v3, s[40:43], s37 offen lds
  s_add_u32 m0, s39, 3072
  s_nop 0
  buffer_load_dwordx4 v4, s[40:43], s37 offen lds
  s_waitcnt vmcnt(10)
  s_barrier
  s_mul_i32 s36, s53, 221184
  s_add_u32 s53, s53, 1
  s_cmp_eq_u32 s53, 9
  s_cselect_b32 s53, 0, s53
  s_add_u32 m0, s38, 24576
  s_nop 0
  buffer_load_dwordx4 v9, s[44:47], s36 offen lds
  s_add_u32 m0, s38, 25600
  s_nop 0
  buffer_load_dwordx4 v10, s[44:47], s36 offen lds
  s_add_u32 m0, s38, 26624
  s_nop 0
  buffer_load_dwordx4 v11, s[44:47], s36 offen lds
  s_add_u32 m0, s38, 27648
  s_nop 0
  buffer_load_dwordx4 v12, s[44:47], s36 offen lds
  s_add_u32 m0, s38, 28672
  s_nop 0
  buffer_load_dwordx4 v13, s[44:47], s36 offen lds
  s_add_u32 m0, s38, 29696
  s_nop 0
  buffer_load_dwordx4 v14, s[44:47], s36 offen lds
  s_lshl_b32 s37, s52, 7
  s_add_u32 s52, s52, 1
  s_cmp_eq_u32 s52, 9
  s_cselect_b32 s52, 0, s52
  s_add_u32 m0, s39, 16384
  s_nop 0
  buffer_load_dwordx4 v1, s[40:43], s37 offen lds
  s_add_u32 m0, s39, 17408
  s_nop 0
  buffer_load_dwordx4 v2, s[40:43], s37 offen lds
  s_add_u32 m0, s39, 18432
  s_nop 0
  buffer_load_dwordx4 v3, s[40:43], s37 offen lds
  s_add_u32 m0, s39, 19456
  s_nop 0
  buffer_load_dwordx4 v4, s[40:43], s37 offen lds
  s_waitcnt vmcnt(10)
  s_barrier
  s_mul_i32 s36, s53, 221184
  s_add_u32 s53, s53, 1
  s_cmp_eq_u32 s53, 9
  s_cselect_b32 s53, 0, s53
  s_add_u32 m0, s38, 49152
  s_nop 0
  buffer_load_dwordx4 v9, s[44:47], s36 offen lds
  s_add_u32 m0, s38, 50176
  s_nop 0
  buffer_load_dwordx4 v10, s[44:47], s36 offen lds
  s_add_u32 m0, s38, 51200
  s_nop 0
  buffer_load_dwordx4 v11, s[44:47], s36 offen lds
  s_add_u32 m0, s38, 52224
  s_nop 0
  buffer_load_dwordx4 v12, s[44:47], s36 offen lds
  s_add_u32 m0, s38, 53248
  s_nop 0
  buffer_load_dwordx4 v13, s[44:47], s36 offen lds
  s_add_u32 m0, s38, 54272
  s_nop 0
  buffer_load_dwordx4 v14, s[44:47], s36 offen lds
  s_lshl_b32 s37, s52, 7
  s_add_u32 s52, s52, 1
  s_cmp_eq_u32 s52, 9
  s_cselect_b32 s52, 0, s52
  s_add_u32 m0, s39, 32768
  s_nop 0
  buffer_load_dwordx4 v1, s[40:43], s37 offen lds
  s_add_u32 m0, s39, 33792
  s_nop 0
  buffer_load_dwordx4 v2, s[40:43], s37 offen lds
  s_add_u32 m0, s39, 34816
  s_nop 0
  buffer_load_dwordx4 v3, s[40:43], s37 offen lds
  s_add_u32 m0, s39, 35840
  s_nop 0
  buffer_load_dwordx4 v4, s[40:43], s37 offen lds
  s_waitcnt vmcnt(10)
  s_barrier
  s_mul_i32 s36, s53, 221184
  s_add_u32 s53, s53, 1
  s_cmp_eq_u32 s53, 9
  s_cselect_b32 s53, 0, s53
  s_add_u32 m0, s38, 0
  s_nop 0
  buffer_load_dwordx4 v9, s[44:47], s36 offen lds
  s_add_u32 m0, s38, 1024
  s_nop 0
  buffer_load_dwordx4 v10, s[44:47], s36 offen lds
  s_add_u32 m0, s38, 2048
  s_nop 0
  buffer_load_dwordx4 v11, s[44:47], s36 offen lds
  s_add_u32 m0, s38, 3072
  s_nop 0
  buffer_load_dwordx4 v12, s[44:47], s36 offen lds
  s_add_u32 m0, s38, 4096
  s_nop 0
  buffer_load_dwordx4 v13, s[44:47], s36 offen lds
  s_add_u32 m0, s38, 5120
  s_nop 0
  buffer_load_dwordx4 v14, s[44:47], s36 offen lds
  s_lshl_b32 s37, s52, 7
  s_add_u32 s52, s52, 1
  s_cmp_eq_u32 s52, 9
  s_cselect_b32 s52, 0, s52
  s_add_u32 m0, s39, 0
  s_nop 0
  buffer_load_dwordx4 v1, s[40:43], s37 offen lds
  s_add_u32 m0, s39, 1024
  s_nop 0
  buffer_load_dwordx4 v2, s[40:43], s37 offen lds
  s_add_u32 m0, s39, 2048
  s_nop 0
  buffer_load_dwordx4 v3, s[40:43], s37 offen lds
  s_add_u32 m0, s39, 3072
  s_nop 0
  buffer_load_dwordx4 v4, s[40:43], s37 offen lds
  s_waitcnt vmcnt(10)
  s_barrier
  s_mul_i32 s36, s53, 221184
  s_add_u32 s53, s53, 1
  s_cmp_eq_u32 s53, 9
  s_cselect_b32 s53, 0, s53
  s_add_u32 m0, s38, 24576
  s_nop 0
  buffer_load_dwordx4 v9, s[44:47], s36 offen lds
  s_add_u32 m0, s38, 25600
  s_nop 0
  buffer_load_dwordx4 v10, s[44:47], s36 offen lds
  s_add_u32 m0, s38, 26624
  s_nop 0
  buffer_load_dwordx4 v11, s[44:47], s36 offen lds
  s_add_u32 m0, s38, 27648
  s_nop 0
  buffer_load_dwordx4 v12, s[44:47], s36 offen lds
  s_add_u32 m0, s38, 28672
  s_nop 0
  buffer_load_dwordx4 v13, s[44:47], s36 offen lds
  s_add_u32 m0, s38, 29696
  s_nop 0
  buffer_load_dwordx4 v14, s[44:47], s36 offen lds
  s_lshl_b32 s37, s52, 7
  s_add_u32 s52, s52, 1
  s_cmp_eq_u32 s52, 9
  s_cselect_b32 s52, 0, s52
  s_add_u32 m0, s39, 16384
  s_nop 0
  buffer_load_dwordx4 v1, s[40:43], s37 offen lds
  s_add_u32 m0, s39, 17408
  s_nop 0
  buffer_load_dwordx4 v2, s[40:43], s37 offen lds
  s_add_u32 m0, s39, 18432
  s_nop 0
  buffer_load_dwordx4 v3, s[40:43], s37 offen lds
  s_add_u32 m0, s39, 19456
  s_nop 0
  buffer_load_dwordx4 v4, s[40:43], s37 offen lds
  s_waitcnt vmcnt(10)
  s_barrier
  s_mul_i32 s36, s53, 221184
  s_add_u32 s53, s53, 1
  s_cmp_eq_u32 s53, 9
  s_cselect_b32 s53, 0, s53
  s_add_u32 m0, s38, 49152
  s_nop 0
  buffer_load_dwordx4 v9, s[44:47], s36 offen lds
  s_add_u32 m0, s38, 50176
  s_nop 0
  buffer_load_dwordx4 v10, s[44:47], s36 offen lds
  s_add_u32 m0, s38, 51200
  s_nop 0
  buffer_load_dwordx4 v11, s[44:47], s36 offen lds
  s_add_u32 m0, s38, 52224
  s_nop 0
  buffer_load_dwordx4 v12, s[44:47], s36 offen lds
  s_add_u32 m0, s38, 53248
  s_nop 0
  buffer_load_dwordx4 v13, s[44:47], s36 offen lds
  s_add_u32 m0, s38, 54272
  s_nop 0
  buffer_load_dwordx4 v14, s[44:47], s36 offen lds
  s_lshl_b32 s37, s52, 7
  s_add_u32 s52, s52, 1
  s_cmp_eq_u32 s52, 9
  s_cselect_b32 s52, 0, s52
  s_add_u32 m0, s39, 32768
  s_nop 0
  buffer_load_dwordx4 v1, s[40:43], s37 offen lds
  s_add_u32 m0, s39, 33792
  s_nop 0
  buffer_load_dwordx4 v2, s[40:43], s37 offen lds
  s_add_u32 m0, s39, 34816
  s_nop 0
  buffer_load_dwordx4 v3, s[40:43], s37 offen lds
  s_add_u32 m0, s39, 35840
  s_nop 0
  buffer_load_dwordx4 v4, s[40:43], s37 offen lds
  s_waitcnt vmcnt(10)
  s_barrier
  s_mul_i32 s36, s53, 221184
  s_add_u32 s53, s53, 1
  s_cmp_eq_u32 s53, 9
  s_cselect_b32 s53, 0, s53
  s_add_u32 m0, s38, 0
  s_nop 0
  buffer_load_dwordx4 v9, s[44:47], s36 offen lds
  s_add_u32 m0, s38, 1024
  s_nop 0
  buffer_load_dwordx4 v10, s[44:47], s36 offen lds
  s_add_u32 m0, s38, 2048
  s_nop 0
  buffer_load_dwordx4 v11, s[44:47], s36 offen lds
  s_add_u32 m0, s38, 3072
  s_nop 0
  buffer_load_dwordx4 v12, s[44:47], s36 offen lds
  s_add_u32 m0, s38, 4096
  s_nop 0
  buffer_load_dwordx4 v13, s[44:47], s36 offen lds
  s_add_u32 m0, s38, 5120
  s_nop 0
  buffer_load_dwordx4 v14, s[44:47], s36 offen lds
  s_lshl_b32 s37, s52, 7
  s_add_u32 s52, s52, 1
  s_cmp_eq_u32 s52, 9
  s_cselect_b32 s52, 0, s52
  s_add_u32 m0, s39, 0
  s_nop 0
  buffer_load_dwordx4 v1, s[40:43], s37 offen lds
  s_add_u32 m0, s39, 1024
  s_nop 0
  buffer_load_dwordx4 v2, s[40:43], s37 offen lds
  s_add_u32 m0, s39, 2048
  s_nop 0
  buffer_load_dwordx4 v3, s[40:43], s37 offen lds
  s_add_u32 m0, s39, 3072
  s_nop 0
  buffer_load_dwordx4 v4, s[40:43], s37 offen lds
  s_waitcnt vmcnt(10)
  s_barrier
  s_mul_i32 s36, s53, 221184
  s_add_u32 s53, s53, 1
  s_cmp_eq_u32 s53, 9
  s_cselect_b32 s53, 0, s53
  s_add_u32 m0, s38, 24576
  s_nop 0
  buffer_load_dwordx4 v9, s[44:47], s36 offen lds
  s_add_u32 m0, s38, 25600
  s_nop 0
  buffer_load_dwordx4 v10, s[44:47], s36 offen lds
  s_add_u32 m0, s38, 26624
  s_nop 0
  buffer_load_dwordx4 v11, s[44:47], s36 offen lds
  s_add_u32 m0, s38, 27648
  s_nop 0
  buffer_load_dwordx4 v12, s[44:47], s36 offen lds
  s_add_u32 m0, s38, 28672
  s_nop 0
  buffer_load_dwordx4 v13, s[44:47], s36 offen lds
  s_add_u32 m0, s38, 29696
  s_nop 0
  buffer_load_dwordx4 v14, s[44:47], s36 offen lds
  s_lshl_b32 s37, s52, 7
  s_add_u32 s52, s52, 1
  s_cmp_eq_u32 s52, 9
  s_cselect_b32 s52, 0, s52
  s_add_u32 m0, s39, 16384
  s_nop 0
  buffer_load_dwordx4 v1, s[40:43], s37 offen lds
  s_add_u32 m0, s39, 17408
  s_nop 0
  buffer_load_dwordx4 v2, s[40:43], s37 offen lds
  s_add_u32 m0, s39, 18432
  s_nop 0
  buffer_load_dwordx4 v3, s[40:43], s37 offen lds
  s_add_u32 m0, s39, 19456
  s_nop 0
  buffer_load_dwordx4 v4, s[40:43], s37 offen lds
  s_waitcnt vmcnt(10)
  s_barrier
  s_mul_i32 s36, s53, 221184
  s_add_u32 s53, s53, 1
  s_cmp_eq_u32 s53, 9
  s_cselect_b32 s53, 0, s53
  s_add_u32 m0, s38, 49152
  s_nop 0
  buffer_load_dwordx4 v9, s[44:47], s36 offen lds
  s_add_u32 m0, s38, 50176
  s_nop 0
  buffer_load_dwordx4 v10, s[44:47], s36 offen lds
  s_add_u32 m0, s38, 51200
  s_nop 0
  buffer_load_dwordx4 v11, s[44:47], s36 offen lds
  s_add_u32 m0, s38, 52224
  s_nop 0
  buffer_load_dwordx4 v12, s[44:47], s36 offen lds
  s_add_u32 m0, s38, 53248
  s_nop 0
  buffer_load_dwordx4 v13, s[44:47], s36 offen lds
  s_add_u32 m0, s38, 54272
  s_nop 0
  buffer_load_dwordx4 v14, s[44:47], s36 offen lds
  s_lshl_b32 s37, s52, 7
  s_add_u32 s52, s52, 1
  s_cmp_eq_u32 s52, 9
  s_cselect_b32 s52, 0, s52
  s_add_u32 m0, s39, 32768
  s_nop 0
  buffer_load_dwordx4 v1, s[40:43], s37 offen lds
  s_add_u32 m0, s39, 33792
  s_nop 0
  buffer_load_dwordx4 v2, s[40:43], s37 offen lds
  s_add_u32 m0, s39, 34816
  s_nop 0
  buffer_load_dwordx4 v3, s[40:43], s37 offen lds
  s_add_u32 m0, s39, 35840
  s_nop 0
  buffer_load_dwordx4 v4, s[40:43], s37 offen lds
  s_waitcnt vmcnt(10)
  s_barrier
  s_waitcnt vmcnt(0)
  s_barrier
  s_branch fused_p1_done
fused_p1_done:
  v_mov_b32 v3, 151552
  ds_read_b32 v2, v3
  s_waitcnt lgkmcnt(0)
  v_readfirstlane_b32 s100, v2
  s_mov_b32 s59, 0
  s_load_dwordx2 s[4:5], s[0:1], 64
  s_load_dwordx2 s[6:7], s[0:1], 16
  s_load_dwordx2 s[40:41], s[0:1], 40
  s_mov_b32 s14, s101
  s_and_b32 s24, s2, 7
  s_lshr_b32 s25, s2, 3
  s_lshl_b32 s12, s24, 2
  s_and_b32 s26, s25, 3
  s_add_u32 s12, s12, s26
  s_lshr_b32 s13, s25, 2
  s_and_b32 s15, s14, 1
  s_lshr_b32 s16, s14, 1
  v_lshlrev_b32 v1, 4, v0
  v_and_b32 v7, 31, v0
  v_lshrrev_b32 v8, 5, v0
  v_lshlrev_b32 v2, 2, v7
  v_lshlrev_b32 v9, 8, v8
  v_lshl_add_u32 v9, v7, 4, v9
  v_lshlrev_b32 v10, 5, v8
  v_lshl_add_u32 v10, v7, 4, v10
  v_add_u32 v10, 768, v10
  v_cmp_gt_u32 vcc, 16, v7
  v_add_u32 v11, 512, v9
  v_add_u32 v12, 64, v10
  v_cndmask_b32 v3, v10, v9, vcc
  v_cndmask_b32 v212, v12, v11, vcc
  v_lshlrev_b32 v9, 30, v8
  v_or_b32 v4, v2, v9
  s_mov_b32 s22, 0x3ffff
  s_mov_b32 s23, 0x3ffff
  s_lshl_b32 s26, s12, 16
  s_lshl_b32 s27, s16, 14
  s_add_u32 s17, s26, s27
  s_add_u32 s17, s17, 2097152
  s_lshl_b32 s27, s12, 13
  s_lshl_b32 s28, s16, 11
  s_add_u32 s18, s27, s28
  s_add_u32 s18, s18, 4456448
  s_mul_i32 s28, s12, 73728
  s_mul_i32 s29, s16, 18432
  s_add_u32 s19, s28, s29
  s_add_u32 s19, s19, 4718592
  s_lshl_b32 s28, s13, 3
  s_lshl_b32 s29, s15, 2
  s_add_u32 s29, s28, s29
  s_add_u32 s32, s28, s14
  s_lshl_b32 s30, s29, 10
  s_add_u32 s30, s30, s26
  s_add_u32 s30, s30, 0
  s_lshl_b32 s31, s29, 7
  s_add_u32 s31, s31, s27
  s_add_u32 s31, s31, 4194304
  s_waitcnt lgkmcnt(0)
  s_mov_b32 s8, s4
  s_and_b32 s9, s5, 0xffff
  s_mov_b32 s10, 19922944
  s_mov_b32 s11, 0x00020000
  s_lshr_b32 s24, s12, 1
  s_mul_i32 s25, s24, 21846
  s_lshr_b32 s25, s25, 16
  s_add_u32 s24, s24, 16
  s_mul_i32 s28, s24, 21846
  s_lshr_b32 s28, s28, 16
  s_add_u32 s24, s24, 16
  s_mul_i32 s29, s24, 21846
  s_lshr_b32 s29, s29, 16
  v_lshrrev_b32 v14, 4, v0
  v_mov_b32 v15, s29
  v_mov_b32 v8, s28
  v_cmp_eq_u32 vcc, 1, v14
  v_mov_b32 v9, s25
  s_and_b32 s24, s13, 7
  v_cndmask_b32 v15, v15, v8, vcc
  v_cmp_eq_u32 vcc, 0, v14
  s_lshl_b32 s24, s24, 11
  s_add_u32 s24, s24, 19922944
  v_cndmask_b32 v15, v15, v9, vcc
  v_and_b32 v14, 15, v0
  v_lshlrev_b32 v14, 2, v14
  v_lshl_add_u32 v14, v15, 7, v14
  v_add_u32 v14, s24, v14
  v_mov_b32 v8, 151556
  s_cmp_ge_u32 s14, 4
  s_cbranch_scc1 attn_kernel_dopoll
  ds_read_b32 v9, v8
  s_waitcnt lgkmcnt(0)
  v_readfirstlane_b32 s24, v9
  s_nop 3
  s_cmp_eq_u32 s24, s100
  s_cbranch_scc1 attn_kernel_polled
attn_kernel_dopoll:
  s_cmp_eq_u32 s59, 1
  s_cbranch_scc1 attn_kernel_poll1_done
  s_mov_b32 s24, 131072
attn_kernel_poll1:
  global_load_dword v9, v14, s[4:5] sc1
  s_sub_u32 s24, s24, 1
  s_cmp_eq_u32 s24, 0
  s_cbranch_scc1 attn_kernel_poll1_x
  s_waitcnt vmcnt(0)
  v_cmp_ne_u32 vcc, s100, v9
  s_nop 1
  s_cmp_lg_u64 vcc, 0
  s_cbranch_scc1 attn_kernel_poll1
attn_kernel_poll1_x:
  s_waitcnt vmcnt(0)
attn_kernel_poll1_done:
  v_mov_b32 v9, s100
  ds_write_b32 v8, v9
attn_kernel_polled:
  buffer_load_dwordx4 v[172:175], v1, s[8:11], s17 offen sc1
  buffer_load_dword v176, v2, s[8:11], s18 offen sc1
  v_lshlrev_b32 v10, 2, v0
  buffer_load_dword v168, v10, s[8:11], s31 offen offset:0 sc1
  buffer_load_dword v170, v10, s[8:11], s31 offen offset:256 sc1
  buffer_load_dwordx4 v[152:155], v1, s[8:11], s30 offen offset:0 sc1
  buffer_load_dwordx4 v[156:159], v1, s[8:11], s30 offen offset:1024 sc1
  buffer_load_dwordx4 v[160:163], v1, s[8:11], s30 offen offset:2048 sc1
  buffer_load_dwordx4 v[164:167], v1, s[8:11], s30 offen offset:3072 sc1
  v_and_b32 v7, 27, v0
  v_cmp_eq_u32 vcc, 18, v7
  v_mov_b32 v8, 0x3f803f80
  s_nop 0
  v_cndmask_b32 v7, 0, v8, vcc
  v_mov_b32 v180, v7
  v_mov_b32 v184, v7
  v_mov_b32 v181, v7
  v_mov_b32 v185, v7
  v_mov_b32 v182, v7
  v_mov_b32 v186, v7
  v_mov_b32 v183, v7
  v_mov_b32 v187, v7
  s_mov_b64 exec, s[22:23]
  buffer_load_dwordx4 v[180:183], v3, s[8:11], s19 offen sc1
  buffer_load_dwordx4 v[184:187], v212, s[8:11], s19 offen sc1
  s_mov_b64 exec, -1
  s_add_u32 s17, s17, 1024
  s_add_u32 s18, s18, 128
  s_add_u32 s19, s19, 1152
  buffer_load_dwordx4 v[188:191], v1, s[8:11], s17 offen sc1
  buffer_load_dword v192, v2, s[8:11], s18 offen sc1
  s_add_u32 s17, s17, 1024
  s_add_u32 s18, s18, 128
  s_cmp_ge_u32 s2, 128
  s_cselect_b32 s6, s40, s6
  s_cselect_b32 s7, s41, s7
  s_mov_b32 s36, s6
  s_and_b32 s37, s7, 0xffff
  s_mov_b32 s38, 663552
  s_mov_b32 s39, 0x00020000
  v_and_b32 v7, 27, v0
  v_cmp_eq_u32 vcc, 18, v7
  v_mov_b32 v8, 0x3f803f80
  s_nop 0
  v_cndmask_b32 v7, 0, v8, vcc
  v_mov_b32 v177, 0x3f803f80
  v_mov_b32 v178, 0
  v_mov_b32 v179, 0
  v_mov_b32 v193, 0x3f803f80
  v_mov_b32 v194, 0
  v_mov_b32 v195, 0
  v_mov_b32 v196, v7
  v_mov_b32 v200, v7
  v_mov_b32 v197, v7
  v_mov_b32 v201, v7
  v_mov_b32 v198, v7
  v_mov_b32 v202, v7
  v_mov_b32 v199, v7
  v_mov_b32 v203, v7
  v_mov_b32 v209, 0
  v_mov_b32 v210, 0
  v_mov_b32 v211, 0
  v_pk_mul_f32 v[16:17], v[178:179], v[178:179]
  v_pk_mul_f32 v[18:19], v[178:179], v[178:179]
  v_pk_mul_f32 v[20:21], v[178:179], v[178:179]
  v_pk_mul_f32 v[22:23], v[178:179], v[178:179]
  v_pk_mul_f32 v[24:25], v[178:179], v[178:179]
  v_pk_mul_f32 v[26:27], v[178:179], v[178:179]
  v_pk_mul_f32 v[28:29], v[178:179], v[178:179]
  v_pk_mul_f32 v[30:31], v[178:179], v[178:179]
  v_pk_mul_f32 v[32:33], v[178:179], v[178:179]
  v_pk_mul_f32 v[34:35], v[178:179], v[178:179]
  v_pk_mul_f32 v[36:37], v[178:179], v[178:179]
  v_pk_mul_f32 v[38:39], v[178:179], v[178:179]
  v_pk_mul_f32 v[40:41], v[178:179], v[178:179]
  v_pk_mul_f32 v[42:43], v[178:179], v[178:179]
  v_pk_mul_f32 v[44:45], v[178:179], v[178:179]
  v_pk_mul_f32 v[46:47], v[178:179], v[178:179]
  v_pk_mul_f32 v[48:49], v[178:179], v[178:179]
  v_pk_mul_f32 v[50:51], v[178:179], v[178:179]
  v_pk_mul_f32 v[52:53], v[178:179], v[178:179]
  v_pk_mul_f32 v[54:55], v[178:179], v[178:179]
  v_pk_mul_f32 v[56:57], v[178:179], v[178:179]
  v_pk_mul_f32 v[58:59], v[178:179], v[178:179]
  v_pk_mul_f32 v[60:61], v[178:179], v[178:179]
  v_pk_mul_f32 v[62:63], v[178:179], v[178:179]
  v_pk_mul_f32 v[64:65], v[178:179], v[178:179]
  v_pk_mul_f32 v[66:67], v[178:179], v[178:179]
  v_pk_mul_f32 v[68:69], v[178:179], v[178:179]
  v_pk_mul_f32 v[70:71], v[178:179], v[178:179]
  v_pk_mul_f32 v[72:73], v[178:179], v[178:179]
  v_pk_mul_f32 v[74:75], v[178:179], v[178:179]
  v_pk_mul_f32 v[76:77], v[178:179], v[178:179]
  v_pk_mul_f32 v[78:79], v[178:179], v[178:179]
  v_mov_b32 v169, 0
  v_mov_b32 v171, 0
  v_mov_b32 v148, 0
  v_mov_b32 v149, 0
  v_mov_b32 v150, 0
  v_mov_b32 v151, 0
  v_and_b32 v7, 31, v0
  v_lshrrev_b32 v8, 5, v0
  v_lshrrev_b32 v9, 4, v7
  v_mul_u32_u24 v9, 18432, v9
  v_and_b32 v10, 15, v7
  v_lshl_add_u32 v9, v10, 4, v9
  v_lshl_add_u32 v5, v8, 8, v9
  s_mul_i32 s28, s32, 36864
  s_add_u32 s28, s28, 14680064
  s_lshr_b32 s29, s12, 1
  s_lshl_b32 s29, s29, 10
  s_add_u32 s33, s28, s29
  s_and_b32 s29, s12, 1
  s_lshl_b32 s29, s29, 9
  s_add_u32 s33, s33, s29
  s_lshl_b32 s28, s12, 13
  s_lshl_b32 s29, s32, 7
  s_add_u32 s28, s28, s29
  s_add_u32 s34, s28, 19398656
  v_mov_b32 v6, v4
  s_waitcnt vmcnt(4)
  v_mfma_f32_32x32x4bf16_1k v[80:111], v[176:177], v[168:169], 0
  s_waitcnt vmcnt(0)
  s_cmp_ge_u32 s14, 4
  s_cbranch_scc1 attn_kernel_nosigb
  s_and_b32 s28, s2, 1
  s_lshl_b32 s24, s28, 3
  s_bfe_u32 s28, s2, 0x30003
  s_add_u32 s24, s24, s28
  s_bfe_u32 s28, s2, 0x20001
  s_lshl_b32 s25, s28, 2
  s_lshr_b32 s29, s2, 6
  s_add_u32 s25, s25, s29
  s_lshl_b32 s25, s25, 8
  s_lshl_b32 s24, s24, 4
  s_add_u32 s24, s24, s25
  s_lshl_b32 s25, s14, 2
  s_add_u32 s24, s24, s25
  s_add_u32 s24, s24, 19939328
  v_mul_u32_u24 v8, 4096, v0
  v_add_u32 v8, s24, v8
  v_mov_b32 v9, s100
  s_mov_b64 exec, 255
  global_store_dword v8, v9, s[4:5] sc1
  s_mov_b64 exec, -1
attn_kernel_nosigb:
  s_nop 7
  s_nop 7
  v_mfma_f32_32x32x16_bf16 v[80:95], v[172:175], v[152:155], v[80:95]
  v_mfma_f32_32x32x16_bf16 v[96:111], v[172:175], v[156:159], v[96:111]
  s_nop 7
  s_nop 3
  s_mov_b32 s20, 7
attn_kernel_loop:
  v_exp_f32 v80, v80
  v_exp_f32 v81, v81
  v_mfma_f32_32x32x16_bf16 v[64:79], v[200:203], v[148:151], v[64:79]
  s_mov_b64 exec, s[22:23]
  buffer_load_dwordx4 v[196:199], v3, s[8:11], s19 offen offset:0 sc1
  buffer_load_dwordx4 v[200:203], v212, s[8:11], s19 offen offset:0 sc1
  s_mov_b64 exec, -1
  v_exp_f32 v82, v82
  v_exp_f32 v83, v83
  v_cvt_pk_bf16_f32 v144, v80, v81
  v_exp_f32 v84, v84
  v_mfma_f32_32x32x4bf16_1k v[112:143], v[176:177], v[170:171], 0
  v_cvt_pk_bf16_f32 v145, v82, v83
  v_exp_f32 v85, v85
  v_exp_f32 v86, v86
  v_exp_f32 v87, v87
  v_cvt_pk_bf16_f32 v146, v84, v85
  v_exp_f32 v88, v88
  v_cvt_pk_bf16_f32 v147, v86, v87
  v_exp_f32 v89, v89
  v_exp_f32 v90, v90
  v_exp_f32 v91, v91
  v_cvt_pk_bf16_f32 v148, v88, v89
  v_exp_f32 v92, v92
  v_cvt_pk_bf16_f32 v149, v90, v91
  s_waitcnt vmcnt(4)
  v_mfma_f32_32x32x16_bf16 v[16:31], v[180:183], v[144:147], v[16:31]
  v_exp_f32 v93, v93
  v_exp_f32 v94, v94
  v_exp_f32 v95, v95
  v_cvt_pk_bf16_f32 v150, v92, v93
  v_cvt_pk_bf16_f32 v151, v94, v95
  v_exp_f32 v96, v96
  v_exp_f32 v97, v97
  v_mfma_f32_32x32x16_bf16 v[16:31], v[184:187], v[148:151], v[16:31]
  v_exp_f32 v98, v98
  v_exp_f32 v99, v99
  v_cvt_pk_bf16_f32 v144, v96, v97
  v_exp_f32 v100, v100
  v_mfma_f32_32x32x16_bf16 v[112:127], v[172:175], v[160:163], v[112:127]
  v_cvt_pk_bf16_f32 v145, v98, v99
  v_exp_f32 v101, v101
  v_exp_f32 v102, v102
  v_exp_f32 v103, v103
  v_cvt_pk_bf16_f32 v146, v100, v101
  v_exp_f32 v104, v104
  v_mfma_f32_32x32x16_bf16 v[128:143], v[172:175], v[164:167], v[128:143]
  v_cvt_pk_bf16_f32 v147, v102, v103
  v_exp_f32 v105, v105
  v_exp_f32 v106, v106
  v_exp_f32 v107, v107
  v_cvt_pk_bf16_f32 v148, v104, v105
  v_exp_f32 v108, v108
  v_cvt_pk_bf16_f32 v149, v106, v107
  v_mfma_f32_32x32x16_bf16 v[32:47], v[180:183], v[144:147], v[32:47]
  v_exp_f32 v109, v109
  v_exp_f32 v110, v110
  v_exp_f32 v111, v111
  v_cvt_pk_bf16_f32 v150, v108, v109
  v_cvt_pk_bf16_f32 v151, v110, v111
  v_exp_f32 v112, v112
  v_exp_f32 v113, v113
  v_mfma_f32_32x32x16_bf16 v[32:47], v[184:187], v[148:151], v[32:47]
  v_exp_f32 v114, v114
  v_exp_f32 v115, v115
  v_cvt_pk_bf16_f32 v144, v112, v113
  v_exp_f32 v116, v116
  s_waitcnt vmcnt(2)
  v_mfma_f32_32x32x4bf16_1k v[80:111], v[192:193], v[168:169], 0
  v_cvt_pk_bf16_f32 v145, v114, v115
  v_exp_f32 v117, v117
  v_exp_f32 v118, v118
  v_exp_f32 v119, v119
  v_cvt_pk_bf16_f32 v146, v116, v117
  v_exp_f32 v120, v120
  v_cvt_pk_bf16_f32 v147, v118, v119
  v_exp_f32 v121, v121
  v_exp_f32 v122, v122
  v_exp_f32 v123, v123
  v_cvt_pk_bf16_f32 v148, v120, v121
  v_exp_f32 v124, v124
  v_cvt_pk_bf16_f32 v149, v122, v123
  v_mfma_f32_32x32x16_bf16 v[48:63], v[180:183], v[144:147], v[48:63]
  v_exp_f32 v125, v125
  v_exp_f32 v126, v126
  v_exp_f32 v127, v127
  v_cvt_pk_bf16_f32 v150, v124, v125
  v_cvt_pk_bf16_f32 v151, v126, v127
  v_exp_f32 v128, v128
  v_exp_f32 v129, v129
  v_mfma_f32_32x32x16_bf16 v[48:63], v[184:187], v[148:151], v[48:63]
  v_exp_f32 v130, v130
  v_exp_f32 v131, v131
  v_cvt_pk_bf16_f32 v144, v128, v129
  v_exp_f32 v132, v132
  v_mfma_f32_32x32x16_bf16 v[80:95], v[188:191], v[152:155], v[80:95]
  v_cvt_pk_bf16_f32 v145, v130, v131
  v_exp_f32 v133, v133
  v_exp_f32 v134, v134
  v_exp_f32 v135, v135
  v_cvt_pk_bf16_f32 v146, v132, v133
  v_exp_f32 v136, v136
  v_mfma_f32_32x32x16_bf16 v[96:111], v[188:191], v[156:159], v[96:111]
  buffer_load_dwordx4 v[172:175], v1, s[8:11], s17 offen offset:0 sc1
  buffer_load_dword v176, v2, s[8:11], s18 offen offset:0 sc1
  v_cvt_pk_bf16_f32 v147, v134, v135
  v_exp_f32 v137, v137
  v_exp_f32 v138, v138
  v_exp_f32 v139, v139
  v_cvt_pk_bf16_f32 v148, v136, v137
  v_exp_f32 v140, v140
  v_cvt_pk_bf16_f32 v149, v138, v139
  v_mfma_f32_32x32x16_bf16 v[64:79], v[180:183], v[144:147], v[64:79]
  v_exp_f32 v141, v141
  v_exp_f32 v142, v142
  v_exp_f32 v143, v143
  v_cvt_pk_bf16_f32 v150, v140, v141
  v_cvt_pk_bf16_f32 v151, v142, v143
  v_exp_f32 v80, v80
  v_exp_f32 v81, v81
  v_mfma_f32_32x32x16_bf16 v[64:79], v[184:187], v[148:151], v[64:79]
  s_mov_b64 exec, s[22:23]
  buffer_load_dwordx4 v[180:183], v3, s[8:11], s19 offen offset:1152 sc1
  buffer_load_dwordx4 v[184:187], v212, s[8:11], s19 offen offset:1152 sc1
  s_mov_b64 exec, -1
  s_add_u32 s19, s19, 2304
  v_exp_f32 v82, v82
  v_exp_f32 v83, v83
  v_cvt_pk_bf16_f32 v144, v80, v81
  v_exp_f32 v84, v84
  v_mfma_f32_32x32x4bf16_1k v[112:143], v[192:193], v[170:171], 0
  v_cvt_pk_bf16_f32 v145, v82, v83
  v_exp_f32 v85, v85
  v_exp_f32 v86, v86
  v_exp_f32 v87, v87
  v_cvt_pk_bf16_f32 v146, v84, v85
  v_exp_f32 v88, v88
  v_cvt_pk_bf16_f32 v147, v86, v87
  v_exp_f32 v89, v89
  v_exp_f32 v90, v90
  v_exp_f32 v91, v91
  v_cvt_pk_bf16_f32 v148, v88, v89
  v_exp_f32 v92, v92
  v_cvt_pk_bf16_f32 v149, v90, v91
  s_waitcnt vmcnt(4)
  v_mfma_f32_32x32x16_bf16 v[16:31], v[196:199], v[144:147], v[16:31]
  v_exp_f32 v93, v93
  v_exp_f32 v94, v94
  v_exp_f32 v95, v95
  v_cvt_pk_bf16_f32 v150, v92, v93
  v_cvt_pk_bf16_f32 v151, v94, v95
  v_exp_f32 v96, v96
  v_exp_f32 v97, v97
  v_mfma_f32_32x32x16_bf16 v[16:31], v[200:203], v[148:151], v[16:31]
  v_exp_f32 v98, v98
  v_exp_f32 v99, v99
  v_cvt_pk_bf16_f32 v144, v96, v97
  v_exp_f32 v100, v100
  v_mfma_f32_32x32x16_bf16 v[112:127], v[188:191], v[160:163], v[112:127]
  v_cvt_pk_bf16_f32 v145, v98, v99
  v_exp_f32 v101, v101
  v_exp_f32 v102, v102
  v_exp_f32 v103, v103
  v_cvt_pk_bf16_f32 v146, v100, v101
  v_exp_f32 v104, v104
  v_mfma_f32_32x32x16_bf16 v[128:143], v[188:191], v[164:167], v[128:143]
  v_cvt_pk_bf16_f32 v147, v102, v103
  v_exp_f32 v105, v105
  v_exp_f32 v106, v106
  v_exp_f32 v107, v107
  v_cvt_pk_bf16_f32 v148, v104, v105
  v_exp_f32 v108, v108
  v_cvt_pk_bf16_f32 v149, v106, v107
  v_mfma_f32_32x32x16_bf16 v[32:47], v[196:199], v[144:147], v[32:47]
  v_exp_f32 v109, v109
  v_exp_f32 v110, v110
  v_exp_f32 v111, v111
  v_cvt_pk_bf16_f32 v150, v108, v109
  v_cvt_pk_bf16_f32 v151, v110, v111
  v_exp_f32 v112, v112
  v_exp_f32 v113, v113
  v_mfma_f32_32x32x16_bf16 v[32:47], v[200:203], v[148:151], v[32:47]
  v_exp_f32 v114, v114
  v_exp_f32 v115, v115
  v_cvt_pk_bf16_f32 v144, v112, v113
  v_exp_f32 v116, v116
  s_waitcnt vmcnt(2)
  v_mfma_f32_32x32x4bf16_1k v[80:111], v[176:177], v[168:169], 0
  v_cvt_pk_bf16_f32 v145, v114, v115
  v_exp_f32 v117, v117
  v_exp_f32 v118, v118
  v_exp_f32 v119, v119
  v_cvt_pk_bf16_f32 v146, v116, v117
  v_exp_f32 v120, v120
  v_cvt_pk_bf16_f32 v147, v118, v119
  v_exp_f32 v121, v121
  v_exp_f32 v122, v122
  v_exp_f32 v123, v123
  v_cvt_pk_bf16_f32 v148, v120, v121
  v_exp_f32 v124, v124
  v_cvt_pk_bf16_f32 v149, v122, v123
  v_mfma_f32_32x32x16_bf16 v[48:63], v[196:199], v[144:147], v[48:63]
  v_exp_f32 v125, v125
  v_exp_f32 v126, v126
  v_exp_f32 v127, v127
  v_cvt_pk_bf16_f32 v150, v124, v125
  v_cvt_pk_bf16_f32 v151, v126, v127
  v_exp_f32 v128, v128
  v_exp_f32 v129, v129
  v_mfma_f32_32x32x16_bf16 v[48:63], v[200:203], v[148:151], v[48:63]
  v_exp_f32 v130, v130
  v_exp_f32 v131, v131
  v_cvt_pk_bf16_f32 v144, v128, v129
  v_exp_f32 v132, v132
  v_mfma_f32_32x32x16_bf16 v[80:95], v[172:175], v[152:155], v[80:95]
  v_cvt_pk_bf16_f32 v145, v130, v131
  v_exp_f32 v133, v133
  v_exp_f32 v134, v134
  v_exp_f32 v135, v135
  v_cvt_pk_bf16_f32 v146, v132, v133
  v_exp_f32 v136, v136
  v_mfma_f32_32x32x16_bf16 v[96:111], v[172:175], v[156:159], v[96:111]
  buffer_load_dwordx4 v[188:191], v1, s[8:11], s17 offen offset:1024 sc1
  buffer_load_dword v192, v2, s[8:11], s18 offen offset:128 sc1
  s_add_u32 s17, s17, 2048
  s_add_u32 s18, s18, 256
  v_cvt_pk_bf16_f32 v147, v134, v135
  v_exp_f32 v137, v137
  v_exp_f32 v138, v138
  v_exp_f32 v139, v139
  v_cvt_pk_bf16_f32 v148, v136, v137
  v_exp_f32 v140, v140
  v_cvt_pk_bf16_f32 v149, v138, v139
  v_mfma_f32_32x32x16_bf16 v[64:79], v[196:199], v[144:147], v[64:79]
  v_exp_f32 v141, v141
  v_exp_f32 v142, v142
  v_exp_f32 v143, v143
  v_cvt_pk_bf16_f32 v150, v140, v141
  v_cvt_pk_bf16_f32 v151, v142, v143
  s_sub_u32 s20, s20, 1
  s_cmp_lg_u32 s20, 0
  s_cbranch_scc1 attn_kernel_loop
  s_lshl_b32 s24, s15, 2
  s_mul_i32 s24, s24, 12288
  s_mul_i32 s25, s16, 3072
  s_add_u32 s24, s24, s25
  v_add_u32 v7, s24, v1
  v_exp_f32 v80, v80
  v_exp_f32 v81, v81
  v_mfma_f32_32x32x16_bf16 v[64:79], v[200:203], v[148:151], v[64:79]
  s_mov_b64 exec, s[22:23]
  buffer_load_dwordx4 v[196:199], v3, s[8:11], s19 offen offset:0 sc1
  buffer_load_dwordx4 v[200:203], v212, s[8:11], s19 offen offset:0 sc1
  s_mov_b64 exec, -1
  v_exp_f32 v82, v82
  v_exp_f32 v83, v83
  v_cvt_pk_bf16_f32 v144, v80, v81
  v_exp_f32 v84, v84
  v_mfma_f32_32x32x4bf16_1k v[112:143], v[176:177], v[170:171], 0
  v_cvt_pk_bf16_f32 v145, v82, v83
  v_exp_f32 v85, v85
  v_exp_f32 v86, v86
  v_exp_f32 v87, v87
  v_cvt_pk_bf16_f32 v146, v84, v85
  v_exp_f32 v88, v88
  v_cvt_pk_bf16_f32 v147, v86, v87
  v_exp_f32 v89, v89
  v_exp_f32 v90, v90
  v_exp_f32 v91, v91
  v_cvt_pk_bf16_f32 v148, v88, v89
  v_exp_f32 v92, v92
  v_cvt_pk_bf16_f32 v149, v90, v91
  s_waitcnt vmcnt(4)
  v_mfma_f32_32x32x16_bf16 v[16:31], v[180:183], v[144:147], v[16:31]
  v_exp_f32 v93, v93
  v_exp_f32 v94, v94
  v_exp_f32 v95, v95
  v_cvt_pk_bf16_f32 v150, v92, v93
  v_cvt_pk_bf16_f32 v151, v94, v95
  v_exp_f32 v96, v96
  v_exp_f32 v97, v97
  v_mfma_f32_32x32x16_bf16 v[16:31], v[184:187], v[148:151], v[16:31]
  v_exp_f32 v98, v98
  v_exp_f32 v99, v99
  v_cvt_pk_bf16_f32 v144, v96, v97
  v_exp_f32 v100, v100
  v_mfma_f32_32x32x16_bf16 v[112:127], v[172:175], v[160:163], v[112:127]
  v_cvt_pk_bf16_f32 v145, v98, v99
  v_exp_f32 v101, v101
  v_exp_f32 v102, v102
  v_exp_f32 v103, v103
  v_cvt_pk_bf16_f32 v146, v100, v101
  v_exp_f32 v104, v104
  v_mfma_f32_32x32x16_bf16 v[128:143], v[172:175], v[164:167], v[128:143]
  v_cvt_pk_bf16_f32 v147, v102, v103
  v_exp_f32 v105, v105
  v_exp_f32 v106, v106
  v_exp_f32 v107, v107
  v_cvt_pk_bf16_f32 v148, v104, v105
  v_exp_f32 v108, v108
  v_cvt_pk_bf16_f32 v149, v106, v107
  v_mfma_f32_32x32x16_bf16 v[32:47], v[180:183], v[144:147], v[32:47]
  v_exp_f32 v109, v109
  v_exp_f32 v110, v110
  v_exp_f32 v111, v111
  v_cvt_pk_bf16_f32 v150, v108, v109
  v_cvt_pk_bf16_f32 v151, v110, v111
  v_exp_f32 v112, v112
  v_exp_f32 v113, v113
  v_mfma_f32_32x32x16_bf16 v[32:47], v[184:187], v[148:151], v[32:47]
  v_exp_f32 v114, v114
  v_exp_f32 v115, v115
  v_cvt_pk_bf16_f32 v144, v112, v113
  v_exp_f32 v116, v116
  s_waitcnt vmcnt(2)
  v_mfma_f32_32x32x4bf16_1k v[80:111], v[192:193], v[168:169], 0
  v_cvt_pk_bf16_f32 v145, v114, v115
  v_exp_f32 v117, v117
  v_exp_f32 v118, v118
  v_exp_f32 v119, v119
  v_cvt_pk_bf16_f32 v146, v116, v117
  v_exp_f32 v120, v120
  v_cvt_pk_bf16_f32 v147, v118, v119
  v_exp_f32 v121, v121
  v_exp_f32 v122, v122
  v_exp_f32 v123, v123
  v_cvt_pk_bf16_f32 v148, v120, v121
  v_exp_f32 v124, v124
  v_cvt_pk_bf16_f32 v149, v122, v123
  v_mfma_f32_32x32x16_bf16 v[48:63], v[180:183], v[144:147], v[48:63]
  v_exp_f32 v125, v125
  v_exp_f32 v126, v126
  v_exp_f32 v127, v127
  v_cvt_pk_bf16_f32 v150, v124, v125
  v_cvt_pk_bf16_f32 v151, v126, v127
  v_exp_f32 v128, v128
  v_exp_f32 v129, v129
  v_mfma_f32_32x32x16_bf16 v[48:63], v[184:187], v[148:151], v[48:63]
  v_exp_f32 v130, v130
  v_exp_f32 v131, v131
  v_cvt_pk_bf16_f32 v144, v128, v129
  v_exp_f32 v132, v132
  v_mfma_f32_32x32x16_bf16 v[80:95], v[188:191], v[152:155], v[80:95]
  v_cvt_pk_bf16_f32 v145, v130, v131
  v_exp_f32 v133, v133
  v_exp_f32 v134, v134
  v_exp_f32 v135, v135
  v_cvt_pk_bf16_f32 v146, v132, v133
  v_exp_f32 v136, v136
  v_mfma_f32_32x32x16_bf16 v[96:111], v[188:191], v[156:159], v[96:111]
  v_cvt_pk_bf16_f32 v147, v134, v135
  v_exp_f32 v137, v137
  v_exp_f32 v138, v138
  v_exp_f32 v139, v139
  v_cvt_pk_bf16_f32 v148, v136, v137
  v_exp_f32 v140, v140
  v_cvt_pk_bf16_f32 v149, v138, v139
  v_mfma_f32_32x32x16_bf16 v[64:79], v[180:183], v[144:147], v[64:79]
  v_exp_f32 v141, v141
  v_exp_f32 v142, v142
  v_exp_f32 v143, v143
  v_cvt_pk_bf16_f32 v150, v140, v141
  v_cvt_pk_bf16_f32 v151, v142, v143
  v_exp_f32 v80, v80
  v_exp_f32 v81, v81
  v_mfma_f32_32x32x16_bf16 v[64:79], v[184:187], v[148:151], v[64:79]
  v_exp_f32 v82, v82
  v_exp_f32 v83, v83
  v_cvt_pk_bf16_f32 v144, v80, v81
  v_exp_f32 v84, v84
  v_mfma_f32_32x32x4bf16_1k v[112:143], v[192:193], v[170:171], 0
  v_cvt_pk_bf16_f32 v145, v82, v83
  v_exp_f32 v85, v85
  v_exp_f32 v86, v86
  v_exp_f32 v87, v87
  v_cvt_pk_bf16_f32 v146, v84, v85
  v_exp_f32 v88, v88
  v_cvt_pk_bf16_f32 v147, v86, v87
  v_exp_f32 v89, v89
  v_exp_f32 v90, v90
  v_exp_f32 v91, v91
  v_cvt_pk_bf16_f32 v148, v88, v89
  v_exp_f32 v92, v92
  v_cvt_pk_bf16_f32 v149, v90, v91
  s_waitcnt vmcnt(0)
  v_mfma_f32_32x32x16_bf16 v[16:31], v[196:199], v[144:147], v[16:31]
  v_exp_f32 v93, v93
  v_exp_f32 v94, v94
  v_exp_f32 v95, v95
  v_cvt_pk_bf16_f32 v150, v92, v93
  v_cvt_pk_bf16_f32 v151, v94, v95
  v_exp_f32 v96, v96
  v_exp_f32 v97, v97
  v_mfma_f32_32x32x16_bf16 v[16:31], v[200:203], v[148:151], v[16:31]
  v_exp_f32 v98, v98
  v_exp_f32 v99, v99
  v_cvt_pk_bf16_f32 v144, v96, v97
  v_exp_f32 v100, v100
  v_mfma_f32_32x32x16_bf16 v[112:127], v[188:191], v[160:163], v[112:127]
  v_cvt_pk_bf16_f32 v145, v98, v99
  v_exp_f32 v101, v101
  v_exp_f32 v102, v102
  v_exp_f32 v103, v103
  v_cvt_pk_bf16_f32 v146, v100, v101
  v_exp_f32 v104, v104
  v_mfma_f32_32x32x16_bf16 v[128:143], v[188:191], v[164:167], v[128:143]
  v_cvt_pk_bf16_f32 v147, v102, v103
  v_exp_f32 v105, v105
  v_exp_f32 v106, v106
  v_exp_f32 v107, v107
  v_cvt_pk_bf16_f32 v148, v104, v105
  v_exp_f32 v108, v108
  v_cvt_pk_bf16_f32 v149, v106, v107
  v_mfma_f32_32x32x16_bf16 v[32:47], v[196:199], v[144:147], v[32:47]
  v_exp_f32 v109, v109
  v_exp_f32 v110, v110
  v_exp_f32 v111, v111
  v_cvt_pk_bf16_f32 v150, v108, v109
  v_cvt_pk_bf16_f32 v151, v110, v111
  ds_write_b128 v7, v[16:19] offset:0
  ds_write_b128 v7, v[20:23] offset:1024
  ds_write_b128 v7, v[24:27] offset:2048
  v_exp_f32 v112, v112
  v_exp_f32 v113, v113
  v_mfma_f32_32x32x16_bf16 v[32:47], v[200:203], v[148:151], v[32:47]
  v_exp_f32 v114, v114
  v_exp_f32 v115, v115
  v_cvt_pk_bf16_f32 v144, v112, v113
  v_exp_f32 v116, v116
  v_cvt_pk_bf16_f32 v145, v114, v115
  v_exp_f32 v117, v117
  v_exp_f32 v118, v118
  v_exp_f32 v119, v119
  v_cvt_pk_bf16_f32 v146, v116, v117
  v_exp_f32 v120, v120
  v_cvt_pk_bf16_f32 v147, v118, v119
  v_exp_f32 v121, v121
  v_exp_f32 v122, v122
  v_exp_f32 v123, v123
  v_cvt_pk_bf16_f32 v148, v120, v121
  v_exp_f32 v124, v124
  v_cvt_pk_bf16_f32 v149, v122, v123
  v_mfma_f32_32x32x16_bf16 v[48:63], v[196:199], v[144:147], v[48:63]
  v_exp_f32 v125, v125
  v_exp_f32 v126, v126
  v_exp_f32 v127, v127
  v_cvt_pk_bf16_f32 v150, v124, v125
  v_cvt_pk_bf16_f32 v151, v126, v127
  ds_write_b128 v7, v[32:35] offset:12288
  ds_write_b128 v7, v[36:39] offset:13312
  ds_write_b128 v7, v[40:43] offset:14336
  v_exp_f32 v128, v128
  v_exp_f32 v129, v129
  v_mfma_f32_32x32x16_bf16 v[48:63], v[200:203], v[148:151], v[48:63]
  v_exp_f32 v130, v130
  v_exp_f32 v131, v131
  v_cvt_pk_bf16_f32 v144, v128, v129
  v_exp_f32 v132, v132
  v_cvt_pk_bf16_f32 v145, v130, v131
  v_exp_f32 v133, v133
  v_exp_f32 v134, v134
  v_exp_f32 v135, v135
  v_cvt_pk_bf16_f32 v146, v132, v133
  v_exp_f32 v136, v136
  v_cvt_pk_bf16_f32 v147, v134, v135
  v_exp_f32 v137, v137
  v_exp_f32 v138, v138
  v_exp_f32 v139, v139
  v_cvt_pk_bf16_f32 v148, v136, v137
  v_exp_f32 v140, v140
  v_cvt_pk_bf16_f32 v149, v138, v139
  v_mfma_f32_32x32x16_bf16 v[64:79], v[196:199], v[144:147], v[64:79]
  v_exp_f32 v141, v141
  v_exp_f32 v142, v142
  v_exp_f32 v143, v143
  v_cvt_pk_bf16_f32 v150, v140, v141
  v_cvt_pk_bf16_f32 v151, v142, v143
  ds_write_b128 v7, v[48:51] offset:24576
  ds_write_b128 v7, v[52:55] offset:25600
  ds_write_b128 v7, v[56:59] offset:26624
  s_cmp_ge_u32 s14, 4
  s_cbranch_scc1 attn_kernel_nopf
  s_and_b32 s28, s2, 127
  s_mul_i32 s28, s28, 5184
  s_lshl_b32 s29, s14, 11
  s_add_u32 s28, s28, s29
  s_mov_b32 m0, 110592
  s_nop 0
  buffer_load_dwordx4 v1, s[36:39], s28 offen lds
  buffer_load_dwordx4 v1, s[36:39], s28 offen offset:1024 lds
attn_kernel_nopf:
  s_nop 1
  v_mfma_f32_32x32x16_bf16 v[64:79], v[200:203], v[148:151], v[64:79]
  s_waitcnt vmcnt(0)
  s_nop 7
  s_nop 2
  ds_write_b128 v7, v[64:67] offset:36864
  ds_write_b128 v7, v[68:71] offset:37888
  ds_write_b128 v7, v[72:75] offset:38912
  s_mov_b32 s35, 0
  s_cmp_ge_u32 s14, 4
  s_cbranch_scc1 attn_kernel_nokv
  s_lshr_b32 s24, s12, 1
  s_mul_i32 s25, s24, 21846
  s_lshr_b32 s25, s25, 16
  s_add_u32 s24, s24, 16
  s_mul_i32 s28, s24, 21846
  s_lshr_b32 s28, s28, 16
  s_add_u32 s24, s24, 16
  s_mul_i32 s29, s24, 21846
  s_lshr_b32 s29, s29, 16
  s_and_b32 s24, s13, 7
  s_lshl_b32 s24, s24, 12
  s_add_u32 s24, s24, 19939328
  s_lshl_b32 s25, s25, 8
  s_add_u32 s25, s25, s24
  v_lshl_add_u32 v10, v0, 2, s25
  s_lshl_b32 s28, s28, 8
  s_add_u32 s28, s28, s24
  v_lshl_add_u32 v11, v0, 2, s28
  s_lshl_b32 s29, s29, 8
  s_add_u32 s29, s29, s24
  v_lshl_add_u32 v12, v0, 2, s29
  s_mov_b32 s24, 131072
attn_kernel_poll2:
  global_load_dword v13, v10, s[4:5] sc1
  global_load_dword v14, v11, s[4:5] sc1
  global_load_dword v15, v12, s[4:5] sc1
  s_sub_u32 s24, s24, 1
  s_cmp_eq_u32 s24, 0
  s_cbranch_scc1 attn_kernel_poll2_x
  s_waitcnt vmcnt(0)
  v_cmp_ne_u32 vcc, s100, v13
  v_cmp_ne_u32 s[28:29], s100, v14
  s_nop 1
  s_or_b64 vcc, vcc, s[28:29]
  v_cmp_ne_u32 s[28:29], s100, v15
  s_nop 1
  s_or_b64 vcc, vcc, s[28:29]
  s_nop 1
  s_cmp_lg_u64 vcc, 0
  s_cbranch_scc1 attn_kernel_poll2
attn_kernel_poll2_x:
  s_waitcnt vmcnt(0)
  v_mov_b32 v8, 151560
  v_mov_b32 v9, s100
  ds_write_b32 v8, v9
  s_lshl_b32 s28, s32, 10
  s_lshl_b32 s29, s12, 16
  s_add_u32 s28, s28, s29
  s_add_u32 s28, s28, 7340032
  buffer_load_dwordx4 v[204:207], v1, s[8:11], s28 offen sc1
  s_lshl_b32 s28, s32, 7
  s_lshl_b32 s29, s12, 13
  s_add_u32 s28, s28, s29
  s_add_u32 s28, s28, 9437184
  buffer_load_dword v208, v4, s[8:11], s28 offen sc1
  s_mov_b32 s35, 1
  s_mul_i32 s24, s12, 73728
  s_mul_i32 s25, s14, 18432
  s_add_u32 s24, s24, s25
  s_add_u32 s17, s24, 9699328
  s_add_u32 s19, s24, 12058624
  s_waitcnt vmcnt(0)
  v_mov_b32 v172, 0
  v_mov_b32 v173, 0
  v_mov_b32 v174, 0
  v_mov_b32 v175, 0
  v_mov_b32 v176, 0
  v_mov_b32 v177, 0
  v_mov_b32 v178, 0
  v_mov_b32 v179, 0
  v_mov_b32 v188, 0
  v_mov_b32 v189, 0
  v_mov_b32 v190, 0
  v_mov_b32 v191, 0
  v_mov_b32 v192, 0
  v_mov_b32 v193, 0
  v_mov_b32 v194, 0
  v_mov_b32 v195, 0
  v_pk_mul_f32 v[80:81], v[172:173], v[172:173]
  v_pk_mul_f32 v[82:83], v[172:173], v[172:173]
  v_pk_mul_f32 v[84:85], v[172:173], v[172:173]
  v_pk_mul_f32 v[86:87], v[172:173], v[172:173]
  v_pk_mul_f32 v[88:89], v[172:173], v[172:173]
  v_pk_mul_f32 v[90:91], v[172:173], v[172:173]
  v_pk_mul_f32 v[92:93], v[172:173], v[172:173]
  v_pk_mul_f32 v[94:95], v[172:173], v[172:173]
  s_mov_b64 exec, s[22:23]
  buffer_load_dwordx4 v[172:175], v3, s[8:11], s17 offen sc1
  buffer_load_dwordx4 v[180:183], v3, s[8:11], s19 offen sc1
  buffer_load_dwordx4 v[176:179], v212, s[8:11], s17 offen sc1
  buffer_load_dwordx4 v[184:187], v212, s[8:11], s19 offen sc1
  s_mov_b64 exec, -1
  s_add_u32 s17, s17, 1152
  s_add_u32 s19, s19, 1152
  s_mov_b64 exec, s[22:23]
  buffer_load_dwordx4 v[188:191], v3, s[8:11], s17 offen sc1
  buffer_load_dwordx4 v[196:199], v3, s[8:11], s19 offen sc1
  buffer_load_dwordx4 v[192:195], v212, s[8:11], s17 offen sc1
  buffer_load_dwordx4 v[200:203], v212, s[8:11], s19 offen sc1
  s_mov_b64 exec, -1
  s_add_u32 s17, s17, 1152
  s_add_u32 s19, s19, 1152
  s_mov_b32 s20, 7
attn_kernel_kvl:
  s_waitcnt vmcnt(4)
  v_mfma_f32_32x32x16_bf16 v[80:95], v[172:175], v[180:183], v[80:95]
  v_mfma_f32_32x32x16_bf16 v[80:95], v[176:179], v[184:187], v[80:95]
  s_mov_b64 exec, s[22:23]
  buffer_load_dwordx4 v[172:175], v3, s[8:11], s17 offen sc1
  buffer_load_dwordx4 v[180:183], v3, s[8:11], s19 offen sc1
  buffer_load_dwordx4 v[176:179], v212, s[8:11], s17 offen sc1
  buffer_load_dwordx4 v[184:187], v212, s[8:11], s19 offen sc1
  s_mov_b64 exec, -1
  s_add_u32 s17, s17, 1152
  s_add_u32 s19, s19, 1152
  s_waitcnt vmcnt(4)
  v_mfma_f32_32x32x16_bf16 v[80:95], v[188:191], v[196:199], v[80:95]
  v_mfma_f32_32x32x16_bf16 v[80:95], v[192:195], v[200:203], v[80:95]
  s_mov_b64 exec, s[22:23]
  buffer_load_dwordx4 v[188:191], v3, s[8:11], s17 offen sc1
  buffer_load_dwordx4 v[196:199], v3, s[8:11], s19 offen sc1
  buffer_load_dwordx4 v[192:195], v212, s[8:11], s17 offen sc1
  buffer_load_dwordx4 v[200:203], v212, s[8:11], s19 offen sc1
  s_mov_b64 exec, -1
  s_add_u32 s17, s17, 1152
  s_add_u32 s19, s19, 1152
  s_sub_u32 s20, s20, 1
  s_cmp_lg_u32 s20, 0
  s_cbranch_scc1 attn_kernel_kvl
  s_waitcnt vmcnt(4)
  v_mfma_f32_32x32x16_bf16 v[80:95], v[172:175], v[180:183], v[80:95]
  v_mfma_f32_32x32x16_bf16 v[80:95], v[176:179], v[184:187], v[80:95]
  s_waitcnt vmcnt(0)
  v_mfma_f32_32x32x16_bf16 v[80:95], v[188:191], v[196:199], v[80:95]
  v_mfma_f32_32x32x16_bf16 v[80:95], v[192:195], v[200:203], v[80:95]
  s_mul_i32 s24, s14, 3072
  s_add_u32 s24, s24, 98304
  v_add_u32 v13, s24, v1
  s_nop 7
  s_nop 3
  ds_write_b128 v13, v[80:83] offset:0
  ds_write_b128 v13, v[84:87] offset:1024
  ds_write_b128 v13, v[88:91] offset:2048
  s_branch attn_kernel_kvdone
attn_kernel_nokv:
  v_mov_b32 v8, 151560
  ds_read_b32 v9, v8
  s_waitcnt lgkmcnt(0)
  v_readfirstlane_b32 s24, v9
  s_nop 3
  s_cmp_eq_u32 s24, s100
  s_cbranch_scc0 attn_kernel_kvdone
  s_lshl_b32 s28, s32, 10
  s_lshl_b32 s29, s12, 16
  s_add_u32 s28, s28, s29
  s_add_u32 s28, s28, 7340032
  buffer_load_dwordx4 v[204:207], v1, s[8:11], s28 offen sc1
  s_lshl_b32 s28, s32, 7
  s_lshl_b32 s29, s12, 13
  s_add_u32 s28, s28, s29
  s_add_u32 s28, s28, 9437184
  buffer_load_dword v208, v4, s[8:11], s28 offen sc1
  s_mov_b32 s35, 1
attn_kernel_kvdone:
  s_waitcnt lgkmcnt(0)
  s_barrier
  s_cmp_eq_u32 s35, 1
  s_cbranch_scc1 attn_kernel_havepq
  s_lshl_b32 s28, s32, 10
  s_lshl_b32 s29, s12, 16
  s_add_u32 s28, s28, s29
  s_add_u32 s28, s28, 7340032
  buffer_load_dwordx4 v[204:207], v1, s[8:11], s28 offen sc1
  s_lshl_b32 s28, s32, 7
  s_lshl_b32 s29, s12, 13
  s_add_u32 s28, s28, s29
  s_add_u32 s28, s28, 9437184
  buffer_load_dword v208, v4, s[8:11], s28 offen sc1
attn_kernel_havepq:
  s_mul_i32 s24, s14, 12288
  v_add_u32 v7, s24, v1
  v_add_u32 v13, 98304, v1
  ds_read_b128 v[80:83], v7 offset:0
  ds_read_b128 v[84:87], v7 offset:1024
  ds_read_b128 v[88:91], v7 offset:2048
  ds_read_b128 v[92:95], v7 offset:3072
  ds_read_b128 v[96:99], v7 offset:4096
  ds_read_b128 v[100:103], v7 offset:5120
  ds_read_b128 v[172:175], v7 offset:6144
  ds_read_b128 v[176:179], v7 offset:7168
  ds_read_b128 v[180:183], v7 offset:8192
  ds_read_b128 v[184:187], v7 offset:9216
  ds_read_b128 v[188:191], v7 offset:10240
  ds_read_b128 v[192:195], v7 offset:11264
  s_waitcnt lgkmcnt(9)
  ds_read_b128 v[32:35], v13 offset:0
  ds_read_b128 v[36:39], v13 offset:1024
  ds_read_b128 v[40:43], v13 offset:2048
  s_waitcnt lgkmcnt(9)
  v_pk_add_f32 v[80:81], v[80:81], v[92:93]
  v_pk_add_f32 v[82:83], v[82:83], v[94:95]
  v_pk_add_f32 v[84:85], v[84:85], v[96:97]
  v_pk_add_f32 v[86:87], v[86:87], v[98:99]
  v_pk_add_f32 v[88:89], v[88:89], v[100:101]
  v_add_f32 v90, v90, v102
  s_waitcnt lgkmcnt(9)
  ds_read_b128 v[44:47], v13 offset:3072
  ds_read_b128 v[48:51], v13 offset:4096
  ds_read_b128 v[52:55], v13 offset:5120
  s_waitcnt lgkmcnt(9)
  v_pk_add_f32 v[80:81], v[80:81], v[172:173]
  v_pk_add_f32 v[82:83], v[82:83], v[174:175]
  v_pk_add_f32 v[84:85], v[84:85], v[176:177]
  v_pk_add_f32 v[86:87], v[86:87], v[178:179]
  v_pk_add_f32 v[88:89], v[88:89], v[180:181]
  v_add_f32 v90, v90, v182
  s_waitcnt lgkmcnt(9)
  ds_read_b128 v[56:59], v13 offset:6144
  ds_read_b128 v[60:63], v13 offset:7168
  ds_read_b128 v[64:67], v13 offset:8192
  s_waitcnt lgkmcnt(9)
  v_pk_add_f32 v[80:81], v[80:81], v[184:185]
  v_pk_add_f32 v[82:83], v[82:83], v[186:187]
  v_pk_add_f32 v[84:85], v[84:85], v[188:189]
  v_pk_add_f32 v[86:87], v[86:87], v[190:191]
  v_pk_add_f32 v[88:89], v[88:89], v[192:193]
  v_add_f32 v90, v90, v194
  ds_read_b128 v[68:71], v13 offset:9216
  ds_read_b128 v[72:75], v13 offset:10240
  ds_read_b128 v[76:79], v13 offset:11264
  s_waitcnt lgkmcnt(6)
  v_pk_add_f32 v[32:33], v[32:33], v[44:45]
  v_pk_add_f32 v[34:35], v[34:35], v[46:47]
  v_pk_add_f32 v[36:37], v[36:37], v[48:49]
  v_pk_add_f32 v[38:39], v[38:39], v[50:51]
  v_pk_add_f32 v[40:41], v[40:41], v[52:53]
  s_waitcnt lgkmcnt(3)
  v_pk_add_f32 v[32:33], v[32:33], v[56:57]
  v_pk_add_f32 v[34:35], v[34:35], v[58:59]
  v_pk_add_f32 v[36:37], v[36:37], v[60:61]
  v_pk_add_f32 v[38:39], v[38:39], v[62:63]
  v_pk_add_f32 v[40:41], v[40:41], v[64:65]
  s_waitcnt lgkmcnt(0)
  v_pk_add_f32 v[32:33], v[32:33], v[68:69]
  v_pk_add_f32 v[34:35], v[34:35], v[70:71]
  v_pk_add_f32 v[36:37], v[36:37], v[72:73]
  v_pk_add_f32 v[38:39], v[38:39], v[74:75]
  v_pk_add_f32 v[40:41], v[40:41], v[76:77]
  v_cvt_pk_bf16_f32 v196, v32, v33
  v_cvt_pk_bf16_f32 v197, v34, v35
  v_cvt_pk_bf16_f32 v198, v36, v37
  v_cvt_pk_bf16_f32 v199, v38, v39
  v_cvt_pk_bf16_f32 v200, v40, v41
  v_mov_b32 v201, 0
  v_mov_b32 v202, 0
  v_mov_b32 v203, 0
  s_waitcnt vmcnt(0)
  s_nop 0
  v_mfma_f32_32x32x16_bf16 v[16:31], v[196:199], v[204:207], 0
  v_mfma_f32_32x32x16_bf16 v[16:31], v[200:203], v[208:211], v[16:31]
  v_rcp_f32 v7, v90
  s_mov_b32 s24, 0x21800000
  s_mov_b32 s25, 0x5d800000
  v_mov_b32 v8, 0
  v_fma_f32 v8, v80, 0, v8
  v_fma_f32 v8, v81, 0, v8
  v_fma_f32 v8, v82, 0, v8
  v_fma_f32 v8, v83, 0, v8
  v_fma_f32 v8, v84, 0, v8
  v_fma_f32 v8, v85, 0, v8
  v_fma_f32 v8, v86, 0, v8
  v_fma_f32 v8, v87, 0, v8
  v_fma_f32 v8, v88, 0, v8
  v_fma_f32 v8, v89, 0, v8
  v_cmp_nle_f32 vcc, s24, v90
  v_cmp_nge_f32 s[26:27], s25, v90
  v_cmp_u_f32 s[28:29], v8, v8
  s_nop 1
  s_or_b64 vcc, vcc, s[26:27]
  s_or_b64 vcc, vcc, s[28:29]
  s_cmp_lg_u64 vcc, 0
  s_cbranch_scc1 attn_kernel_fallback
attn_kernel_store:
  v_mul_f32 v80, v7, v80
  v_mul_f32 v81, v7, v81
  v_mul_f32 v82, v7, v82
  v_mul_f32 v83, v7, v83
  v_mul_f32 v84, v7, v84
  v_mul_f32 v85, v7, v85
  v_mul_f32 v86, v7, v86
  v_mul_f32 v87, v7, v87
  v_mul_f32 v88, v7, v88
  v_mul_f32 v89, v7, v89
  v_cvt_pk_bf16_f32 v8, v80, v81
  v_cvt_pk_bf16_f32 v9, v82, v83
  v_cvt_pk_bf16_f32 v10, v84, v85
  v_cvt_pk_bf16_f32 v11, v86, v87
  v_cvt_pk_bf16_f32 v12, v88, v89
  s_add_u32 s24, s33, 0
  s_add_u32 s25, s34, 0
  buffer_store_dwordx4 v[8:11], v5, s[8:11], s24 offen sc1
  buffer_store_dword v12, v6, s[8:11], s25 offen sc1
  v_add_f32 v26, 0x358637bd, v26
  v_rcp_f32 v7, v26
  s_nop 0
  v_mul_f32 v16, v7, v16
  v_mul_f32 v17, v7, v17
  v_mul_f32 v18, v7, v18
  v_mul_f32 v19, v7, v19
  v_mul_f32 v20, v7, v20
  v_mul_f32 v21, v7, v21
  v_mul_f32 v22, v7, v22
  v_mul_f32 v23, v7, v23
  v_mul_f32 v24, v7, v24
  v_mul_f32 v25, v7, v25
  v_cvt_pk_bf16_f32 v8, v16, v17
  v_cvt_pk_bf16_f32 v9, v18, v19
  v_cvt_pk_bf16_f32 v10, v20, v21
  v_cvt_pk_bf16_f32 v11, v22, v23
  v_cvt_pk_bf16_f32 v12, v24, v25
  s_add_u32 s24, s33, 2359296
  s_add_u32 s25, s34, 262144
  buffer_store_dwordx4 v[8:11], v5, s[8:11], s24 offen sc1
  buffer_store_dword v12, v6, s[8:11], s25 offen sc1
  s_branch fused_p2_done
attn_kernel_fallback:
  s_lshl_b32 s26, s12, 16
  s_lshl_b32 s27, s12, 13
  s_lshl_b32 s28, s32, 10
  s_add_u32 s28, s28, s26
  s_add_u32 s28, s28, 0
  buffer_load_dwordx4 v[114:117], v1, s[8:11], s28 offen sc1
  s_lshl_b32 s28, s32, 7
  s_add_u32 s28, s28, s27
  s_add_u32 s28, s28, 4194304
  buffer_load_dword v112, v4, s[8:11], s28 offen sc1
  v_mov_b32 v113, 0
  v_mov_b32 v177, 0x3f803f80
  v_mov_b32 v178, 0
  v_mov_b32 v179, 0
  v_and_b32 v14, 27, v0
  v_cmp_eq_u32 vcc, 18, v14
  v_mov_b32 v15, 0x3f803f80
  s_nop 0
  v_cndmask_b32 v14, 0, v15, vcc
  v_mov_b32 v180, v14
  v_mov_b32 v184, v14
  v_mov_b32 v181, v14
  v_mov_b32 v185, v14
  v_mov_b32 v182, v14
  v_mov_b32 v186, v14
  v_mov_b32 v183, v14
  v_mov_b32 v187, v14
  s_add_u32 s17, s26, 2097152
  s_add_u32 s18, s27, 4456448
  s_mul_i32 s19, s12, 73728
  s_add_u32 s19, s19, 4718592
  s_mov_b32 s20, 64
  v_mov_b32 v13, 0xff800000
attn_kernel_fb1:
  buffer_load_dwordx4 v[172:175], v1, s[8:11], s17 offen sc1
  buffer_load_dword v176, v2, s[8:11], s18 offen sc1
  s_mov_b64 exec, s[22:23]
  buffer_load_dwordx4 v[180:183], v3, s[8:11], s19 offen sc1
  buffer_load_dwordx4 v[184:187], v212, s[8:11], s19 offen sc1
  s_mov_b64 exec, -1
  s_add_u32 s17, s17, 1024
  s_add_u32 s18, s18, 128
  s_add_u32 s19, s19, 1152
  s_waitcnt vmcnt(0)
  v_mfma_f32_32x32x16_bf16 v[80:95], v[172:175], v[114:117], 0
  v_mfma_f32_32x32x16_bf16 v[80:95], v[176:179], v[112:115], v[80:95]
  s_nop 7
  s_nop 7
  v_max3_f32 v13, v80, v81, v13
  v_max3_f32 v13, v82, v83, v13
  v_max3_f32 v13, v84, v85, v13
  v_max3_f32 v13, v86, v87, v13
  v_max3_f32 v13, v88, v89, v13
  v_max3_f32 v13, v90, v91, v13
  v_max3_f32 v13, v92, v93, v13
  v_max3_f32 v13, v94, v95, v13
  s_sub_u32 s20, s20, 1
  s_cmp_lg_u32 s20, 0
  s_cbranch_scc1 attn_kernel_fb1
  v_mov_b32 v14, v13
  s_nop 1
  v_permlane32_swap_b32 v13, v14
  s_nop 1
  v_max_f32 v13, v13, v14
  v_sub_f32 v13, 0, v13
  v_cvt_pk_bf16_f32 v14, v13, v13
  v_lshlrev_b32 v14, 16, v14
  v_sub_f32 v14, v13, v14
  v_cvt_pk_bf16_f32 v14, v13, v14
  v_cmp_gt_u32 vcc, 32, v0
  s_nop 1
  v_cndmask_b32 v113, 0, v14, vcc
  s_add_u32 s17, s26, 2097152
  s_add_u32 s18, s27, 4456448
  s_mul_i32 s19, s12, 73728
  s_add_u32 s19, s19, 4718592
  s_mov_b32 s20, 64
  v_mov_b32 v32, 0
  v_mov_b32 v33, 0
  v_mov_b32 v34, 0
  v_mov_b32 v35, 0
  v_mov_b32 v36, 0
  v_mov_b32 v37, 0
  v_mov_b32 v38, 0
  v_mov_b32 v39, 0
  v_mov_b32 v40, 0
  v_mov_b32 v41, 0
  v_mov_b32 v42, 0
  v_mov_b32 v43, 0
  v_mov_b32 v44, 0
  v_mov_b32 v45, 0
  v_mov_b32 v46, 0
  v_mov_b32 v47, 0
attn_kernel_fb2:
  buffer_load_dwordx4 v[172:175], v1, s[8:11], s17 offen sc1
  buffer_load_dword v176, v2, s[8:11], s18 offen sc1
  s_mov_b64 exec, s[22:23]
  buffer_load_dwordx4 v[180:183], v3, s[8:11], s19 offen sc1
  buffer_load_dwordx4 v[184:187], v212, s[8:11], s19 offen sc1
  s_mov_b64 exec, -1
  s_add_u32 s17, s17, 1024
  s_add_u32 s18, s18, 128
  s_add_u32 s19, s19, 1152
  s_waitcnt vmcnt(0)
  v_mfma_f32_32x32x16_bf16 v[80:95], v[172:175], v[114:117], 0
  v_mfma_f32_32x32x16_bf16 v[80:95], v[176:179], v[112:115], v[80:95]
  s_nop 7
  s_nop 7
  v_exp_f32 v80, v80
  v_exp_f32 v81, v81
  v_exp_f32 v82, v82
  v_exp_f32 v83, v83
  v_exp_f32 v84, v84
  v_exp_f32 v85, v85
  v_exp_f32 v86, v86
  v_exp_f32 v87, v87
  v_exp_f32 v88, v88
  v_exp_f32 v89, v89
  v_exp_f32 v90, v90
  v_exp_f32 v91, v91
  v_exp_f32 v92, v92
  v_exp_f32 v93, v93
  v_exp_f32 v94, v94
  v_exp_f32 v95, v95
  s_nop 0
  v_cvt_pk_bf16_f32 v144, v80, v81
  v_cvt_pk_bf16_f32 v145, v82, v83
  v_cvt_pk_bf16_f32 v146, v84, v85
  v_cvt_pk_bf16_f32 v147, v86, v87
  v_cvt_pk_bf16_f32 v148, v88, v89
  v_cvt_pk_bf16_f32 v149, v90, v91
  v_cvt_pk_bf16_f32 v150, v92, v93
  v_cvt_pk_bf16_f32 v151, v94, v95
  s_nop 1
  v_mfma_f32_32x32x16_bf16 v[32:47], v[180:183], v[144:147], v[32:47]
  v_mfma_f32_32x32x16_bf16 v[32:47], v[184:187], v[148:151], v[32:47]
  s_sub_u32 s20, s20, 1
  s_cmp_lg_u32 s20, 0
  s_cbranch_scc1 attn_kernel_fb2
  s_nop 7
  s_nop 7
  v_mov_b32 v80, v32
  v_mov_b32 v81, v33
  v_mov_b32 v82, v34
  v_mov_b32 v83, v35
  v_mov_b32 v84, v36
  v_mov_b32 v85, v37
  v_mov_b32 v86, v38
  v_mov_b32 v87, v39
  v_mov_b32 v88, v40
  v_mov_b32 v89, v41
  v_mov_b32 v90, v42
  v_rcp_f32 v7, v90
  s_nop 0
  s_branch attn_kernel_store
fused_p2_done:
  s_waitcnt vmcnt(0) lgkmcnt(0)
  s_barrier
  s_cmp_lg_u32 s101, 0
  s_cbranch_scc1 fused_p2_noarr
  s_lshl_b32 s30, s13, 7
  s_lshl_b32 s31, s12, 2
  s_add_u32 s30, s30, s31
  s_add_u32 s30, s30, 19972096
  v_mul_u32_u24 v2, 1024, v0
  v_add_u32 v2, s30, v2
  v_mov_b32 v3, s100
  s_mov_b64 exec, 255
  global_store_dword v2, v3, s[4:5] sc1
  s_mov_b64 exec, -1
fused_p2_noarr:
  s_load_dwordx2 s[4:5], s[0:1], 16
  s_load_dwordx2 s[6:7], s[0:1], 40
  s_load_dwordx2 s[28:29], s[0:1], 48
  s_load_dwordx2 s[30:31], s[0:1], 64
  s_mov_b32 s23, s101
  s_and_b32 s32, s2, 7
  s_lshl_b32 s32, s32, 2
  s_bfe_u32 s33, s2, 0x20003
  s_add_u32 s32, s32, s33
  s_lshr_b32 s44, s2, 5
  s_lshr_b32 s20, s32, 4
  s_bfe_u32 s33, s32, 0x10003
  s_lshl_b32 s21, s44, 1
  s_add_u32 s21, s21, s33
  s_and_b32 s22, s32, 7
  s_mul_i32 s36, s22, 144
  s_and_b32 s37, s36, 0xffffffc0
  s_sub_u32 s38, s36, s37
  s_and_b32 s48, s23, 3
  v_and_b32 v17, 15, v0
  v_lshrrev_b32 v18, 4, v0
  s_cmp_lt_u32 s23, 4
  s_cbranch_scc1 proj_setup
  v_add_u32 v20, 0, v0
  v_mul_u32_u24 v21, 5462, v20
  v_lshrrev_b32 v21, 16, v21
  v_mul_u32_u24 v22, 12, v21
  v_sub_u32 v22, v20, v22
  v_lshrrev_b32 v24, 3, v21
  v_lshlrev_b32 v23, 1, v24
  v_xor_b32 v22, v22, v23
  v_lshl_add_u32 v22, v22, 4, s37
  v_and_b32 v23, 3, v21
  v_bfe_u32 v25, v21, 2, 1
  v_lshl_add_u32 v26, v25, 3, v23
  v_lshl_add_u32 v26, v24, 2, v26
  v_mul_u32_u24 v26, 1152, v26
  v_add_u32 v6, v26, v22
  v_lshrrev_b32 v25, 2, v21
  v_mul_u32_u24 v25, 36, v25
  v_add3_u32 v25, v25, v23, 16
  v_mul_u32_u24 v25, 1152, v25
  v_add_u32 v9, v25, v22
  v_add_u32 v20, 64, v0
  v_mul_u32_u24 v21, 5462, v20
  v_lshrrev_b32 v21, 16, v21
  v_mul_u32_u24 v22, 12, v21
  v_sub_u32 v22, v20, v22
  v_lshrrev_b32 v24, 3, v21
  v_lshlrev_b32 v23, 1, v24
  v_xor_b32 v22, v22, v23
  v_lshl_add_u32 v22, v22, 4, s37
  v_and_b32 v23, 3, v21
  v_bfe_u32 v25, v21, 2, 1
  v_lshl_add_u32 v26, v25, 3, v23
  v_lshl_add_u32 v26, v24, 2, v26
  v_mul_u32_u24 v26, 1152, v26
  v_add_u32 v7, v26, v22
  v_lshrrev_b32 v25, 2, v21
  v_mul_u32_u24 v25, 36, v25
  v_add3_u32 v25, v25, v23, 16
  v_mul_u32_u24 v25, 1152, v25
  v_add_u32 v10, v25, v22
  v_add_u32 v20, 128, v0
  v_mul_u32_u24 v21, 5462, v20
  v_lshrrev_b32 v21, 16, v21
  v_mul_u32_u24 v22, 12, v21
  v_sub_u32 v22, v20, v22
  v_lshrrev_b32 v24, 3, v21
  v_lshlrev_b32 v23, 1, v24
  v_xor_b32 v22, v22, v23
  v_lshl_add_u32 v22, v22, 4, s37
  v_and_b32 v23, 3, v21
  v_bfe_u32 v25, v21, 2, 1
  v_lshl_add_u32 v26, v25, 3, v23
  v_lshl_add_u32 v26, v24, 2, v26
  v_mul_u32_u24 v26, 1152, v26
  v_add_u32 v8, v26, v22
  v_lshrrev_b32 v25, 2, v21
  v_mul_u32_u24 v25, 36, v25
  v_add3_u32 v25, v25, v23, 16
  v_mul_u32_u24 v25, 1152, v25
  v_add_u32 v11, v25, v22
  s_lshr_b32 s34, s48, 1
  s_mul_i32 s34, s34, 36
  s_and_b32 s35, s48, 1
  s_mul_i32 s35, s35, 20
  s_add_u32 s34, s34, s35
  s_mul_i32 s26, s34, 1152
  s_mul_i32 s27, s48, 3072
  s_mul_i32 s39, s48, 165888
  s_waitcnt lgkmcnt(0)
  s_cmp_eq_u32 s20, 0
  s_cselect_b32 s4, s4, s6
  s_cselect_b32 s5, s5, s7
  s_mov_b32 s12, s4
  s_and_b32 s13, s5, 0xffff
  s_mov_b32 s14, 663552
  s_mov_b32 s15, 0x00020000
  s_add_u32 m0, s27, 0
  s_nop 0
  buffer_load_dwordx4 v6, s[12:15], s26 offen lds
  s_add_u32 m0, s27, 1024
  s_nop 0
  buffer_load_dwordx4 v7, s[12:15], s26 offen lds
  s_add_u32 m0, s27, 2048
  s_add_u32 s41, s26, 82944
  buffer_load_dwordx4 v8, s[12:15], s26 offen lds
  s_mov_b32 s26, s41
  s_add_u32 m0, s27, 12288
  s_nop 0
  buffer_load_dwordx4 v6, s[12:15], s26 offen lds
  s_add_u32 m0, s27, 13312
  s_nop 0
  buffer_load_dwordx4 v7, s[12:15], s26 offen lds
  s_add_u32 m0, s27, 14336
  s_add_u32 s41, s26, 82944
  buffer_load_dwordx4 v8, s[12:15], s26 offen lds
  s_mov_b32 s26, s41
  s_add_u32 m0, s27, 24576
  s_nop 0
  buffer_load_dwordx4 v6, s[12:15], s26 offen lds
  s_add_u32 m0, s27, 25600
  s_nop 0
  buffer_load_dwordx4 v7, s[12:15], s26 offen lds
  s_add_u32 m0, s27, 26624
  s_add_u32 s41, s26, 82944
  buffer_load_dwordx4 v8, s[12:15], s26 offen lds
  s_mov_b32 s26, s41
  s_add_u32 m0, s27, 36864
  s_nop 0
  buffer_load_dwordx4 v6, s[12:15], s26 offen lds
  s_add_u32 m0, s27, 37888
  s_nop 0
  buffer_load_dwordx4 v7, s[12:15], s26 offen lds
  s_add_u32 m0, s27, 38912
  s_add_u32 s41, s26, 82944
  buffer_load_dwordx4 v8, s[12:15], s26 offen lds
  s_mov_b32 s26, s41
  s_add_u32 m0, s27, 49152
  s_nop 0
  buffer_load_dwordx4 v6, s[12:15], s26 offen lds
  s_add_u32 m0, s27, 50176
  s_nop 0
  buffer_load_dwordx4 v7, s[12:15], s26 offen lds
  s_add_u32 m0, s27, 51200
  s_add_u32 s41, s26, 82944
  buffer_load_dwordx4 v8, s[12:15], s26 offen lds
  s_mov_b32 s26, s41
  s_add_u32 m0, s27, 61440
  s_nop 0
  buffer_load_dwordx4 v6, s[12:15], s26 offen lds
  s_add_u32 m0, s27, 62464
  s_nop 0
  buffer_load_dwordx4 v7, s[12:15], s26 offen lds
  s_add_u32 m0, s27, 63488
  s_add_u32 s41, s26, 82944
  buffer_load_dwordx4 v8, s[12:15], s26 offen lds
  s_mov_b32 s26, s41
  s_add_u32 m0, s27, 73728
  s_nop 0
  buffer_load_dwordx4 v6, s[12:15], s26 offen lds
  s_add_u32 m0, s27, 74752
  s_nop 0
  buffer_load_dwordx4 v7, s[12:15], s26 offen lds
  s_add_u32 m0, s27, 75776
  s_add_u32 s41, s26, 82944
  buffer_load_dwordx4 v8, s[12:15], s26 offen lds
  s_mov_b32 s26, s41
  s_add_u32 m0, s27, 86016
  s_nop 0
  buffer_load_dwordx4 v6, s[12:15], s26 offen lds
  s_add_u32 m0, s27, 87040
  s_nop 0
  buffer_load_dwordx4 v7, s[12:15], s26 offen lds
  s_add_u32 m0, s27, 88064
  s_nop 0
  buffer_load_dwordx4 v8, s[12:15], s26 offen lds
  s_add_u32 m0, s27, 98304
  s_nop 0
  buffer_load_dwordx4 v9, s[12:15], s39 offen lds
  s_add_u32 m0, s27, 99328
  s_nop 0
  buffer_load_dwordx4 v10, s[12:15], s39 offen lds
  s_add_u32 m0, s27, 100352
  s_nop 0
  buffer_load_dwordx4 v11, s[12:15], s39 offen lds
proj_setup:
  v_lshlrev_b32 v1, 4, v0
  v_add_u32 v2, 4096, v1
  v_add_u32 v3, 8192, v1
  v_add_u32 v4, 12288, v1
  v_add_u32 v5, 16384, v1
  s_lshl_b32 s34, s21, 3
  s_lshl_b32 s35, s48, 1
  s_add_u32 s34, s34, s35
  s_mul_i32 s24, s34, 18432
  s_mul_i32 s35, s20, 2359296
  s_add_u32 s24, s24, s35
  s_add_u32 s24, s24, 14680064
  s_add_u32 s25, s24, 18432
  v_lshlrev_b32 v190, 2, v17
  v_lshl_add_u32 v190, v18, 15, v190
  s_lshl_b32 s34, s21, 9
  s_lshl_b32 s35, s48, 7
  s_add_u32 s34, s34, s35
  s_lshl_b32 s35, s20, 18
  s_add_u32 s34, s34, s35
  s_add_u32 s47, s34, 19398656
  v_lshrrev_b32 v20, 2, v17
  v_and_b32 v21, 3, v17
  v_lshl_add_u32 v22, v18, 3, v20
  v_mul_u32_u24 v22, 192, v22
  s_lshr_b32 s34, s23, 2
  s_mul_i32 s34, s34, 61440
  v_add_u32 v22, s34, v22
  v_and_b32 v23, 1, v18
  v_lshlrev_b32 v23, 5, v23
  v_lshl_add_u32 v24, v21, 3, s38
  v_xor_b32 v25, v24, v23
  v_add_u32 v12, v25, v22
  v_add_u32 v24, 32, v24
  v_xor_b32 v25, v24, v23
  v_add_u32 v13, v25, v22
  v_add_u32 v24, 32, v24
  v_xor_b32 v25, v24, v23
  v_add_u32 v14, v25, v22
  v_add_u32 v24, 32, v24
  v_xor_b32 v25, v24, v23
  v_add_u32 v15, v25, v22
  v_and_b32 v24, 1, v21
  v_lshl_add_u32 v24, v24, 3, s38
  v_add_u32 v24, 128, v24
  v_xor_b32 v25, v24, v23
  v_add_u32 v16, v25, v22
  s_mul_i32 s34, s23, 5120
  s_add_u32 s34, s34, 110592
  v_lshl_add_u32 v191, v0, 4, s34
  s_xor_b32 s35, s23, 4
  s_mul_i32 s34, s35, 5120
  s_add_u32 s34, s34, 110592
  v_lshl_add_u32 v192, v0, 4, s34
  s_mul_i32 s34, s23, 2560
  v_mul_u32_u24 v20, 160, v17
  v_lshl_add_u32 v20, v18, 3, v20
  v_add_u32 v19, s34, v20
  v_add_u32 v21, 0, v0
  v_mul_u32_u24 v22, 7282, v21
  v_lshrrev_b32 v22, 16, v22
  v_mul_u32_u24 v23, 9, v22
  v_sub_u32 v23, v21, v23
  v_lshlrev_b32 v23, 4, v23
  v_mul_u32_u24 v21, 160, v22
  v_add3_u32 v184, v21, v23, s34
  v_mul_u32_u24 v22, 2304, v22
  v_add_u32 v187, v22, v23
  v_add_u32 v21, 64, v0
  v_mul_u32_u24 v22, 7282, v21
  v_lshrrev_b32 v22, 16, v22
  v_mul_u32_u24 v23, 9, v22
  v_sub_u32 v23, v21, v23
  v_lshlrev_b32 v23, 4, v23
  v_mul_u32_u24 v21, 160, v22
  v_add3_u32 v185, v21, v23, s34
  v_mul_u32_u24 v22, 2304, v22
  v_add_u32 v188, v22, v23
  v_add_u32 v21, 128, v0
  v_mul_u32_u24 v22, 7282, v21
  v_lshrrev_b32 v22, 16, v22
  v_mul_u32_u24 v23, 9, v22
  v_sub_u32 v23, v21, v23
  v_lshlrev_b32 v23, 4, v23
  v_mul_u32_u24 v21, 160, v22
  v_add3_u32 v186, v21, v23, s34
  v_mul_u32_u24 v22, 2304, v22
  v_add_u32 v189, v22, v23
  v_mov_b32 v21, 0x7ff00000
  v_cmp_gt_u32 vcc, 16, v0
  s_add_u32 s35, s34, 2528
  v_min_u32 v186, s35, v186
  v_cndmask_b32 v189, v21, v189, vcc
  s_lshl_b32 s34, s21, 7
  s_lshl_b32 s35, s48, 5
  s_add_u32 s34, s34, s35
  s_lshr_b32 s35, s23, 2
  s_lshl_b32 s35, s35, 4
  s_add_u32 s34, s34, s35
  s_mul_i32 s34, s34, 2304
  s_mul_i32 s35, s20, 1152
  s_add_u32 s34, s34, s35
  s_add_u32 s40, s34, s36
  s_waitcnt lgkmcnt(0)
  s_mov_b32 s8, s30
  s_and_b32 s9, s31, 0xffff
  s_mov_b32 s10, 19922944
  s_mov_b32 s11, 0x00020000
  s_mov_b32 s16, s28
  s_and_b32 s17, s29, 0xffff
  s_mov_b32 s18, 4718592
  s_mov_b32 s19, 0x00020000
  s_cmp_lg_u32 s23, 0
  s_cbranch_scc1 proj_nopoll
  s_and_b32 s45, s22, 7
  s_lshl_b32 s45, s45, 10
  s_lshl_b32 s44, s44, 7
  s_add_u32 s44, s44, s45
  s_add_u32 s44, s44, 19972096
  v_and_b32 v20, 31, v0
  v_lshl_add_u32 v20, v20, 2, s44
  s_mov_b32 s45, 131072
proj_poll:
  global_load_dword v21, v20, s[30:31] sc1
  s_sub_u32 s45, s45, 1
  s_cmp_eq_u32 s45, 0
  s_cbranch_scc1 proj_poll_x
  s_waitcnt vmcnt(0)
  v_cmp_ne_u32 vcc, s100, v21
  s_nop 1
  s_cmp_lg_u64 vcc, 0
  s_cbranch_scc1 proj_poll
proj_poll_x:
  s_waitcnt vmcnt(0)
proj_nopoll:
  s_waitcnt vmcnt(0)
  s_barrier
  s_cmp_ge_u32 s23, 4
  s_cbranch_scc1 proj_half1
  buffer_load_dwordx4 v[96:99], v1, s[8:11], s24 offen offset:0 sc1
  buffer_load_dwordx4 v[100:103], v1, s[8:11], s25 offen offset:0 sc1
  buffer_load_dwordx4 v[104:107], v1, s[8:11], s24 offen offset:1024 sc1
  buffer_load_dwordx4 v[108:111], v1, s[8:11], s25 offen offset:1024 sc1
  buffer_load_dwordx4 v[112:115], v1, s[8:11], s24 offen offset:2048 sc1
  buffer_load_dwordx4 v[116:119], v1, s[8:11], s25 offen offset:2048 sc1
  buffer_load_dwordx4 v[120:123], v1, s[8:11], s24 offen offset:3072 sc1
  buffer_load_dwordx4 v[124:127], v1, s[8:11], s25 offen offset:3072 sc1
  buffer_load_dwordx4 v[128:131], v2, s[8:11], s24 offen offset:0 sc1
  buffer_load_dwordx4 v[132:135], v2, s[8:11], s25 offen offset:0 sc1
  buffer_load_dwordx4 v[136:139], v2, s[8:11], s24 offen offset:1024 sc1
  buffer_load_dwordx4 v[140:143], v2, s[8:11], s25 offen offset:1024 sc1
  buffer_load_dwordx4 v[144:147], v2, s[8:11], s24 offen offset:2048 sc1
  buffer_load_dwordx4 v[148:151], v2, s[8:11], s25 offen offset:2048 sc1
  buffer_load_dwordx4 v[152:155], v2, s[8:11], s24 offen offset:3072 sc1
  buffer_load_dwordx4 v[156:159], v2, s[8:11], s25 offen offset:3072 sc1
  buffer_load_dwordx4 v[160:163], v3, s[8:11], s24 offen offset:0 sc1
  buffer_load_dwordx4 v[164:167], v3, s[8:11], s25 offen offset:0 sc1
  buffer_load_dwordx4 v[168:171], v3, s[8:11], s24 offen offset:1024 sc1
  buffer_load_dwordx4 v[172:175], v3, s[8:11], s25 offen offset:1024 sc1
  ds_read_b64_tr_b16 v[24:25], v12 offset:0
  ds_read_b64_tr_b16 v[26:27], v12 offset:768
  ds_read_b64_tr_b16 v[28:29], v13 offset:0
  ds_read_b64_tr_b16 v[30:31], v13 offset:768
  ds_read_b64_tr_b16 v[32:33], v14 offset:0
  ds_read_b64_tr_b16 v[34:35], v14 offset:768
  ds_read_b64_tr_b16 v[36:37], v15 offset:0
  ds_read_b64_tr_b16 v[38:39], v15 offset:768
  ds_read_b64_tr_b16 v[40:41], v16 offset:0
  ds_read_b64_tr_b16 v[42:43], v16 offset:768
  ds_read_b64_tr_b16 v[44:45], v12 offset:6144
  ds_read_b64_tr_b16 v[46:47], v12 offset:6912
  s_waitcnt vmcnt(18) lgkmcnt(10)
  v_mfma_f32_16x16x32_bf16 v[56:59], v[24:27], v[96:99], 0
  v_mfma_f32_16x16x32_bf16 v[60:63], v[24:27], v[100:103], 0
  ds_read_b64_tr_b16 v[48:49], v13 offset:6144
  ds_read_b64_tr_b16 v[50:51], v13 offset:6912
  s_waitcnt lgkmcnt(10)
  v_mfma_f32_16x16x32_bf16 v[64:67], v[28:31], v[96:99], 0
  v_mfma_f32_16x16x32_bf16 v[68:71], v[28:31], v[100:103], 0
  ds_read_b64_tr_b16 v[52:53], v14 offset:6144
  ds_read_b64_tr_b16 v[54:55], v14 offset:6912
  s_waitcnt lgkmcnt(10)
  v_mfma_f32_16x16x32_bf16 v[72:75], v[32:35], v[96:99], 0
  v_mfma_f32_16x16x32_bf16 v[76:79], v[32:35], v[100:103], 0
  ds_read_b64_tr_b16 v[24:25], v15 offset:6144
  ds_read_b64_tr_b16 v[26:27], v15 offset:6912
  s_waitcnt lgkmcnt(10)
  v_mfma_f32_16x16x32_bf16 v[80:83], v[36:39], v[96:99], 0
  v_mfma_f32_16x16x32_bf16 v[84:87], v[36:39], v[100:103], 0
  ds_read_b64_tr_b16 v[28:29], v16 offset:6144
  ds_read_b64_tr_b16 v[30:31], v16 offset:6912
  s_waitcnt lgkmcnt(10)
  v_mfma_f32_16x16x32_bf16 v[88:91], v[40:43], v[96:99], 0
  v_mfma_f32_16x16x32_bf16 v[92:95], v[40:43], v[100:103], 0
  ds_read_b64_tr_b16 v[32:33], v12 offset:12288
  ds_read_b64_tr_b16 v[34:35], v12 offset:13056
  s_waitcnt vmcnt(16) lgkmcnt(10)
  v_mfma_f32_16x16x32_bf16 v[56:59], v[44:47], v[104:107], v[56:59]
  v_mfma_f32_16x16x32_bf16 v[60:63], v[44:47], v[108:111], v[60:63]
  ds_read_b64_tr_b16 v[36:37], v13 offset:12288
  ds_read_b64_tr_b16 v[38:39], v13 offset:13056
  s_waitcnt lgkmcnt(10)
  v_mfma_f32_16x16x32_bf16 v[64:67], v[48:51], v[104:107], v[64:67]
  v_mfma_f32_16x16x32_bf16 v[68:71], v[48:51], v[108:111], v[68:71]
  ds_read_b64_tr_b16 v[40:41], v14 offset:12288
  ds_read_b64_tr_b16 v[42:43], v14 offset:13056
  s_waitcnt lgkmcnt(10)
  v_mfma_f32_16x16x32_bf16 v[72:75], v[52:55], v[104:107], v[72:75]
  v_mfma_f32_16x16x32_bf16 v[76:79], v[52:55], v[108:111], v[76:79]
  ds_read_b64_tr_b16 v[44:45], v15 offset:12288
  ds_read_b64_tr_b16 v[46:47], v15 offset:13056
  s_waitcnt lgkmcnt(10)
  v_mfma_f32_16x16x32_bf16 v[80:83], v[24:27], v[104:107], v[80:83]
  v_mfma_f32_16x16x32_bf16 v[84:87], v[24:27], v[108:111], v[84:87]
  ds_read_b64_tr_b16 v[48:49], v16 offset:12288
  ds_read_b64_tr_b16 v[50:51], v16 offset:13056
  s_waitcnt lgkmcnt(10)
  v_mfma_f32_16x16x32_bf16 v[88:91], v[28:31], v[104:107], v[88:91]
  v_mfma_f32_16x16x32_bf16 v[92:95], v[28:31], v[108:111], v[92:95]
  ds_read_b64_tr_b16 v[52:53], v12 offset:18432
  ds_read_b64_tr_b16 v[54:55], v12 offset:19200
  s_waitcnt vmcnt(14) lgkmcnt(10)
  v_mfma_f32_16x16x32_bf16 v[56:59], v[32:35], v[112:115], v[56:59]
  v_mfma_f32_16x16x32_bf16 v[60:63], v[32:35], v[116:119], v[60:63]
  ds_read_b64_tr_b16 v[24:25], v13 offset:18432
  ds_read_b64_tr_b16 v[26:27], v13 offset:19200
  s_waitcnt lgkmcnt(10)
  v_mfma_f32_16x16x32_bf16 v[64:67], v[36:39], v[112:115], v[64:67]
  v_mfma_f32_16x16x32_bf16 v[68:71], v[36:39], v[116:119], v[68:71]
  ds_read_b64_tr_b16 v[28:29], v14 offset:18432
  ds_read_b64_tr_b16 v[30:31], v14 offset:19200
  s_waitcnt lgkmcnt(10)
  v_mfma_f32_16x16x32_bf16 v[72:75], v[40:43], v[112:115], v[72:75]
  v_mfma_f32_16x16x32_bf16 v[76:79], v[40:43], v[116:119], v[76:79]
  ds_read_b64_tr_b16 v[32:33], v15 offset:18432
  ds_read_b64_tr_b16 v[34:35], v15 offset:19200
  s_waitcnt lgkmcnt(10)
  v_mfma_f32_16x16x32_bf16 v[80:83], v[44:47], v[112:115], v[80:83]
  v_mfma_f32_16x16x32_bf16 v[84:87], v[44:47], v[116:119], v[84:87]
  ds_read_b64_tr_b16 v[36:37], v16 offset:18432
  ds_read_b64_tr_b16 v[38:39], v16 offset:19200
  s_waitcnt lgkmcnt(10)
  v_mfma_f32_16x16x32_bf16 v[88:91], v[48:51], v[112:115], v[88:91]
  v_mfma_f32_16x16x32_bf16 v[92:95], v[48:51], v[116:119], v[92:95]
  ds_read_b64_tr_b16 v[40:41], v12 offset:24576
  ds_read_b64_tr_b16 v[42:43], v12 offset:25344
  s_waitcnt vmcnt(12) lgkmcnt(10)
  v_mfma_f32_16x16x32_bf16 v[56:59], v[52:55], v[120:123], v[56:59]
  v_mfma_f32_16x16x32_bf16 v[60:63], v[52:55], v[124:127], v[60:63]
  ds_read_b64_tr_b16 v[44:45], v13 offset:24576
  ds_read_b64_tr_b16 v[46:47], v13 offset:25344
  s_waitcnt lgkmcnt(10)
  v_mfma_f32_16x16x32_bf16 v[64:67], v[24:27], v[120:123], v[64:67]
  v_mfma_f32_16x16x32_bf16 v[68:71], v[24:27], v[124:127], v[68:71]
  ds_read_b64_tr_b16 v[48:49], v14 offset:24576
  ds_read_b64_tr_b16 v[50:51], v14 offset:25344
  s_waitcnt lgkmcnt(10)
  v_mfma_f32_16x16x32_bf16 v[72:75], v[28:31], v[120:123], v[72:75]
  v_mfma_f32_16x16x32_bf16 v[76:79], v[28:31], v[124:127], v[76:79]
  ds_read_b64_tr_b16 v[52:53], v15 offset:24576
  ds_read_b64_tr_b16 v[54:55], v15 offset:25344
  s_waitcnt lgkmcnt(10)
  v_mfma_f32_16x16x32_bf16 v[80:83], v[32:35], v[120:123], v[80:83]
  v_mfma_f32_16x16x32_bf16 v[84:87], v[32:35], v[124:127], v[84:87]
  ds_read_b64_tr_b16 v[24:25], v16 offset:24576
  ds_read_b64_tr_b16 v[26:27], v16 offset:25344
  s_waitcnt lgkmcnt(10)
  v_mfma_f32_16x16x32_bf16 v[88:91], v[36:39], v[120:123], v[88:91]
  v_mfma_f32_16x16x32_bf16 v[92:95], v[36:39], v[124:127], v[92:95]
  ds_read_b64_tr_b16 v[28:29], v12 offset:30720
  ds_read_b64_tr_b16 v[30:31], v12 offset:31488
  s_waitcnt vmcnt(10) lgkmcnt(10)
  v_mfma_f32_16x16x32_bf16 v[56:59], v[40:43], v[128:131], v[56:59]
  v_mfma_f32_16x16x32_bf16 v[60:63], v[40:43], v[132:135], v[60:63]
  ds_read_b64_tr_b16 v[32:33], v13 offset:30720
  ds_read_b64_tr_b16 v[34:35], v13 offset:31488
  s_waitcnt lgkmcnt(10)
  v_mfma_f32_16x16x32_bf16 v[64:67], v[44:47], v[128:131], v[64:67]
  v_mfma_f32_16x16x32_bf16 v[68:71], v[44:47], v[132:135], v[68:71]
  ds_read_b64_tr_b16 v[36:37], v14 offset:30720
  ds_read_b64_tr_b16 v[38:39], v14 offset:31488
  s_waitcnt lgkmcnt(10)
  v_mfma_f32_16x16x32_bf16 v[72:75], v[48:51], v[128:131], v[72:75]
  v_mfma_f32_16x16x32_bf16 v[76:79], v[48:51], v[132:135], v[76:79]
  ds_read_b64_tr_b16 v[40:41], v15 offset:30720
  ds_read_b64_tr_b16 v[42:43], v15 offset:31488
  s_waitcnt lgkmcnt(10)
  v_mfma_f32_16x16x32_bf16 v[80:83], v[52:55], v[128:131], v[80:83]
  v_mfma_f32_16x16x32_bf16 v[84:87], v[52:55], v[132:135], v[84:87]
  ds_read_b64_tr_b16 v[44:45], v16 offset:30720
  ds_read_b64_tr_b16 v[46:47], v16 offset:31488
  s_waitcnt lgkmcnt(10)
  v_mfma_f32_16x16x32_bf16 v[88:91], v[24:27], v[128:131], v[88:91]
  v_mfma_f32_16x16x32_bf16 v[92:95], v[24:27], v[132:135], v[92:95]
  ds_read_b64_tr_b16 v[48:49], v12 offset:36864
  ds_read_b64_tr_b16 v[50:51], v12 offset:37632
  s_waitcnt vmcnt(8) lgkmcnt(10)
  v_mfma_f32_16x16x32_bf16 v[56:59], v[28:31], v[136:139], v[56:59]
  v_mfma_f32_16x16x32_bf16 v[60:63], v[28:31], v[140:143], v[60:63]
  ds_read_b64_tr_b16 v[52:53], v13 offset:36864
  ds_read_b64_tr_b16 v[54:55], v13 offset:37632
  s_waitcnt lgkmcnt(10)
  v_mfma_f32_16x16x32_bf16 v[64:67], v[32:35], v[136:139], v[64:67]
  v_mfma_f32_16x16x32_bf16 v[68:71], v[32:35], v[140:143], v[68:71]
  ds_read_b64_tr_b16 v[24:25], v14 offset:36864
  ds_read_b64_tr_b16 v[26:27], v14 offset:37632
  s_waitcnt lgkmcnt(10)
  v_mfma_f32_16x16x32_bf16 v[72:75], v[36:39], v[136:139], v[72:75]
  v_mfma_f32_16x16x32_bf16 v[76:79], v[36:39], v[140:143], v[76:79]
  ds_read_b64_tr_b16 v[28:29], v15 offset:36864
  ds_read_b64_tr_b16 v[30:31], v15 offset:37632
  s_waitcnt lgkmcnt(10)
  v_mfma_f32_16x16x32_bf16 v[80:83], v[40:43], v[136:139], v[80:83]
  v_mfma_f32_16x16x32_bf16 v[84:87], v[40:43], v[140:143], v[84:87]
  ds_read_b64_tr_b16 v[32:33], v16 offset:36864
  ds_read_b64_tr_b16 v[34:35], v16 offset:37632
  s_waitcnt lgkmcnt(10)
  v_mfma_f32_16x16x32_bf16 v[88:91], v[44:47], v[136:139], v[88:91]
  v_mfma_f32_16x16x32_bf16 v[92:95], v[44:47], v[140:143], v[92:95]
  ds_read_b64_tr_b16 v[36:37], v12 offset:43008
  ds_read_b64_tr_b16 v[38:39], v12 offset:43776
  s_waitcnt vmcnt(6) lgkmcnt(10)
  v_mfma_f32_16x16x32_bf16 v[56:59], v[48:51], v[144:147], v[56:59]
  v_mfma_f32_16x16x32_bf16 v[60:63], v[48:51], v[148:151], v[60:63]
  ds_read_b64_tr_b16 v[40:41], v13 offset:43008
  ds_read_b64_tr_b16 v[42:43], v13 offset:43776
  s_waitcnt lgkmcnt(10)
  v_mfma_f32_16x16x32_bf16 v[64:67], v[52:55], v[144:147], v[64:67]
  v_mfma_f32_16x16x32_bf16 v[68:71], v[52:55], v[148:151], v[68:71]
  ds_read_b64_tr_b16 v[44:45], v14 offset:43008
  ds_read_b64_tr_b16 v[46:47], v14 offset:43776
  s_waitcnt lgkmcnt(10)
  v_mfma_f32_16x16x32_bf16 v[72:75], v[24:27], v[144:147], v[72:75]
  v_mfma_f32_16x16x32_bf16 v[76:79], v[24:27], v[148:151], v[76:79]
  ds_read_b64_tr_b16 v[48:49], v15 offset:43008
  ds_read_b64_tr_b16 v[50:51], v15 offset:43776
  s_waitcnt lgkmcnt(10)
  v_mfma_f32_16x16x32_bf16 v[80:83], v[28:31], v[144:147], v[80:83]
  v_mfma_f32_16x16x32_bf16 v[84:87], v[28:31], v[148:151], v[84:87]
  ds_read_b64_tr_b16 v[52:53], v16 offset:43008
  ds_read_b64_tr_b16 v[54:55], v16 offset:43776
  s_waitcnt lgkmcnt(10)
  v_mfma_f32_16x16x32_bf16 v[88:91], v[32:35], v[144:147], v[88:91]
  v_mfma_f32_16x16x32_bf16 v[92:95], v[32:35], v[148:151], v[92:95]
  ds_read_b64_tr_b16 v[24:25], v12 offset:49152
  ds_read_b64_tr_b16 v[26:27], v12 offset:49920
  s_waitcnt vmcnt(4) lgkmcnt(10)
  v_mfma_f32_16x16x32_bf16 v[56:59], v[36:39], v[152:155], v[56:59]
  v_mfma_f32_16x16x32_bf16 v[60:63], v[36:39], v[156:159], v[60:63]
  ds_read_b64_tr_b16 v[28:29], v13 offset:49152
  ds_read_b64_tr_b16 v[30:31], v13 offset:49920
  s_waitcnt lgkmcnt(10)
  v_mfma_f32_16x16x32_bf16 v[64:67], v[40:43], v[152:155], v[64:67]
  v_mfma_f32_16x16x32_bf16 v[68:71], v[40:43], v[156:159], v[68:71]
  ds_read_b64_tr_b16 v[32:33], v14 offset:49152
  ds_read_b64_tr_b16 v[34:35], v14 offset:49920
  s_waitcnt lgkmcnt(10)
  v_mfma_f32_16x16x32_bf16 v[72:75], v[44:47], v[152:155], v[72:75]
  v_mfma_f32_16x16x32_bf16 v[76:79], v[44:47], v[156:159], v[76:79]
  ds_read_b64_tr_b16 v[36:37], v15 offset:49152
  ds_read_b64_tr_b16 v[38:39], v15 offset:49920
  s_waitcnt lgkmcnt(10)
  v_mfma_f32_16x16x32_bf16 v[80:83], v[48:51], v[152:155], v[80:83]
  v_mfma_f32_16x16x32_bf16 v[84:87], v[48:51], v[156:159], v[84:87]
  ds_read_b64_tr_b16 v[40:41], v16 offset:49152
  ds_read_b64_tr_b16 v[42:43], v16 offset:49920
  s_waitcnt lgkmcnt(10)
  v_mfma_f32_16x16x32_bf16 v[88:91], v[52:55], v[152:155], v[88:91]
  v_mfma_f32_16x16x32_bf16 v[92:95], v[52:55], v[156:159], v[92:95]
  ds_read_b64_tr_b16 v[44:45], v12 offset:55296
  ds_read_b64_tr_b16 v[46:47], v12 offset:56064
  s_waitcnt vmcnt(2) lgkmcnt(10)
  v_mfma_f32_16x16x32_bf16 v[56:59], v[24:27], v[160:163], v[56:59]
  v_mfma_f32_16x16x32_bf16 v[60:63], v[24:27], v[164:167], v[60:63]
  ds_read_b64_tr_b16 v[48:49], v13 offset:55296
  ds_read_b64_tr_b16 v[50:51], v13 offset:56064
  s_waitcnt lgkmcnt(10)
  v_mfma_f32_16x16x32_bf16 v[64:67], v[28:31], v[160:163], v[64:67]
  v_mfma_f32_16x16x32_bf16 v[68:71], v[28:31], v[164:167], v[68:71]
  ds_read_b64_tr_b16 v[52:53], v14 offset:55296
  ds_read_b64_tr_b16 v[54:55], v14 offset:56064
  s_waitcnt lgkmcnt(10)
  v_mfma_f32_16x16x32_bf16 v[72:75], v[32:35], v[160:163], v[72:75]
  v_mfma_f32_16x16x32_bf16 v[76:79], v[32:35], v[164:167], v[76:79]
  ds_read_b64_tr_b16 v[24:25], v15 offset:55296
  ds_read_b64_tr_b16 v[26:27], v15 offset:56064
  s_waitcnt lgkmcnt(10)
  v_mfma_f32_16x16x32_bf16 v[80:83], v[36:39], v[160:163], v[80:83]
  v_mfma_f32_16x16x32_bf16 v[84:87], v[36:39], v[164:167], v[84:87]
  ds_read_b64_tr_b16 v[28:29], v16 offset:55296
  ds_read_b64_tr_b16 v[30:31], v16 offset:56064
  s_waitcnt lgkmcnt(10)
  v_mfma_f32_16x16x32_bf16 v[88:91], v[40:43], v[160:163], v[88:91]
  v_mfma_f32_16x16x32_bf16 v[92:95], v[40:43], v[164:167], v[92:95]
  s_waitcnt vmcnt(0) lgkmcnt(8)
  v_mfma_f32_16x16x32_bf16 v[56:59], v[44:47], v[168:171], v[56:59]
  v_mfma_f32_16x16x32_bf16 v[60:63], v[44:47], v[172:175], v[60:63]
  s_waitcnt lgkmcnt(6)
  v_mfma_f32_16x16x32_bf16 v[64:67], v[48:51], v[168:171], v[64:67]
  v_mfma_f32_16x16x32_bf16 v[68:71], v[48:51], v[172:175], v[68:71]
  s_waitcnt lgkmcnt(4)
  v_mfma_f32_16x16x32_bf16 v[72:75], v[52:55], v[168:171], v[72:75]
  v_mfma_f32_16x16x32_bf16 v[76:79], v[52:55], v[172:175], v[76:79]
  s_waitcnt lgkmcnt(2)
  v_mfma_f32_16x16x32_bf16 v[80:83], v[24:27], v[168:171], v[80:83]
  v_mfma_f32_16x16x32_bf16 v[84:87], v[24:27], v[172:175], v[84:87]
  s_waitcnt lgkmcnt(0)
  v_mfma_f32_16x16x32_bf16 v[88:91], v[28:31], v[168:171], v[88:91]
  v_mfma_f32_16x16x32_bf16 v[92:95], v[28:31], v[172:175], v[92:95]
  s_nop 7
  ds_write_b128 v191, v[60:63] offset:0
  ds_write_b128 v191, v[68:71] offset:1024
  ds_write_b128 v191, v[76:79] offset:2048
  ds_write_b128 v191, v[84:87] offset:3072
  ds_write_b128 v191, v[92:95] offset:4096
  s_branch proj_join
proj_half1:
  buffer_load_dwordx4 v[96:99], v3, s[8:11], s24 offen offset:2048 sc1
  buffer_load_dwordx4 v[100:103], v3, s[8:11], s25 offen offset:2048 sc1
  buffer_load_dwordx4 v[104:107], v3, s[8:11], s24 offen offset:3072 sc1
  buffer_load_dwordx4 v[108:111], v3, s[8:11], s25 offen offset:3072 sc1
  buffer_load_dwordx4 v[112:115], v4, s[8:11], s24 offen offset:0 sc1
  buffer_load_dwordx4 v[116:119], v4, s[8:11], s25 offen offset:0 sc1
  buffer_load_dwordx4 v[120:123], v4, s[8:11], s24 offen offset:1024 sc1
  buffer_load_dwordx4 v[124:127], v4, s[8:11], s25 offen offset:1024 sc1
  buffer_load_dwordx4 v[128:131], v4, s[8:11], s24 offen offset:2048 sc1
  buffer_load_dwordx4 v[132:135], v4, s[8:11], s25 offen offset:2048 sc1
  buffer_load_dwordx4 v[136:139], v4, s[8:11], s24 offen offset:3072 sc1
  buffer_load_dwordx4 v[140:143], v4, s[8:11], s25 offen offset:3072 sc1
  s_add_u32 s46, s47, 0
  buffer_load_dword v144, v190, s[8:11], s46 offen offset:0 sc1
  buffer_load_dword v148, v190, s[8:11], s46 offen offset:64 sc1
  s_add_u32 s46, s47, 8192
  buffer_load_dword v145, v190, s[8:11], s46 offen offset:0 sc1
  buffer_load_dword v149, v190, s[8:11], s46 offen offset:64 sc1
  s_add_u32 s46, s47, 16384
  buffer_load_dword v146, v190, s[8:11], s46 offen offset:0 sc1
  buffer_load_dword v150, v190, s[8:11], s46 offen offset:64 sc1
  s_add_u32 s46, s47, 24576
  buffer_load_dword v147, v190, s[8:11], s46 offen offset:0 sc1
  buffer_load_dword v151, v190, s[8:11], s46 offen offset:64 sc1
  s_add_u32 s46, s47, 131072
  buffer_load_dword v152, v190, s[8:11], s46 offen offset:0 sc1
  buffer_load_dword v156, v190, s[8:11], s46 offen offset:64 sc1
  s_add_u32 s46, s47, 139264
  buffer_load_dword v153, v190, s[8:11], s46 offen offset:0 sc1
  buffer_load_dword v157, v190, s[8:11], s46 offen offset:64 sc1
  s_add_u32 s46, s47, 147456
  buffer_load_dword v154, v190, s[8:11], s46 offen offset:0 sc1
  buffer_load_dword v158, v190, s[8:11], s46 offen offset:64 sc1
  s_add_u32 s46, s47, 155648
  buffer_load_dword v155, v190, s[8:11], s46 offen offset:0 sc1
  buffer_load_dword v159, v190, s[8:11], s46 offen offset:64 sc1
  ds_read_b64_tr_b16 v[24:25], v12 offset:0
  ds_read_b64_tr_b16 v[26:27], v12 offset:768
  ds_read_b64_tr_b16 v[28:29], v13 offset:0
  ds_read_b64_tr_b16 v[30:31], v13 offset:768
  ds_read_b64_tr_b16 v[32:33], v14 offset:0
  ds_read_b64_tr_b16 v[34:35], v14 offset:768
  ds_read_b64_tr_b16 v[36:37], v15 offset:0
  ds_read_b64_tr_b16 v[38:39], v15 offset:768
  ds_read_b64_tr_b16 v[40:41], v16 offset:0
  ds_read_b64_tr_b16 v[42:43], v16 offset:768
  ds_read_b64_tr_b16 v[44:45], v12 offset:6144
  ds_read_b64_tr_b16 v[46:47], v12 offset:6912
  s_waitcnt vmcnt(26) lgkmcnt(10)
  v_mfma_f32_16x16x32_bf16 v[60:63], v[24:27], v[96:99], 0
  v_mfma_f32_16x16x32_bf16 v[56:59], v[24:27], v[100:103], 0
  ds_read_b64_tr_b16 v[48:49], v13 offset:6144
  ds_read_b64_tr_b16 v[50:51], v13 offset:6912
  s_waitcnt lgkmcnt(10)
  v_mfma_f32_16x16x32_bf16 v[68:71], v[28:31], v[96:99], 0
  v_mfma_f32_16x16x32_bf16 v[64:67], v[28:31], v[100:103], 0
  ds_read_b64_tr_b16 v[52:53], v14 offset:6144
  ds_read_b64_tr_b16 v[54:55], v14 offset:6912
  s_waitcnt lgkmcnt(10)
  v_mfma_f32_16x16x32_bf16 v[76:79], v[32:35], v[96:99], 0
  v_mfma_f32_16x16x32_bf16 v[72:75], v[32:35], v[100:103], 0
  ds_read_b64_tr_b16 v[24:25], v15 offset:6144
  ds_read_b64_tr_b16 v[26:27], v15 offset:6912
  s_waitcnt lgkmcnt(10)
  v_mfma_f32_16x16x32_bf16 v[84:87], v[36:39], v[96:99], 0
  v_mfma_f32_16x16x32_bf16 v[80:83], v[36:39], v[100:103], 0
  ds_read_b64_tr_b16 v[28:29], v16 offset:6144
  ds_read_b64_tr_b16 v[30:31], v16 offset:6912
  s_waitcnt lgkmcnt(10)
  v_mfma_f32_16x16x32_bf16 v[92:95], v[40:43], v[96:99], 0
  v_mfma_f32_16x16x32_bf16 v[88:91], v[40:43], v[100:103], 0
  ds_read_b64_tr_b16 v[32:33], v12 offset:12288
  ds_read_b64_tr_b16 v[34:35], v12 offset:13056
  s_waitcnt vmcnt(24) lgkmcnt(10)
  v_mfma_f32_16x16x32_bf16 v[60:63], v[44:47], v[104:107], v[60:63]
  v_mfma_f32_16x16x32_bf16 v[56:59], v[44:47], v[108:111], v[56:59]
  ds_read_b64_tr_b16 v[36:37], v13 offset:12288
  ds_read_b64_tr_b16 v[38:39], v13 offset:13056
  s_waitcnt lgkmcnt(10)
  v_mfma_f32_16x16x32_bf16 v[68:71], v[48:51], v[104:107], v[68:71]
  v_mfma_f32_16x16x32_bf16 v[64:67], v[48:51], v[108:111], v[64:67]
  ds_read_b64_tr_b16 v[40:41], v14 offset:12288
  ds_read_b64_tr_b16 v[42:43], v14 offset:13056
  s_waitcnt lgkmcnt(10)
  v_mfma_f32_16x16x32_bf16 v[76:79], v[52:55], v[104:107], v[76:79]
  v_mfma_f32_16x16x32_bf16 v[72:75], v[52:55], v[108:111], v[72:75]
  ds_read_b64_tr_b16 v[44:45], v15 offset:12288
  ds_read_b64_tr_b16 v[46:47], v15 offset:13056
  s_waitcnt lgkmcnt(10)
  v_mfma_f32_16x16x32_bf16 v[84:87], v[24:27], v[104:107], v[84:87]
  v_mfma_f32_16x16x32_bf16 v[80:83], v[24:27], v[108:111], v[80:83]
  ds_read_b64_tr_b16 v[48:49], v16 offset:12288
  ds_read_b64_tr_b16 v[50:51], v16 offset:13056
  s_waitcnt lgkmcnt(10)
  v_mfma_f32_16x16x32_bf16 v[92:95], v[28:31], v[104:107], v[92:95]
  v_mfma_f32_16x16x32_bf16 v[88:91], v[28:31], v[108:111], v[88:91]
  ds_read_b64_tr_b16 v[52:53], v12 offset:18432
  ds_read_b64_tr_b16 v[54:55], v12 offset:19200
  s_waitcnt vmcnt(22) lgkmcnt(10)
  v_mfma_f32_16x16x32_bf16 v[60:63], v[32:35], v[112:115], v[60:63]
  v_mfma_f32_16x16x32_bf16 v[56:59], v[32:35], v[116:119], v[56:59]
  ds_read_b64_tr_b16 v[24:25], v13 offset:18432
  ds_read_b64_tr_b16 v[26:27], v13 offset:19200
  s_waitcnt lgkmcnt(10)
  v_mfma_f32_16x16x32_bf16 v[68:71], v[36:39], v[112:115], v[68:71]
  v_mfma_f32_16x16x32_bf16 v[64:67], v[36:39], v[116:119], v[64:67]
  ds_read_b64_tr_b16 v[28:29], v14 offset:18432
  ds_read_b64_tr_b16 v[30:31], v14 offset:19200
  s_waitcnt lgkmcnt(10)
  v_mfma_f32_16x16x32_bf16 v[76:79], v[40:43], v[112:115], v[76:79]
  v_mfma_f32_16x16x32_bf16 v[72:75], v[40:43], v[116:119], v[72:75]
  ds_read_b64_tr_b16 v[32:33], v15 offset:18432
  ds_read_b64_tr_b16 v[34:35], v15 offset:19200
  s_waitcnt lgkmcnt(10)
  v_mfma_f32_16x16x32_bf16 v[84:87], v[44:47], v[112:115], v[84:87]
  v_mfma_f32_16x16x32_bf16 v[80:83], v[44:47], v[116:119], v[80:83]
  ds_read_b64_tr_b16 v[36:37], v16 offset:18432
  ds_read_b64_tr_b16 v[38:39], v16 offset:19200
  s_waitcnt lgkmcnt(10)
  v_mfma_f32_16x16x32_bf16 v[92:95], v[48:51], v[112:115], v[92:95]
  v_mfma_f32_16x16x32_bf16 v[88:91], v[48:51], v[116:119], v[88:91]
  ds_read_b64_tr_b16 v[40:41], v12 offset:24576
  ds_read_b64_tr_b16 v[42:43], v12 offset:25344
  s_waitcnt vmcnt(20) lgkmcnt(10)
  v_mfma_f32_16x16x32_bf16 v[60:63], v[52:55], v[120:123], v[60:63]
  v_mfma_f32_16x16x32_bf16 v[56:59], v[52:55], v[124:127], v[56:59]
  ds_read_b64_tr_b16 v[44:45], v13 offset:24576
  ds_read_b64_tr_b16 v[46:47], v13 offset:25344
  s_waitcnt lgkmcnt(10)
  v_mfma_f32_16x16x32_bf16 v[68:71], v[24:27], v[120:123], v[68:71]
  v_mfma_f32_16x16x32_bf16 v[64:67], v[24:27], v[124:127], v[64:67]
  ds_read_b64_tr_b16 v[48:49], v14 offset:24576
  ds_read_b64_tr_b16 v[50:51], v14 offset:25344
  s_waitcnt lgkmcnt(10)
  v_mfma_f32_16x16x32_bf16 v[76:79], v[28:31], v[120:123], v[76:79]
  v_mfma_f32_16x16x32_bf16 v[72:75], v[28:31], v[124:127], v[72:75]
  ds_read_b64_tr_b16 v[52:53], v15 offset:24576
  ds_read_b64_tr_b16 v[54:55], v15 offset:25344
  s_waitcnt lgkmcnt(10)
  v_mfma_f32_16x16x32_bf16 v[84:87], v[32:35], v[120:123], v[84:87]
  v_mfma_f32_16x16x32_bf16 v[80:83], v[32:35], v[124:127], v[80:83]
  ds_read_b64_tr_b16 v[24:25], v16 offset:24576
  ds_read_b64_tr_b16 v[26:27], v16 offset:25344
  s_waitcnt lgkmcnt(10)
  v_mfma_f32_16x16x32_bf16 v[92:95], v[36:39], v[120:123], v[92:95]
  v_mfma_f32_16x16x32_bf16 v[88:91], v[36:39], v[124:127], v[88:91]
  ds_read_b64_tr_b16 v[28:29], v12 offset:30720
  ds_read_b64_tr_b16 v[30:31], v12 offset:31488
  s_waitcnt vmcnt(18) lgkmcnt(10)
  v_mfma_f32_16x16x32_bf16 v[60:63], v[40:43], v[128:131], v[60:63]
  v_mfma_f32_16x16x32_bf16 v[56:59], v[40:43], v[132:135], v[56:59]
  ds_read_b64_tr_b16 v[32:33], v13 offset:30720
  ds_read_b64_tr_b16 v[34:35], v13 offset:31488
  s_waitcnt lgkmcnt(10)
  v_mfma_f32_16x16x32_bf16 v[68:71], v[44:47], v[128:131], v[68:71]
  v_mfma_f32_16x16x32_bf16 v[64:67], v[44:47], v[132:135], v[64:67]
  ds_read_b64_tr_b16 v[36:37], v14 offset:30720
  ds_read_b64_tr_b16 v[38:39], v14 offset:31488
  s_waitcnt lgkmcnt(10)
  v_mfma_f32_16x16x32_bf16 v[76:79], v[48:51], v[128:131], v[76:79]
  v_mfma_f32_16x16x32_bf16 v[72:75], v[48:51], v[132:135], v[72:75]
  ds_read_b64_tr_b16 v[40:41], v15 offset:30720
  ds_read_b64_tr_b16 v[42:43], v15 offset:31488
  s_waitcnt lgkmcnt(10)
  v_mfma_f32_16x16x32_bf16 v[84:87], v[52:55], v[128:131], v[84:87]
  v_mfma_f32_16x16x32_bf16 v[80:83], v[52:55], v[132:135], v[80:83]
  ds_read_b64_tr_b16 v[44:45], v16 offset:30720
  ds_read_b64_tr_b16 v[46:47], v16 offset:31488
  s_waitcnt lgkmcnt(10)
  v_mfma_f32_16x16x32_bf16 v[92:95], v[24:27], v[128:131], v[92:95]
  v_mfma_f32_16x16x32_bf16 v[88:91], v[24:27], v[132:135], v[88:91]
  ds_read_b64_tr_b16 v[48:49], v12 offset:36864
  ds_read_b64_tr_b16 v[50:51], v12 offset:37632
  s_waitcnt vmcnt(16) lgkmcnt(10)
  v_mfma_f32_16x16x32_bf16 v[60:63], v[28:31], v[136:139], v[60:63]
  v_mfma_f32_16x16x32_bf16 v[56:59], v[28:31], v[140:143], v[56:59]
  ds_read_b64_tr_b16 v[52:53], v13 offset:36864
  ds_read_b64_tr_b16 v[54:55], v13 offset:37632
  s_waitcnt lgkmcnt(10)
  v_mfma_f32_16x16x32_bf16 v[68:71], v[32:35], v[136:139], v[68:71]
  v_mfma_f32_16x16x32_bf16 v[64:67], v[32:35], v[140:143], v[64:67]
  ds_read_b64_tr_b16 v[24:25], v14 offset:36864
  ds_read_b64_tr_b16 v[26:27], v14 offset:37632
  s_waitcnt lgkmcnt(10)
  v_mfma_f32_16x16x32_bf16 v[76:79], v[36:39], v[136:139], v[76:79]
  v_mfma_f32_16x16x32_bf16 v[72:75], v[36:39], v[140:143], v[72:75]
  ds_read_b64_tr_b16 v[28:29], v15 offset:36864
  ds_read_b64_tr_b16 v[30:31], v15 offset:37632
  s_waitcnt lgkmcnt(10)
  v_mfma_f32_16x16x32_bf16 v[84:87], v[40:43], v[136:139], v[84:87]
  v_mfma_f32_16x16x32_bf16 v[80:83], v[40:43], v[140:143], v[80:83]
  ds_read_b64_tr_b16 v[32:33], v16 offset:36864
  ds_read_b64_tr_b16 v[34:35], v16 offset:37632
  s_waitcnt lgkmcnt(10)
  v_mfma_f32_16x16x32_bf16 v[92:95], v[44:47], v[136:139], v[92:95]
  v_mfma_f32_16x16x32_bf16 v[88:91], v[44:47], v[140:143], v[88:91]
  ds_read_b64_tr_b16 v[36:37], v12 offset:43008
  ds_read_b64_tr_b16 v[38:39], v12 offset:43776
  s_waitcnt vmcnt(8) lgkmcnt(10)
  v_mfma_f32_16x16x32_bf16 v[60:63], v[48:51], v[144:147], v[60:63]
  v_mfma_f32_16x16x32_bf16 v[56:59], v[48:51], v[148:151], v[56:59]
  ds_read_b64_tr_b16 v[40:41], v13 offset:43008
  ds_read_b64_tr_b16 v[42:43], v13 offset:43776
  s_waitcnt lgkmcnt(10)
  v_mfma_f32_16x16x32_bf16 v[68:71], v[52:55], v[144:147], v[68:71]
  v_mfma_f32_16x16x32_bf16 v[64:67], v[52:55], v[148:151], v[64:67]
  ds_read_b64_tr_b16 v[44:45], v14 offset:43008
  ds_read_b64_tr_b16 v[46:47], v14 offset:43776
  s_waitcnt lgkmcnt(10)
  v_mfma_f32_16x16x32_bf16 v[76:79], v[24:27], v[144:147], v[76:79]
  v_mfma_f32_16x16x32_bf16 v[72:75], v[24:27], v[148:151], v[72:75]
  ds_read_b64_tr_b16 v[48:49], v15 offset:43008
  ds_read_b64_tr_b16 v[50:51], v15 offset:43776
  s_waitcnt lgkmcnt(10)
  v_mfma_f32_16x16x32_bf16 v[84:87], v[28:31], v[144:147], v[84:87]
  v_mfma_f32_16x16x32_bf16 v[80:83], v[28:31], v[148:151], v[80:83]
  ds_read_b64_tr_b16 v[52:53], v16 offset:43008
  ds_read_b64_tr_b16 v[54:55], v16 offset:43776
  s_waitcnt lgkmcnt(10)
  v_mfma_f32_16x16x32_bf16 v[92:95], v[32:35], v[144:147], v[92:95]
  v_mfma_f32_16x16x32_bf16 v[88:91], v[32:35], v[148:151], v[88:91]
  s_waitcnt vmcnt(0) lgkmcnt(8)
  v_mfma_f32_16x16x32_bf16 v[60:63], v[36:39], v[152:155], v[60:63]
  v_mfma_f32_16x16x32_bf16 v[56:59], v[36:39], v[156:159], v[56:59]
  s_waitcnt lgkmcnt(6)
  v_mfma_f32_16x16x32_bf16 v[68:71], v[40:43], v[152:155], v[68:71]
  v_mfma_f32_16x16x32_bf16 v[64:67], v[40:43], v[156:159], v[64:67]
  s_waitcnt lgkmcnt(4)
  v_mfma_f32_16x16x32_bf16 v[76:79], v[44:47], v[152:155], v[76:79]
  v_mfma_f32_16x16x32_bf16 v[72:75], v[44:47], v[156:159], v[72:75]
  s_waitcnt lgkmcnt(2)
  v_mfma_f32_16x16x32_bf16 v[84:87], v[48:51], v[152:155], v[84:87]
  v_mfma_f32_16x16x32_bf16 v[80:83], v[48:51], v[156:159], v[80:83]
  s_waitcnt lgkmcnt(0)
  v_mfma_f32_16x16x32_bf16 v[92:95], v[52:55], v[152:155], v[92:95]
  v_mfma_f32_16x16x32_bf16 v[88:91], v[52:55], v[156:159], v[88:91]
  s_nop 7
  ds_write_b128 v191, v[60:63] offset:0
  ds_write_b128 v191, v[68:71] offset:1024
  ds_write_b128 v191, v[76:79] offset:2048
  ds_write_b128 v191, v[84:87] offset:3072
  ds_write_b128 v191, v[92:95] offset:4096
proj_join:
  s_waitcnt lgkmcnt(0)
  s_barrier
  ds_read_b128 v[96:99], v192 offset:0
  ds_read_b128 v[100:103], v192 offset:1024
  ds_read_b128 v[104:107], v192 offset:2048
  ds_read_b128 v[108:111], v192 offset:3072
  ds_read_b128 v[112:115], v192 offset:4096
  s_waitcnt lgkmcnt(4)
  v_pk_add_f32 v[56:57], v[56:57], v[96:97]
  v_pk_add_f32 v[58:59], v[58:59], v[98:99]
  v_cvt_pk_bf16_f32 v24, v56, v57
  v_cvt_pk_bf16_f32 v25, v58, v59
  ds_write_b64 v19, v[24:25] offset:0
  s_waitcnt lgkmcnt(3)
  v_pk_add_f32 v[64:65], v[64:65], v[100:101]
  v_pk_add_f32 v[66:67], v[66:67], v[102:103]
  v_cvt_pk_bf16_f32 v26, v64, v65
  v_cvt_pk_bf16_f32 v27, v66, v67
  ds_write_b64 v19, v[26:27] offset:32
  s_waitcnt lgkmcnt(2)
  v_pk_add_f32 v[72:73], v[72:73], v[104:105]
  v_pk_add_f32 v[74:75], v[74:75], v[106:107]
  v_cvt_pk_bf16_f32 v28, v72, v73
  v_cvt_pk_bf16_f32 v29, v74, v75
  ds_write_b64 v19, v[28:29] offset:64
  s_waitcnt lgkmcnt(1)
  v_pk_add_f32 v[80:81], v[80:81], v[108:109]
  v_pk_add_f32 v[82:83], v[82:83], v[110:111]
  v_cvt_pk_bf16_f32 v30, v80, v81
  v_cvt_pk_bf16_f32 v31, v82, v83
  ds_write_b64 v19, v[30:31] offset:96
  s_waitcnt lgkmcnt(0)
  v_pk_add_f32 v[88:89], v[88:89], v[112:113]
  v_pk_add_f32 v[90:91], v[90:91], v[114:115]
  v_cvt_pk_bf16_f32 v32, v88, v89
  v_cvt_pk_bf16_f32 v33, v90, v91
  ds_write_b64 v19, v[32:33] offset:128
  s_waitcnt lgkmcnt(0)
  ds_read_b128 v[96:99], v184
  ds_read_b128 v[100:103], v185
  ds_read_b128 v[104:107], v186
  s_waitcnt lgkmcnt(2)
  buffer_store_dwordx4 v[96:99], v187, s[16:19], s40 offen
  s_waitcnt lgkmcnt(1)
  buffer_store_dwordx4 v[100:103], v188, s[16:19], s40 offen
  s_waitcnt lgkmcnt(0)
  buffer_store_dwordx4 v[104:107], v189, s[16:19], s40 offen
  s_endpgm
fused_end:
  s_endpgm
.section .rodata,"a"
.p2align 6
.amdhsa_kernel concat_heads__mha_block__linear_attn_block__prompt_kernel
  .amdhsa_next_free_vgpr 256
  .amdhsa_next_free_sgpr 102
  .amdhsa_accum_offset 256
  .amdhsa_group_segment_fixed_size 0
  .amdhsa_kernarg_size 72
  .amdhsa_user_sgpr_count 2
  .amdhsa_user_sgpr_kernarg_segment_ptr 1
  .amdhsa_system_sgpr_workgroup_id_x 1
.end_amdhsa_kernel
.text
```
